```python
import torch

def _softmax(x, axis=-1):
    return torch.softmax(x, dim=axis)

def _gelu(x):
    return torch.nn.functional.gelu(x, approximate='tanh')

def _silu(x):
    return torch.nn.functional.silu(x)

def _sigmoid(x):
    return torch.sigmoid(x)

def _layernorm(x, axis=-1, eps=1e-05):
    m = x.mean(dim=axis, keepdim=True)
    v = x.var(dim=axis, keepdim=True, unbiased=False)
    return (x - m) / torch.sqrt(v + eps)

def _scatter_add(tgt, idx, src, axis=0):
    return tgt.clone().index_add_(axis, idx, src)

def _segment_sum(src, seg, n):
    out = torch.zeros((n,) + src.shape[1:], dtype=src.dtype)
    return out.index_add_(0, seg, src)

def _pad(x, pw):
    flat = tuple((v for pair in reversed(pw) for v in pair))
    return torch.nn.functional.pad(x, flat)
kernel_name = 'standalone__mm_dit__diffusion'

def setup_inputs():

    _w = lambda a: (lambda t: t.to(torch.bfloat16) if t.is_floating_point() else t)(torch.as_tensor(a))
    B, Ni, Nt, D = (2, 1024, 32, 768)
    return {'x_img': _w((lambda *s: torch.randn(*s, dtype=torch.bfloat16) * 0.05)(B, Ni, D)), 'x_txt': _w((lambda *s: torch.randn(*s, dtype=torch.bfloat16) * 0.05)(B, Nt, D)), 'c': _w((lambda *s: torch.randn(*s, dtype=torch.bfloat16) * 0.05)(B, D)), 'wqkv_img': _w((lambda *s: torch.randn(*s, dtype=torch.bfloat16) * 0.05)(D, 3 * D)), 'wqkv_txt': _w((lambda *s: torch.randn(*s, dtype=torch.bfloat16) * 0.05)(D, 3 * D)), 'wo_img': _w((lambda *s: torch.randn(*s, dtype=torch.bfloat16) * 0.05)(D, D)), 'wo_txt': _w((lambda *s: torch.randn(*s, dtype=torch.bfloat16) * 0.05)(D, D)), 'wmod_img': _w((lambda *s: torch.randn(*s, dtype=torch.bfloat16) * 0.05)(D, 6 * D)), 'wmod_txt': _w((lambda *s: torch.randn(*s, dtype=torch.bfloat16) * 0.05)(D, 6 * D))}

def reference(x_img, x_txt, c, wqkv_img, wqkv_txt, wo_img, wo_txt, wmod_img, wmod_txt):
    B, Ni, D = x_img.shape
    Nt = x_txt.shape[1]
    mod_i = (_silu(c) @ wmod_img).reshape(B, 6, 1, D)
    mod_t = (_silu(c) @ wmod_txt).reshape(B, 6, 1, D)
    shi, sci, gai = (mod_i[:, 0].clone(), mod_i[:, 1].clone(), mod_i[:, 2].clone())
    sht, sct, gat = (mod_t[:, 0].clone(), mod_t[:, 1].clone(), mod_t[:, 2].clone())
    hi = _layernorm(x_img, axis=-1) * (1 + sci) + shi
    ht = _layernorm(x_txt, axis=-1) * (1 + sct) + sht
    qkvi = hi @ wqkv_img
    qkvt = ht @ wqkv_txt
    qi, ki, vi = (qkvi[..., :D].clone(), qkvi[..., D:2 * D].clone(), qkvi[..., 2 * D:].clone())
    qt, kt, vt = (qkvt[..., :D].clone(), qkvt[..., D:2 * D].clone(), qkvt[..., 2 * D:].clone())
    q = torch.concatenate([qt, qi], axis=1)
    k = torch.concatenate([kt, ki], axis=1)
    v = torch.concatenate([vt, vi], axis=1)
    scores = torch.einsum('bqd,bkd->bqk', q, k) * D ** (-0.5)
    p = _softmax(scores, axis=-1)
    a = torch.einsum('bqk,bkd->bqd', p, v)
    at, ai = (a[:, :Nt].clone(), a[:, Nt:].clone())
    out_i = x_img + gai * (ai @ wo_img)
    out_t = x_txt + gat * (at @ wo_txt)
    return (out_i, out_t)
```

```asm
; @launch kernel=k1_kernel grid=(480,1,1) block=(256,1,1) lds=12288
; @launch kernel=k2_kernel grid=(256,1,1) block=(256,1,1) lds=94208
; @launch kernel=k3_kernel grid=(256,1,1) block=(256,1,1) lds=147456
; @launch kernel=k4_kernel grid=(256,1,1) block=(256,1,1) lds=122880
.amdgcn_target "amdgcn-amd-amdhsa--gfx950"
.text
.globl k1_kernel
.p2align 8
.type k1_kernel,@function
k1_kernel:
  s_cmp_ge_u32 s2, 480
  s_cbranch_scc1 K1_end
  s_load_dwordx4 s[4:7], s[0:1], 0
  s_load_dwordx2 s[8:9], s[0:1], 16
  s_load_dwordx4 s[12:15], s[0:1], 56
  s_load_dwordx2 s[10:11], s[0:1], 88
  s_load_dwordx2 s[44:45], s[0:1], 24
  v_and_b32 v1, 63, v0
  v_lshrrev_b32 v2, 6, v0

  s_waitcnt lgkmcnt(0)
  s_mov_b32 s16, s10
  s_mov_b32 s17, s11
  s_mov_b32 s18, 268435456
  s_mov_b32 s19, 0x00020000
  s_cmp_ge_u32 s2, 216
  s_cbranch_scc1 K1_stats
  s_mov_b32 s20, 0
  s_mov_b32 s21, s2
  s_cmp_ge_u32 s21, 72
  s_cbranch_scc0 K1_m1
  s_sub_u32 s21, s21, 72
  s_add_u32 s20, s20, 1
  s_cmp_ge_u32 s21, 72
  s_cbranch_scc0 K1_m1
  s_sub_u32 s21, s21, 72
  s_add_u32 s20, s20, 1
K1_m1:
  s_cmp_ge_u32 s21, 36
  s_cselect_b32 s24, s14, s12
  s_cselect_b32 s25, s15, s13
  s_cselect_b32 s22, 36, 0
  s_sub_u32 s22, s21, s22
  s_mov_b32 s26, 7077888
  s_mov_b32 s27, 0x00020000

  s_mov_b32 s28, s8
  s_mov_b32 s29, s9
  s_mov_b32 s30, 3072
  s_mov_b32 s31, 0x00020000
  s_lshl_b32 s23, s20, 8
  v_add_u32 v3, s23, v0
  v_lshlrev_b32 v3, 1, v3
  buffer_load_ushort v4, v3, s[28:31], 0 offen
  buffer_load_ushort v5, v3, s[28:31], 0 offen offset:1536
  v_and_b32 v6, 15, v1
  v_lshrrev_b32 v7, 4, v1
  v_lshl_add_u32 v8, v2, 6, v7
  s_movk_i32 s32, 9216
  v_mul_lo_u32 v9, v8, s32
  v_lshl_add_u32 v9, v6, 3, v9
  s_lshl_b32 s33, s22, 7
  v_add_u32 v9, s33, v9
  s_mul_i32 s34, s20, 2359296

  buffer_load_dwordx2 v[32:33], v9, s[24:27], s34 offen
  s_add_u32 s34, s34, 36864
  buffer_load_dwordx2 v[34:35], v9, s[24:27], s34 offen
  s_add_u32 s34, s34, 36864
  buffer_load_dwordx2 v[36:37], v9, s[24:27], s34 offen
  s_add_u32 s34, s34, 36864
  buffer_load_dwordx2 v[38:39], v9, s[24:27], s34 offen
  s_add_u32 s34, s34, 36864
  buffer_load_dwordx2 v[40:41], v9, s[24:27], s34 offen
  s_add_u32 s34, s34, 36864
  buffer_load_dwordx2 v[42:43], v9, s[24:27], s34 offen
  s_add_u32 s34, s34, 36864
  buffer_load_dwordx2 v[44:45], v9, s[24:27], s34 offen
  s_add_u32 s34, s34, 36864
  buffer_load_dwordx2 v[46:47], v9, s[24:27], s34 offen
  s_add_u32 s34, s34, 36864
  buffer_load_dwordx2 v[48:49], v9, s[24:27], s34 offen
  s_add_u32 s34, s34, 36864
  buffer_load_dwordx2 v[50:51], v9, s[24:27], s34 offen
  s_add_u32 s34, s34, 36864
  buffer_load_dwordx2 v[52:53], v9, s[24:27], s34 offen
  s_add_u32 s34, s34, 36864
  buffer_load_dwordx2 v[54:55], v9, s[24:27], s34 offen
  s_add_u32 s34, s34, 36864
  buffer_load_dwordx2 v[56:57], v9, s[24:27], s34 offen
  s_add_u32 s34, s34, 36864
  buffer_load_dwordx2 v[58:59], v9, s[24:27], s34 offen
  s_add_u32 s34, s34, 36864
  buffer_load_dwordx2 v[60:61], v9, s[24:27], s34 offen
  s_add_u32 s34, s34, 36864
  buffer_load_dwordx2 v[62:63], v9, s[24:27], s34 offen
  s_waitcnt vmcnt(16)

  v_lshlrev_b32 v4, 16, v4
  v_mul_f32 v10, 0xbfb8aa3b, v4
  v_exp_f32 v10, v10
  s_nop 0
  v_add_f32 v10, 1.0, v10
  v_rcp_f32 v10, v10
  s_nop 0
  v_mul_f32 v4, v4, v10

  v_lshlrev_b32 v5, 16, v5
  v_mul_f32 v10, 0xbfb8aa3b, v5
  v_exp_f32 v10, v10
  s_nop 0
  v_add_f32 v10, 1.0, v10
  v_rcp_f32 v10, v10
  s_nop 0
  v_mul_f32 v5, v5, v10

  v_cvt_pk_bf16_f32 v10, v4, v5
  v_lshlrev_b32 v4, 16, v10
  v_and_b32 v5, 0xffff0000, v10
  v_lshlrev_b32 v11, 3, v0
  ds_write_b64 v11, v[4:5]
  s_waitcnt lgkmcnt(0)
  s_barrier
  v_lshlrev_b32 v11, 3, v8

  ds_read_b64 v[64:65], v11 offset:0
  ds_read_b64 v[66:67], v11 offset:32
  ds_read_b64 v[68:69], v11 offset:64
  ds_read_b64 v[70:71], v11 offset:96
  ds_read_b64 v[72:73], v11 offset:128
  ds_read_b64 v[74:75], v11 offset:160
  ds_read_b64 v[76:77], v11 offset:192
  ds_read_b64 v[78:79], v11 offset:224
  ds_read_b64 v[80:81], v11 offset:256
  ds_read_b64 v[82:83], v11 offset:288
  ds_read_b64 v[84:85], v11 offset:320
  ds_read_b64 v[86:87], v11 offset:352
  ds_read_b64 v[88:89], v11 offset:384
  ds_read_b64 v[90:91], v11 offset:416
  ds_read_b64 v[92:93], v11 offset:448
  ds_read_b64 v[94:95], v11 offset:480
  v_mov_b32 v16, 0
  v_mov_b32 v17, 0
  v_mov_b32 v18, 0
  v_mov_b32 v19, 0
  v_mov_b32 v20, 0
  v_mov_b32 v21, 0
  v_mov_b32 v22, 0
  v_mov_b32 v23, 0
  s_waitcnt vmcnt(15) lgkmcnt(15)
  v_lshlrev_b32 v12, 16, v32
  v_and_b32 v13, 0xffff0000, v32
  v_lshlrev_b32 v14, 16, v33
  v_and_b32 v15, 0xffff0000, v33
  v_fmac_f32 v16, v12, v64
  v_fmac_f32 v17, v13, v64
  v_fmac_f32 v18, v14, v64
  v_fmac_f32 v19, v15, v64
  v_fmac_f32 v20, v12, v65
  v_fmac_f32 v21, v13, v65
  v_fmac_f32 v22, v14, v65
  v_fmac_f32 v23, v15, v65

  s_waitcnt vmcnt(14) lgkmcnt(14)
  v_lshlrev_b32 v12, 16, v34
  v_and_b32 v13, 0xffff0000, v34
  v_lshlrev_b32 v14, 16, v35
  v_and_b32 v15, 0xffff0000, v35
  v_fmac_f32 v16, v12, v66
  v_fmac_f32 v17, v13, v66
  v_fmac_f32 v18, v14, v66
  v_fmac_f32 v19, v15, v66
  v_fmac_f32 v20, v12, v67
  v_fmac_f32 v21, v13, v67
  v_fmac_f32 v22, v14, v67
  v_fmac_f32 v23, v15, v67

  s_waitcnt vmcnt(13) lgkmcnt(13)
  v_lshlrev_b32 v12, 16, v36
  v_and_b32 v13, 0xffff0000, v36
  v_lshlrev_b32 v14, 16, v37
  v_and_b32 v15, 0xffff0000, v37
  v_fmac_f32 v16, v12, v68
  v_fmac_f32 v17, v13, v68
  v_fmac_f32 v18, v14, v68
  v_fmac_f32 v19, v15, v68
  v_fmac_f32 v20, v12, v69
  v_fmac_f32 v21, v13, v69
  v_fmac_f32 v22, v14, v69
  v_fmac_f32 v23, v15, v69

  s_waitcnt vmcnt(12) lgkmcnt(12)
  v_lshlrev_b32 v12, 16, v38
  v_and_b32 v13, 0xffff0000, v38
  v_lshlrev_b32 v14, 16, v39
  v_and_b32 v15, 0xffff0000, v39
  v_fmac_f32 v16, v12, v70
  v_fmac_f32 v17, v13, v70
  v_fmac_f32 v18, v14, v70
  v_fmac_f32 v19, v15, v70
  v_fmac_f32 v20, v12, v71
  v_fmac_f32 v21, v13, v71
  v_fmac_f32 v22, v14, v71
  v_fmac_f32 v23, v15, v71

  s_waitcnt vmcnt(11) lgkmcnt(11)
  v_lshlrev_b32 v12, 16, v40
  v_and_b32 v13, 0xffff0000, v40
  v_lshlrev_b32 v14, 16, v41
  v_and_b32 v15, 0xffff0000, v41
  v_fmac_f32 v16, v12, v72
  v_fmac_f32 v17, v13, v72
  v_fmac_f32 v18, v14, v72
  v_fmac_f32 v19, v15, v72
  v_fmac_f32 v20, v12, v73
  v_fmac_f32 v21, v13, v73
  v_fmac_f32 v22, v14, v73
  v_fmac_f32 v23, v15, v73

  s_waitcnt vmcnt(10) lgkmcnt(10)
  v_lshlrev_b32 v12, 16, v42
  v_and_b32 v13, 0xffff0000, v42
  v_lshlrev_b32 v14, 16, v43
  v_and_b32 v15, 0xffff0000, v43
  v_fmac_f32 v16, v12, v74
  v_fmac_f32 v17, v13, v74
  v_fmac_f32 v18, v14, v74
  v_fmac_f32 v19, v15, v74
  v_fmac_f32 v20, v12, v75
  v_fmac_f32 v21, v13, v75
  v_fmac_f32 v22, v14, v75
  v_fmac_f32 v23, v15, v75

  s_waitcnt vmcnt(9) lgkmcnt(9)
  v_lshlrev_b32 v12, 16, v44
  v_and_b32 v13, 0xffff0000, v44
  v_lshlrev_b32 v14, 16, v45
  v_and_b32 v15, 0xffff0000, v45
  v_fmac_f32 v16, v12, v76
  v_fmac_f32 v17, v13, v76
  v_fmac_f32 v18, v14, v76
  v_fmac_f32 v19, v15, v76
  v_fmac_f32 v20, v12, v77
  v_fmac_f32 v21, v13, v77
  v_fmac_f32 v22, v14, v77
  v_fmac_f32 v23, v15, v77

  s_waitcnt vmcnt(8) lgkmcnt(8)
  v_lshlrev_b32 v12, 16, v46
  v_and_b32 v13, 0xffff0000, v46
  v_lshlrev_b32 v14, 16, v47
  v_and_b32 v15, 0xffff0000, v47
  v_fmac_f32 v16, v12, v78
  v_fmac_f32 v17, v13, v78
  v_fmac_f32 v18, v14, v78
  v_fmac_f32 v19, v15, v78
  v_fmac_f32 v20, v12, v79
  v_fmac_f32 v21, v13, v79
  v_fmac_f32 v22, v14, v79
  v_fmac_f32 v23, v15, v79

  s_waitcnt vmcnt(7) lgkmcnt(7)
  v_lshlrev_b32 v12, 16, v48
  v_and_b32 v13, 0xffff0000, v48
  v_lshlrev_b32 v14, 16, v49
  v_and_b32 v15, 0xffff0000, v49
  v_fmac_f32 v16, v12, v80
  v_fmac_f32 v17, v13, v80
  v_fmac_f32 v18, v14, v80
  v_fmac_f32 v19, v15, v80
  v_fmac_f32 v20, v12, v81
  v_fmac_f32 v21, v13, v81
  v_fmac_f32 v22, v14, v81
  v_fmac_f32 v23, v15, v81

  s_waitcnt vmcnt(6) lgkmcnt(6)
  v_lshlrev_b32 v12, 16, v50
  v_and_b32 v13, 0xffff0000, v50
  v_lshlrev_b32 v14, 16, v51
  v_and_b32 v15, 0xffff0000, v51
  v_fmac_f32 v16, v12, v82
  v_fmac_f32 v17, v13, v82
  v_fmac_f32 v18, v14, v82
  v_fmac_f32 v19, v15, v82
  v_fmac_f32 v20, v12, v83
  v_fmac_f32 v21, v13, v83
  v_fmac_f32 v22, v14, v83
  v_fmac_f32 v23, v15, v83

  s_waitcnt vmcnt(5) lgkmcnt(5)
  v_lshlrev_b32 v12, 16, v52
  v_and_b32 v13, 0xffff0000, v52
  v_lshlrev_b32 v14, 16, v53
  v_and_b32 v15, 0xffff0000, v53
  v_fmac_f32 v16, v12, v84
  v_fmac_f32 v17, v13, v84
  v_fmac_f32 v18, v14, v84
  v_fmac_f32 v19, v15, v84
  v_fmac_f32 v20, v12, v85
  v_fmac_f32 v21, v13, v85
  v_fmac_f32 v22, v14, v85
  v_fmac_f32 v23, v15, v85

  s_waitcnt vmcnt(4) lgkmcnt(4)
  v_lshlrev_b32 v12, 16, v54
  v_and_b32 v13, 0xffff0000, v54
  v_lshlrev_b32 v14, 16, v55
  v_and_b32 v15, 0xffff0000, v55
  v_fmac_f32 v16, v12, v86
  v_fmac_f32 v17, v13, v86
  v_fmac_f32 v18, v14, v86
  v_fmac_f32 v19, v15, v86
  v_fmac_f32 v20, v12, v87
  v_fmac_f32 v21, v13, v87
  v_fmac_f32 v22, v14, v87
  v_fmac_f32 v23, v15, v87

  s_waitcnt vmcnt(3) lgkmcnt(3)
  v_lshlrev_b32 v12, 16, v56
  v_and_b32 v13, 0xffff0000, v56
  v_lshlrev_b32 v14, 16, v57
  v_and_b32 v15, 0xffff0000, v57
  v_fmac_f32 v16, v12, v88
  v_fmac_f32 v17, v13, v88
  v_fmac_f32 v18, v14, v88
  v_fmac_f32 v19, v15, v88
  v_fmac_f32 v20, v12, v89
  v_fmac_f32 v21, v13, v89
  v_fmac_f32 v22, v14, v89
  v_fmac_f32 v23, v15, v89

  s_waitcnt vmcnt(2) lgkmcnt(2)
  v_lshlrev_b32 v12, 16, v58
  v_and_b32 v13, 0xffff0000, v58
  v_lshlrev_b32 v14, 16, v59
  v_and_b32 v15, 0xffff0000, v59
  v_fmac_f32 v16, v12, v90
  v_fmac_f32 v17, v13, v90
  v_fmac_f32 v18, v14, v90
  v_fmac_f32 v19, v15, v90
  v_fmac_f32 v20, v12, v91
  v_fmac_f32 v21, v13, v91
  v_fmac_f32 v22, v14, v91
  v_fmac_f32 v23, v15, v91

  s_waitcnt vmcnt(1) lgkmcnt(1)
  v_lshlrev_b32 v12, 16, v60
  v_and_b32 v13, 0xffff0000, v60
  v_lshlrev_b32 v14, 16, v61
  v_and_b32 v15, 0xffff0000, v61
  v_fmac_f32 v16, v12, v92
  v_fmac_f32 v17, v13, v92
  v_fmac_f32 v18, v14, v92
  v_fmac_f32 v19, v15, v92
  v_fmac_f32 v20, v12, v93
  v_fmac_f32 v21, v13, v93
  v_fmac_f32 v22, v14, v93
  v_fmac_f32 v23, v15, v93

  s_waitcnt vmcnt(0) lgkmcnt(0)
  v_lshlrev_b32 v12, 16, v62
  v_and_b32 v13, 0xffff0000, v62
  v_lshlrev_b32 v14, 16, v63
  v_and_b32 v15, 0xffff0000, v63
  v_fmac_f32 v16, v12, v94
  v_fmac_f32 v17, v13, v94
  v_fmac_f32 v18, v14, v94
  v_fmac_f32 v19, v15, v94
  v_fmac_f32 v20, v12, v95
  v_fmac_f32 v21, v13, v95
  v_fmac_f32 v22, v14, v95
  v_fmac_f32 v23, v15, v95

  v_lshl_add_u32 v11, v2, 2, v7
  v_lshlrev_b32 v11, 9, v11
  v_lshl_add_u32 v11, v6, 5, v11
  ds_write_b128 v11, v[16:19] offset:2048
  ds_write_b128 v11, v[20:23] offset:2064
  s_waitcnt lgkmcnt(0)
  s_barrier
  v_cmp_gt_u32 vcc, 128, v0
  s_and_saveexec_b64 s[36:37], vcc
  s_cbranch_execz K1_end
  v_lshlrev_b32 v11, 2, v0

  ds_read_b32 v32, v11 offset:2048
  ds_read_b32 v33, v11 offset:2560
  ds_read_b32 v34, v11 offset:3072
  ds_read_b32 v35, v11 offset:3584
  ds_read_b32 v36, v11 offset:4096
  ds_read_b32 v37, v11 offset:4608
  ds_read_b32 v38, v11 offset:5120
  ds_read_b32 v39, v11 offset:5632
  ds_read_b32 v40, v11 offset:6144
  ds_read_b32 v41, v11 offset:6656
  ds_read_b32 v42, v11 offset:7168
  ds_read_b32 v43, v11 offset:7680
  ds_read_b32 v44, v11 offset:8192
  ds_read_b32 v45, v11 offset:8704
  ds_read_b32 v46, v11 offset:9216
  ds_read_b32 v47, v11 offset:9728
  s_waitcnt lgkmcnt(0)
  v_add_f32 v32, v32, v40
  v_add_f32 v33, v33, v41
  v_add_f32 v34, v34, v42
  v_add_f32 v35, v35, v43
  v_add_f32 v36, v36, v44
  v_add_f32 v37, v37, v45
  v_add_f32 v38, v38, v46
  v_add_f32 v39, v39, v47
  v_add_f32 v32, v32, v36
  v_add_f32 v33, v33, v37
  v_add_f32 v34, v34, v38
  v_add_f32 v35, v35, v39
  v_add_f32 v32, v32, v34
  v_add_f32 v33, v33, v35
  v_add_f32 v32, v32, v33
  v_lshrrev_b32 v12, 3, v0
  v_and_b32 v13, 3, v0
  v_bfe_u32 v14, v0, 2, 1
  v_lshl_add_u32 v12, v12, 2, v13
  s_lshl_b32 s33, s21, 6
  v_add_u32 v12, s33, v12
  s_movk_i32 s32, 4608
  v_mad_u32_u24 v12, v14, s32, v12
  s_mul_i32 s33, s20, 9216
  v_add_u32 v12, s33, v12
  v_lshlrev_b32 v12, 2, v12
  buffer_store_dword v32, v12, s[16:19], 0 offen offset:0
  s_endpgm
K1_stats:
  s_sub_u32 s20, s2, 216
  s_lshl_b32 s20, s20, 3
  s_cmp_ge_u32 s20, 2048
  s_cselect_b32 s24, s6, s4
  s_cselect_b32 s25, s7, s5
  s_mov_b32 s33, 3145728
  s_cselect_b32 s26, 98304, s33
  s_cselect_b32 s21, 2048, 0
  s_mov_b32 s27, 0x00020000
  s_sub_u32 s21, s20, s21
  v_lshl_add_u32 v3, v2, 1, s21
  s_movk_i32 s32, 1536
  v_mul_lo_u32 v4, v3, s32
  v_mul_u32_u24 v5, 24, v1
  v_add_u32 v4, v4, v5
  buffer_load_dwordx3 v[8:10], v4, s[24:27], 0 offen
  buffer_load_dwordx3 v[12:14], v4, s[24:27], 0 offen offset:12
  buffer_load_dwordx3 v[16:18], v4, s[24:27], 0 offen offset:1536
  buffer_load_dwordx3 v[20:22], v4, s[24:27], 0 offen offset:1548

  s_waitcnt vmcnt(2)
  v_lshlrev_b32 v32, 16, v8
  v_and_b32 v33, 0xffff0000, v8
  v_lshlrev_b32 v34, 16, v9
  v_and_b32 v35, 0xffff0000, v9
  v_lshlrev_b32 v36, 16, v10
  v_and_b32 v37, 0xffff0000, v10
  v_lshlrev_b32 v38, 16, v12
  v_and_b32 v39, 0xffff0000, v12
  v_lshlrev_b32 v40, 16, v13
  v_and_b32 v41, 0xffff0000, v13
  v_lshlrev_b32 v42, 16, v14
  v_and_b32 v43, 0xffff0000, v14
  v_add_f32 v24, v32, v33
  v_add_f32 v24, v24, v34
  v_add_f32 v24, v24, v35
  v_add_f32 v24, v24, v36
  v_add_f32 v24, v24, v37
  v_add_f32 v24, v24, v38
  v_add_f32 v24, v24, v39
  v_add_f32 v24, v24, v40
  v_add_f32 v24, v24, v41
  v_add_f32 v24, v24, v42
  v_add_f32 v24, v24, v43
  s_nop 1
  v_add_f32_dpp v24, v24, v24 quad_perm:[1,0,3,2] row_mask:0xf bank_mask:0xf
  s_nop 1
  v_add_f32_dpp v24, v24, v24 quad_perm:[2,3,0,1] row_mask:0xf bank_mask:0xf
  s_nop 1
  v_add_f32_dpp v24, v24, v24 row_half_mirror row_mask:0xf bank_mask:0xf
  s_nop 1
  v_add_f32_dpp v24, v24, v24 row_mirror row_mask:0xf bank_mask:0xf
  v_mov_b32 v28, v24
  s_nop 1
  v_permlane16_swap_b32 v24, v28
  s_nop 1
  v_add_f32 v24, v24, v28
  v_mov_b32 v28, v24
  s_nop 1
  v_permlane32_swap_b32 v24, v28
  s_nop 1
  v_add_f32 v24, v24, v28
  v_mul_f32 v24, 0x3aaaaaab, v24
  v_sub_f32 v32, v32, v24
  v_sub_f32 v33, v33, v24
  v_sub_f32 v34, v34, v24
  v_sub_f32 v35, v35, v24
  v_sub_f32 v36, v36, v24
  v_sub_f32 v37, v37, v24
  v_sub_f32 v38, v38, v24
  v_sub_f32 v39, v39, v24
  v_sub_f32 v40, v40, v24
  v_sub_f32 v41, v41, v24
  v_sub_f32 v42, v42, v24
  v_sub_f32 v43, v43, v24
  v_mul_f32 v25, v32, v32
  v_fmac_f32 v25, v33, v33
  v_fmac_f32 v25, v34, v34
  v_fmac_f32 v25, v35, v35
  v_fmac_f32 v25, v36, v36
  v_fmac_f32 v25, v37, v37
  v_fmac_f32 v25, v38, v38
  v_fmac_f32 v25, v39, v39
  v_fmac_f32 v25, v40, v40
  v_fmac_f32 v25, v41, v41
  v_fmac_f32 v25, v42, v42
  v_fmac_f32 v25, v43, v43
  s_nop 1
  v_add_f32_dpp v25, v25, v25 quad_perm:[1,0,3,2] row_mask:0xf bank_mask:0xf
  s_nop 1
  v_add_f32_dpp v25, v25, v25 quad_perm:[2,3,0,1] row_mask:0xf bank_mask:0xf
  s_nop 1
  v_add_f32_dpp v25, v25, v25 row_half_mirror row_mask:0xf bank_mask:0xf
  s_nop 1
  v_add_f32_dpp v25, v25, v25 row_mirror row_mask:0xf bank_mask:0xf
  v_mov_b32 v28, v25
  s_nop 1
  v_permlane16_swap_b32 v25, v28
  s_nop 1
  v_add_f32 v25, v25, v28
  v_mov_b32 v28, v25
  s_nop 1
  v_permlane32_swap_b32 v25, v28
  s_nop 1
  v_add_f32 v25, v25, v28
  v_mov_b32 v29, 0x3727c5ac
  v_fmac_f32 v29, 0x3aaaaaab, v25
  v_rsq_f32 v25, v29
  s_nop 0
  v_mul_f32 v24, v24, v25
  v_sub_f32 v24, 0, v24

  s_waitcnt vmcnt(0)
  v_lshlrev_b32 v48, 16, v16
  v_and_b32 v49, 0xffff0000, v16
  v_lshlrev_b32 v50, 16, v17
  v_and_b32 v51, 0xffff0000, v17
  v_lshlrev_b32 v52, 16, v18
  v_and_b32 v53, 0xffff0000, v18
  v_lshlrev_b32 v54, 16, v20
  v_and_b32 v55, 0xffff0000, v20
  v_lshlrev_b32 v56, 16, v21
  v_and_b32 v57, 0xffff0000, v21
  v_lshlrev_b32 v58, 16, v22
  v_and_b32 v59, 0xffff0000, v22
  v_add_f32 v26, v48, v49
  v_add_f32 v26, v26, v50
  v_add_f32 v26, v26, v51
  v_add_f32 v26, v26, v52
  v_add_f32 v26, v26, v53
  v_add_f32 v26, v26, v54
  v_add_f32 v26, v26, v55
  v_add_f32 v26, v26, v56
  v_add_f32 v26, v26, v57
  v_add_f32 v26, v26, v58
  v_add_f32 v26, v26, v59
  s_nop 1
  v_add_f32_dpp v26, v26, v26 quad_perm:[1,0,3,2] row_mask:0xf bank_mask:0xf
  s_nop 1
  v_add_f32_dpp v26, v26, v26 quad_perm:[2,3,0,1] row_mask:0xf bank_mask:0xf
  s_nop 1
  v_add_f32_dpp v26, v26, v26 row_half_mirror row_mask:0xf bank_mask:0xf
  s_nop 1
  v_add_f32_dpp v26, v26, v26 row_mirror row_mask:0xf bank_mask:0xf
  v_mov_b32 v28, v26
  s_nop 1
  v_permlane16_swap_b32 v26, v28
  s_nop 1
  v_add_f32 v26, v26, v28
  v_mov_b32 v28, v26
  s_nop 1
  v_permlane32_swap_b32 v26, v28
  s_nop 1
  v_add_f32 v26, v26, v28
  v_mul_f32 v26, 0x3aaaaaab, v26
  v_sub_f32 v48, v48, v26
  v_sub_f32 v49, v49, v26
  v_sub_f32 v50, v50, v26
  v_sub_f32 v51, v51, v26
  v_sub_f32 v52, v52, v26
  v_sub_f32 v53, v53, v26
  v_sub_f32 v54, v54, v26
  v_sub_f32 v55, v55, v26
  v_sub_f32 v56, v56, v26
  v_sub_f32 v57, v57, v26
  v_sub_f32 v58, v58, v26
  v_sub_f32 v59, v59, v26
  v_mul_f32 v27, v48, v48
  v_fmac_f32 v27, v49, v49
  v_fmac_f32 v27, v50, v50
  v_fmac_f32 v27, v51, v51
  v_fmac_f32 v27, v52, v52
  v_fmac_f32 v27, v53, v53
  v_fmac_f32 v27, v54, v54
  v_fmac_f32 v27, v55, v55
  v_fmac_f32 v27, v56, v56
  v_fmac_f32 v27, v57, v57
  v_fmac_f32 v27, v58, v58
  v_fmac_f32 v27, v59, v59
  s_nop 1
  v_add_f32_dpp v27, v27, v27 quad_perm:[1,0,3,2] row_mask:0xf bank_mask:0xf
  s_nop 1
  v_add_f32_dpp v27, v27, v27 quad_perm:[2,3,0,1] row_mask:0xf bank_mask:0xf
  s_nop 1
  v_add_f32_dpp v27, v27, v27 row_half_mirror row_mask:0xf bank_mask:0xf
  s_nop 1
  v_add_f32_dpp v27, v27, v27 row_mirror row_mask:0xf bank_mask:0xf
  v_mov_b32 v28, v27
  s_nop 1
  v_permlane16_swap_b32 v27, v28
  s_nop 1
  v_add_f32 v27, v27, v28
  v_mov_b32 v28, v27
  s_nop 1
  v_permlane32_swap_b32 v27, v28
  s_nop 1
  v_add_f32 v27, v27, v28
  v_mov_b32 v29, 0x3727c5ac
  v_fmac_f32 v29, 0x3aaaaaab, v27
  v_rsq_f32 v27, v29
  s_nop 0
  v_mul_f32 v26, v26, v27
  v_sub_f32 v26, 0, v26

  v_mul_u32_u24 v28, 12, v1
  v_lshlrev_b32 v29, 5, v2

  v_mul_f32 v32, v32, v25
  v_mul_f32 v33, v33, v25
  v_mul_f32 v34, v34, v25
  v_mul_f32 v35, v35, v25
  v_cvt_pk_bf16_f32 v64, v32, v33
  v_cvt_pk_bf16_f32 v65, v34, v35
  v_add_u32 v30, 0, v28
  v_lshrrev_b32 v31, 3, v30
  v_bfe_u32 v30, v30, 2, 1
  v_lshlrev_b32 v31, 7, v31
  v_lshl_add_u32 v31, v30, 3, v31
  v_add_u32 v31, v31, v29
  ds_write_b64 v31, v[64:65] offset:0

  v_mul_f32 v36, v36, v25
  v_mul_f32 v37, v37, v25
  v_mul_f32 v38, v38, v25
  v_mul_f32 v39, v39, v25
  v_cvt_pk_bf16_f32 v66, v36, v37
  v_cvt_pk_bf16_f32 v67, v38, v39
  v_add_u32 v30, 4, v28
  v_lshrrev_b32 v31, 3, v30
  v_bfe_u32 v30, v30, 2, 1
  v_lshlrev_b32 v31, 7, v31
  v_lshl_add_u32 v31, v30, 3, v31
  v_add_u32 v31, v31, v29
  ds_write_b64 v31, v[66:67] offset:0

  v_mul_f32 v40, v40, v25
  v_mul_f32 v41, v41, v25
  v_mul_f32 v42, v42, v25
  v_mul_f32 v43, v43, v25
  v_cvt_pk_bf16_f32 v68, v40, v41
  v_cvt_pk_bf16_f32 v69, v42, v43
  v_add_u32 v30, 8, v28
  v_lshrrev_b32 v31, 3, v30
  v_bfe_u32 v30, v30, 2, 1
  v_lshlrev_b32 v31, 7, v31
  v_lshl_add_u32 v31, v30, 3, v31
  v_add_u32 v31, v31, v29
  ds_write_b64 v31, v[68:69] offset:0

  v_mul_f32 v48, v48, v27
  v_mul_f32 v49, v49, v27
  v_mul_f32 v50, v50, v27
  v_mul_f32 v51, v51, v27
  v_cvt_pk_bf16_f32 v64, v48, v49
  v_cvt_pk_bf16_f32 v65, v50, v51
  v_add_u32 v30, 0, v28
  v_lshrrev_b32 v31, 3, v30
  v_bfe_u32 v30, v30, 2, 1
  v_lshlrev_b32 v31, 7, v31
  v_lshl_add_u32 v31, v30, 3, v31
  v_add_u32 v31, v31, v29
  ds_write_b64 v31, v[64:65] offset:16

  v_mul_f32 v52, v52, v27
  v_mul_f32 v53, v53, v27
  v_mul_f32 v54, v54, v27
  v_mul_f32 v55, v55, v27
  v_cvt_pk_bf16_f32 v66, v52, v53
  v_cvt_pk_bf16_f32 v67, v54, v55
  v_add_u32 v30, 4, v28
  v_lshrrev_b32 v31, 3, v30
  v_bfe_u32 v30, v30, 2, 1
  v_lshlrev_b32 v31, 7, v31
  v_lshl_add_u32 v31, v30, 3, v31
  v_add_u32 v31, v31, v29
  ds_write_b64 v31, v[66:67] offset:16

  v_mul_f32 v56, v56, v27
  v_mul_f32 v57, v57, v27
  v_mul_f32 v58, v58, v27
  v_mul_f32 v59, v59, v27
  v_cvt_pk_bf16_f32 v68, v56, v57
  v_cvt_pk_bf16_f32 v69, v58, v59
  v_add_u32 v30, 8, v28
  v_lshrrev_b32 v31, 3, v30
  v_bfe_u32 v30, v30, 2, 1
  v_lshlrev_b32 v31, 7, v31
  v_lshl_add_u32 v31, v30, 3, v31
  v_add_u32 v31, v31, v29
  ds_write_b64 v31, v[68:69] offset:16

  s_waitcnt lgkmcnt(0)
  s_barrier
  v_lshlrev_b32 v3, 4, v0
  ds_read_b128 v[8:11], v3
  ds_read_b128 v[12:15], v3 offset:4096
  ds_read_b128 v[16:19], v3 offset:8192
  s_lshr_b32 s22, s20, 5
  s_mul_i32 s22, s22, 49152
  s_and_b32 s23, s20, 31
  s_lshl_b32 s23, s23, 4
  s_add_u32 s22, s22, s23
  s_add_u32 s22, s22, 12582912
  v_lshrrev_b32 v4, 4, v0
  v_bfe_u32 v5, v0, 3, 1
  v_and_b32 v6, 7, v0
  v_lshlrev_b32 v4, 10, v4
  v_lshl_add_u32 v4, v5, 9, v4
  v_lshl_add_u32 v4, v6, 4, v4
  s_waitcnt lgkmcnt(0)
  buffer_store_dwordx4 v[8:11], v4, s[16:19], s22 offen
  s_add_u32 s22, s22, 16384
  buffer_store_dwordx4 v[12:15], v4, s[16:19], s22 offen
  s_add_u32 s22, s22, 16384
  buffer_store_dwordx4 v[16:19], v4, s[16:19], s22 offen
K1_end:
  s_endpgm

k1_kernel_END:
.globl k2_kernel
.p2align 8
.type k2_kernel,@function
k2_kernel:
  s_cmp_ge_u32 s2, 256
  s_cbranch_scc1 K2_end
  s_load_dwordx4 s[8:11], s[0:1], 24
  s_load_dwordx2 s[12:13], s[0:1], 88
  s_load_dwordx2 s[36:37], s[0:1], 40
  v_and_b32 v165, 63, v0
  v_lshrrev_b32 v166, 6, v0
  v_mov_b32 v167, v0
  s_nop 0
  v_readfirstlane_b32 s40, v166
  s_and_b32 s3, s2, 7
  s_lshr_b32 s14, s2, 3
  s_lshr_b32 s15, s3, 1
  s_and_b32 s3, s3, 1
  s_and_b32 s41, s40, 1
  s_lshr_b32 s42, s40, 1
  s_lshr_b32 s43, s14, 2
  s_lshl_b32 s3, s3, 3
  s_add_u32 s43, s43, s3
  s_and_b32 s44, s14, 3
  s_lshl_b32 s15, s15, 2
  s_add_u32 s44, s44, s15
  s_mov_b32 s45, 0
  s_cmp_eq_u32 s43, 15
  s_cbranch_scc0 K2_dec
  s_mov_b32 s45, 1
  s_mov_b32 s43, s44
  s_cmp_eq_u32 s43, 15
  s_cbranch_scc1 K2_end
K2_dec:
  s_mul_i32 s46, s43, 160
  s_cmp_ge_u32 s43, 4
  s_cselect_b32 s47, 32, 0
  s_sub_u32 s46, s46, s47
  s_cmp_ge_u32 s43, 9
  s_cselect_b32 s47, 32, 0
  s_sub_u32 s46, s46, s47
  s_cmp_ge_u32 s43, 14
  s_cselect_b32 s47, 32, 0
  s_sub_u32 s46, s46, s47
  s_lshl_b32 s55, s46, 1
  s_mul_i32 s54, s40, 320
  s_mul_i32 s56, s40, 5120

  v_add_u32 v168, s54, v165
  v_add_u32 v168, 0, v168
  v_mul_u32_u24 v169, 3277, v168
  v_lshrrev_b32 v169, 16, v169
  v_mul_u32_u24 v170, 20, v169
  v_sub_u32 v170, v168, v170
  v_mul_u32_u24 v169, 4608, v169
  v_lshl_add_u32 v169, v170, 4, v169
  v_add_u32 v156, s55, v169

  v_add_u32 v168, s54, v165
  v_add_u32 v168, 64, v168
  v_mul_u32_u24 v169, 3277, v168
  v_lshrrev_b32 v169, 16, v169
  v_mul_u32_u24 v170, 20, v169
  v_sub_u32 v170, v168, v170
  v_mul_u32_u24 v169, 4608, v169
  v_lshl_add_u32 v169, v170, 4, v169
  v_add_u32 v157, s55, v169

  v_add_u32 v168, s54, v165
  v_add_u32 v168, 128, v168
  v_mul_u32_u24 v169, 3277, v168
  v_lshrrev_b32 v169, 16, v169
  v_mul_u32_u24 v170, 20, v169
  v_sub_u32 v170, v168, v170
  v_mul_u32_u24 v169, 4608, v169
  v_lshl_add_u32 v169, v170, 4, v169
  v_add_u32 v158, s55, v169

  v_add_u32 v168, s54, v165
  v_add_u32 v168, 192, v168
  v_mul_u32_u24 v169, 3277, v168
  v_lshrrev_b32 v169, 16, v169
  v_mul_u32_u24 v170, 20, v169
  v_sub_u32 v170, v168, v170
  v_mul_u32_u24 v169, 4608, v169
  v_lshl_add_u32 v169, v170, 4, v169
  v_add_u32 v159, s55, v169

  v_add_u32 v168, s54, v165
  v_add_u32 v168, 256, v168
  v_mul_u32_u24 v169, 3277, v168
  v_lshrrev_b32 v169, 16, v169
  v_mul_u32_u24 v170, 20, v169
  v_sub_u32 v170, v168, v170
  v_mul_u32_u24 v169, 4608, v169
  v_lshl_add_u32 v169, v170, 4, v169
  v_add_u32 v160, s55, v169

  v_lshlrev_b32 v161, 4, v165
  v_mov_b32 v175, 0xffff0000
  s_waitcnt lgkmcnt(0)

  s_mov_b32 s24, s12
  s_mov_b32 s25, s13
  s_mov_b32 s26, 1048576
  s_mov_b32 s27, 0x00020000
  s_add_u32 s28, s12, 1048576
  s_addc_u32 s29, s13, 0
  s_mov_b32 s30, 9732096
  s_mov_b32 s31, 0x00020000
  s_add_u32 s16, s12, 12582912
  s_addc_u32 s17, s13, 0
  s_mov_b32 s18, 3244032
  s_mov_b32 s19, 0x00020000
  s_cmp_eq_u32 s45, 1
  s_cselect_b32 s20, s10, s8
  s_cselect_b32 s21, s11, s9
  s_mov_b32 s22, 3538944
  s_mov_b32 s23, 0x00020000
  s_cbranch_scc1 K2_txt
  s_lshl_b32 s48, s44, 2
  s_lshl_b32 s47, s41, 1
  s_add_u32 s48, s48, s47
  s_lshr_b32 s50, s44, 3
  s_add_u32 s51, s48, s42
  s_add_u32 s51, s51, s50
  s_lshl_b32 s51, s51, 5
  s_mov_b32 s52, 1
  s_mov_b32 s53, 0
  s_branch K2_dec2
K2_txt:
  s_add_u32 s48, s41, 64
  s_mov_b32 s50, s41
  s_mul_i32 s51, s50, 1056
  s_add_u32 s51, s51, 1024
  s_cmp_eq_u32 s42, 0
  s_cselect_b32 s52, 1, 0
  s_movk_i32 s53, 2304
K2_dec2:
  s_add_u32 s63, s48, s42
  s_mul_i32 s63, s63, 48
  s_lshl_b32 s64, s42, 1
  s_add_u32 s63, s63, s64
  s_lshl_b32 s63, s63, 10
  s_xor_b32 s62, s42, 1
  s_add_u32 s62, s62, s48
  s_mul_i32 s62, s62, 48
  s_add_u32 s62, s62, s64
  s_lshl_b32 s62, s62, 10

  s_mov_b32 s38, 0
  s_add_u32 m0, s56, 0
  s_nop 0
  buffer_load_dwordx4 v156, s[20:23], s38 offen lds
  s_add_u32 m0, s56, 1024
  s_nop 0
  buffer_load_dwordx4 v157, s[20:23], s38 offen lds
  s_add_u32 m0, s56, 2048
  s_nop 0
  buffer_load_dwordx4 v158, s[20:23], s38 offen lds
  s_add_u32 m0, s56, 3072
  s_nop 0
  buffer_load_dwordx4 v159, s[20:23], s38 offen lds
  s_add_u32 m0, s56, 4096
  s_nop 0
  buffer_load_dwordx4 v160, s[20:23], s38 offen lds
  s_add_u32 s64, s63, 0
  s_add_u32 s65, s62, 0
  buffer_load_dwordx4 v[40:43], v161, s[16:19], s64 offen
  buffer_load_dwordx4 v[44:47], v161, s[16:19], s65 offen
  buffer_load_dwordx4 v[48:51], v161, s[16:19], s64 offen offset:1024
  buffer_load_dwordx4 v[52:55], v161, s[16:19], s65 offen offset:1024
  v_lshrrev_b32 v168, 7, v167
  v_and_b32 v169, 127, v167
  v_mul_u32_u24 v169, 12, v169
  v_mul_u32_u24 v170, 4608, v168
  v_add_u32 v170, v170, v169
  v_add_u32 v170, s53, v170
  v_lshlrev_b32 v170, 2, v170
  s_mov_b32 s64, 36864
  s_mov_b32 s65, 73728

  buffer_load_dwordx4 v[120:123], v170, s[24:27], 0 offen offset:0
  buffer_load_dwordx4 v[124:127], v170, s[24:27], 0 offen offset:16
  buffer_load_dwordx4 v[128:131], v170, s[24:27], 0 offen offset:32
  buffer_load_dwordx4 v[132:135], v170, s[24:27], s64 offen offset:0
  buffer_load_dwordx4 v[136:139], v170, s[24:27], s64 offen offset:16
  buffer_load_dwordx4 v[140:143], v170, s[24:27], s64 offen offset:32
  buffer_load_dwordx4 v[144:147], v170, s[24:27], s65 offen offset:0
  buffer_load_dwordx4 v[148:151], v170, s[24:27], s65 offen offset:16
  buffer_load_dwordx4 v[152:155], v170, s[24:27], s65 offen offset:32
  s_mov_b32 s38, 294912
  s_add_u32 m0, s56, 20480
  s_nop 0
  buffer_load_dwordx4 v156, s[20:23], s38 offen lds
  s_add_u32 m0, s56, 21504
  s_nop 0
  buffer_load_dwordx4 v157, s[20:23], s38 offen lds
  s_add_u32 m0, s56, 22528
  s_nop 0
  buffer_load_dwordx4 v158, s[20:23], s38 offen lds
  s_add_u32 m0, s56, 23552
  s_nop 0
  buffer_load_dwordx4 v159, s[20:23], s38 offen lds
  s_add_u32 m0, s56, 24576
  s_nop 0
  buffer_load_dwordx4 v160, s[20:23], s38 offen lds
  s_add_u32 s64, s63, 4096
  s_add_u32 s65, s62, 4096
  buffer_load_dwordx4 v[56:59], v161, s[16:19], s64 offen
  buffer_load_dwordx4 v[60:63], v161, s[16:19], s65 offen
  buffer_load_dwordx4 v[64:67], v161, s[16:19], s64 offen offset:1024
  buffer_load_dwordx4 v[68:71], v161, s[16:19], s65 offen offset:1024
  v_bfe_u32 v170, v165, 2, 2
  v_lshrrev_b32 v171, 5, v165
  v_lshl_add_u32 v170, v171, 3, v170
  s_lshl_b32 s64, s42, 5
  v_add_u32 v170, s64, v170
  v_mul_u32_u24 v162, 320, v170
  v_bfe_u32 v170, v165, 4, 1
  v_lshl_add_u32 v162, v170, 5, v162
  v_and_b32 v170, 3, v165
  v_lshl_add_u32 v162, v170, 3, v162
  v_add_u32 v163, 40960, v162
  s_mul_i32 s64, s50, 6144
  s_lshl_b32 s65, s42, 7
  s_add_u32 s64, s64, s65
  s_add_u32 s64, s64, 81920
  v_lshlrev_b32 v164, 5, v171
  v_add_u32 v164, s64, v164

  s_waitcnt vmcnt(9)
  v_add_f32 v120, v120, v132
  v_add_f32 v120, v120, v144
  v_add_f32 v121, v121, v133
  v_add_f32 v121, v121, v145
  v_add_f32 v122, v122, v134
  v_add_f32 v122, v122, v146
  v_add_f32 v123, v123, v135
  v_add_f32 v123, v123, v147
  v_add_f32 v124, v124, v136
  v_add_f32 v124, v124, v148
  v_add_f32 v125, v125, v137
  v_add_f32 v125, v125, v149
  v_add_f32 v126, v126, v138
  v_add_f32 v126, v126, v150
  v_add_f32 v127, v127, v139
  v_add_f32 v127, v127, v151
  v_add_f32 v128, v128, v140
  v_add_f32 v128, v128, v152
  v_add_f32 v129, v129, v141
  v_add_f32 v129, v129, v153
  v_add_f32 v130, v130, v142
  v_add_f32 v130, v130, v154
  v_add_f32 v131, v131, v143
  v_add_f32 v131, v131, v155
  v_cvt_pk_bf16_f32 v132, v120, v121
  v_lshlrev_b32 v120, 16, v132
  v_and_b32 v121, 0xffff0000, v132
  v_cvt_pk_bf16_f32 v132, v122, v123
  v_lshlrev_b32 v122, 16, v132
  v_and_b32 v123, 0xffff0000, v132
  v_cvt_pk_bf16_f32 v132, v124, v125
  v_lshlrev_b32 v124, 16, v132
  v_and_b32 v125, 0xffff0000, v132
  v_cvt_pk_bf16_f32 v132, v126, v127
  v_lshlrev_b32 v126, 16, v132
  v_and_b32 v127, 0xffff0000, v132
  v_cvt_pk_bf16_f32 v132, v128, v129
  v_lshlrev_b32 v128, 16, v132
  v_and_b32 v129, 0xffff0000, v132
  v_cvt_pk_bf16_f32 v132, v130, v131
  v_lshlrev_b32 v130, 16, v132
  v_and_b32 v131, 0xffff0000, v132
  s_and_b32 s64, s40, 1
  s_cmp_eq_u32 s64, 0
  s_cbranch_scc1 K2_nosc

  v_add_f32 v120, 1.0, v120
  v_add_f32 v121, 1.0, v121
  v_cvt_pk_bf16_f32 v132, v120, v121
  v_lshlrev_b32 v120, 16, v132
  v_and_b32 v121, 0xffff0000, v132
  v_add_f32 v122, 1.0, v122
  v_add_f32 v123, 1.0, v123
  v_cvt_pk_bf16_f32 v132, v122, v123
  v_lshlrev_b32 v122, 16, v132
  v_and_b32 v123, 0xffff0000, v132
  v_add_f32 v124, 1.0, v124
  v_add_f32 v125, 1.0, v125
  v_cvt_pk_bf16_f32 v132, v124, v125
  v_lshlrev_b32 v124, 16, v132
  v_and_b32 v125, 0xffff0000, v132
  v_add_f32 v126, 1.0, v126
  v_add_f32 v127, 1.0, v127
  v_cvt_pk_bf16_f32 v132, v126, v127
  v_lshlrev_b32 v126, 16, v132
  v_and_b32 v127, 0xffff0000, v132
  v_add_f32 v128, 1.0, v128
  v_add_f32 v129, 1.0, v129
  v_cvt_pk_bf16_f32 v132, v128, v129
  v_lshlrev_b32 v128, 16, v132
  v_and_b32 v129, 0xffff0000, v132
  v_add_f32 v130, 1.0, v130
  v_add_f32 v131, 1.0, v131
  v_cvt_pk_bf16_f32 v132, v130, v131
  v_lshlrev_b32 v130, 16, v132
  v_and_b32 v131, 0xffff0000, v132
K2_nosc:
  v_mul_u32_u24 v170, 1536, v168
  v_add_u32 v170, v170, v169
  v_lshlrev_b32 v170, 2, v170
  v_add_u32 v170, 81920, v170
  ds_write_b128 v170, v[120:123]
  ds_write_b128 v170, v[124:127] offset:16
  ds_write_b128 v170, v[128:131] offset:32

  s_mov_b32 s38, 589824
  s_add_u32 m0, s56, 40960
  s_nop 0
  buffer_load_dwordx4 v156, s[20:23], s38 offen lds
  s_add_u32 m0, s56, 41984
  s_nop 0
  buffer_load_dwordx4 v157, s[20:23], s38 offen lds
  s_add_u32 m0, s56, 43008
  s_nop 0
  buffer_load_dwordx4 v158, s[20:23], s38 offen lds
  s_add_u32 m0, s56, 44032
  s_nop 0
  buffer_load_dwordx4 v159, s[20:23], s38 offen lds
  s_add_u32 m0, s56, 45056
  s_nop 0
  buffer_load_dwordx4 v160, s[20:23], s38 offen lds
  s_add_u32 s64, s63, 8192
  s_add_u32 s65, s62, 8192
  buffer_load_dwordx4 v[72:75], v161, s[16:19], s64 offen
  buffer_load_dwordx4 v[76:79], v161, s[16:19], s65 offen
  buffer_load_dwordx4 v[80:83], v161, s[16:19], s64 offen offset:1024
  buffer_load_dwordx4 v[84:87], v161, s[16:19], s65 offen offset:1024
  s_waitcnt lgkmcnt(0)
  s_waitcnt vmcnt(27)
  s_barrier
  ds_read_b128 v[124:127], v164 offset:0
  ds_read_b128 v[128:131], v164 offset:16
  ds_read_b128 v[132:135], v164 offset:3072
  ds_read_b128 v[136:139], v164 offset:3088
  ds_read_b64_tr_b16 v[0:1], v162 offset:0
  ds_read_b64_tr_b16 v[2:3], v162 offset:1280
  ds_read_b64_tr_b16 v[4:5], v162 offset:64
  ds_read_b64_tr_b16 v[6:7], v162 offset:1344
  ds_read_b64_tr_b16 v[8:9], v162 offset:128
  ds_read_b64_tr_b16 v[10:11], v162 offset:1408
  ds_read_b64_tr_b16 v[12:13], v162 offset:192
  ds_read_b64_tr_b16 v[14:15], v162 offset:1472
  ds_read_b64_tr_b16 v[16:17], v162 offset:256
  ds_read_b64_tr_b16 v[18:19], v162 offset:1536
  ds_read_b128 v[140:143], v164 offset:64
  ds_read_b128 v[144:147], v164 offset:80
  ds_read_b128 v[148:151], v164 offset:3136
  ds_read_b128 v[152:155], v164 offset:3152
  s_waitcnt lgkmcnt(14)
  v_lshlrev_b32 v120, 16, v40
  v_and_b32 v121, v175, v40
  v_fma_f32 v120, v120, v132, v124
  v_fma_f32 v121, v121, v133, v125
  v_cvt_pk_bf16_f32 v104, v120, v121
  v_lshlrev_b32 v122, 16, v41
  v_and_b32 v123, v175, v41
  v_fma_f32 v122, v122, v134, v126
  v_fma_f32 v123, v123, v135, v127
  v_cvt_pk_bf16_f32 v105, v122, v123
  v_lshlrev_b32 v120, 16, v42
  v_and_b32 v121, v175, v42
  v_fma_f32 v120, v120, v136, v128
  v_fma_f32 v121, v121, v137, v129
  v_cvt_pk_bf16_f32 v106, v120, v121
  v_lshlrev_b32 v122, 16, v43
  v_and_b32 v123, v175, v43
  v_fma_f32 v122, v122, v138, v130
  v_fma_f32 v123, v123, v139, v131
  v_cvt_pk_bf16_f32 v107, v122, v123
  v_lshlrev_b32 v120, 16, v44
  v_and_b32 v121, v175, v44
  v_fmac_f32 v124, v120, v132
  v_fmac_f32 v125, v121, v133
  v_cvt_pk_bf16_f32 v108, v124, v125
  v_lshlrev_b32 v122, 16, v45
  v_and_b32 v123, v175, v45
  v_fmac_f32 v126, v122, v134
  v_fmac_f32 v127, v123, v135
  v_cvt_pk_bf16_f32 v109, v126, v127
  v_lshlrev_b32 v120, 16, v46
  v_and_b32 v121, v175, v46
  v_fmac_f32 v128, v120, v136
  v_fmac_f32 v129, v121, v137
  v_cvt_pk_bf16_f32 v110, v128, v129
  v_lshlrev_b32 v122, 16, v47
  v_and_b32 v123, v175, v47
  v_fmac_f32 v130, v122, v138
  v_fmac_f32 v131, v123, v139
  v_cvt_pk_bf16_f32 v111, v130, v131
  ds_read_b64_tr_b16 v[20:21], v162 offset:5120
  ds_read_b64_tr_b16 v[22:23], v162 offset:6400
  ds_read_b64_tr_b16 v[24:25], v162 offset:5184
  ds_read_b64_tr_b16 v[26:27], v162 offset:6464
  ds_read_b64_tr_b16 v[28:29], v162 offset:5248
  ds_read_b64_tr_b16 v[30:31], v162 offset:6528
  ds_read_b64_tr_b16 v[32:33], v162 offset:5312
  ds_read_b64_tr_b16 v[34:35], v162 offset:6592
  ds_read_b64_tr_b16 v[36:37], v162 offset:5376
  ds_read_b64_tr_b16 v[38:39], v162 offset:6656
  s_waitcnt lgkmcnt(10)
  v_mfma_f32_32x32x16_bf16 v[176:191], v[0:3], v[104:107], 0
  s_waitcnt vmcnt(9)
  s_barrier
  s_mov_b32 s38, 884736
  v_lshlrev_b32 v120, 16, v48
  v_and_b32 v121, v175, v48
  s_add_u32 m0, s56, 61440
  v_mfma_f32_32x32x16_bf16 v[192:207], v[4:7], v[104:107], 0
  v_fma_f32 v120, v120, v148, v140
  v_fma_f32 v121, v121, v149, v141
  s_nop 0
  v_cvt_pk_bf16_f32 v112, v120, v121
  v_lshlrev_b32 v122, 16, v49
  buffer_load_dwordx4 v156, s[20:23], s38 offen lds
  v_mfma_f32_32x32x16_bf16 v[208:223], v[8:11], v[104:107], 0
  v_and_b32 v123, v175, v49
  v_fma_f32 v122, v122, v150, v142
  s_add_u32 m0, s56, 62464
  v_fma_f32 v123, v123, v151, v143
  v_cvt_pk_bf16_f32 v113, v122, v123
  s_nop 0
  v_lshlrev_b32 v120, 16, v50
  v_mfma_f32_32x32x16_bf16 v[224:239], v[12:15], v[104:107], 0
  buffer_load_dwordx4 v157, s[20:23], s38 offen lds
  v_and_b32 v121, v175, v50
  v_fma_f32 v120, v120, v152, v144
  s_add_u32 m0, s56, 63488
  v_fma_f32 v121, v121, v153, v145
  v_cvt_pk_bf16_f32 v114, v120, v121
  v_mfma_f32_32x32x16_bf16 v[240:255], v[16:19], v[104:107], 0
  s_nop 0
  v_lshlrev_b32 v122, 16, v51
  v_and_b32 v123, v175, v51
  buffer_load_dwordx4 v158, s[20:23], s38 offen lds
  v_fma_f32 v122, v122, v154, v146
  v_fma_f32 v123, v123, v155, v147
  s_add_u32 m0, s56, 64512
  v_mfma_f32_32x32x16_bf16 a[0:15], v[0:3], v[108:111], 0
  v_cvt_pk_bf16_f32 v115, v122, v123
  s_nop 0
  v_lshlrev_b32 v120, 16, v52
  v_and_b32 v121, v175, v52
  buffer_load_dwordx4 v159, s[20:23], s38 offen lds
  v_fmac_f32 v140, v120, v148
  v_mfma_f32_32x32x16_bf16 a[16:31], v[4:7], v[108:111], 0
  v_fmac_f32 v141, v121, v149
  s_add_u32 m0, s56, 65536
  v_cvt_pk_bf16_f32 v116, v140, v141
  v_lshlrev_b32 v122, 16, v53
  s_nop 0
  v_and_b32 v123, v175, v53
  v_mfma_f32_32x32x16_bf16 a[32:47], v[8:11], v[108:111], 0
  v_fmac_f32 v142, v122, v150
  buffer_load_dwordx4 v160, s[20:23], s38 offen lds
  v_fmac_f32 v143, v123, v151
  v_cvt_pk_bf16_f32 v117, v142, v143
  s_add_u32 s64, s63, 12288
  v_lshlrev_b32 v120, 16, v54
  s_add_u32 s65, s62, 12288
  v_mfma_f32_32x32x16_bf16 a[48:63], v[12:15], v[108:111], 0
  v_and_b32 v121, v175, v54
  v_fmac_f32 v144, v120, v152
  buffer_load_dwordx4 v[88:91], v161, s[16:19], s64 offen
  v_fmac_f32 v145, v121, v153
  v_cvt_pk_bf16_f32 v118, v144, v145
  buffer_load_dwordx4 v[92:95], v161, s[16:19], s65 offen
  v_mfma_f32_32x32x16_bf16 a[64:79], v[16:19], v[108:111], 0
  v_lshlrev_b32 v122, 16, v55
  v_and_b32 v123, v175, v55
  buffer_load_dwordx4 v[96:99], v161, s[16:19], s64 offen offset:1024
  v_fmac_f32 v146, v122, v154
  v_fmac_f32 v147, v123, v155
  buffer_load_dwordx4 v[100:103], v161, s[16:19], s65 offen offset:1024
  v_cvt_pk_bf16_f32 v119, v146, v147
  s_waitcnt lgkmcnt(0)
  v_mfma_f32_32x32x16_bf16 v[176:191], v[20:23], v[112:115], v[176:191]
  ds_read_b128 v[124:127], v164 offset:256
  ds_read_b128 v[128:131], v164 offset:272
  ds_read_b128 v[132:135], v164 offset:3328
  ds_read_b128 v[136:139], v164 offset:3344
  ds_read_b64_tr_b16 v[0:1], v162 offset:20480
  v_mfma_f32_32x32x16_bf16 v[192:207], v[24:27], v[112:115], v[192:207]
  ds_read_b64_tr_b16 v[2:3], v162 offset:21760
  ds_read_b64_tr_b16 v[4:5], v162 offset:20544
  ds_read_b64_tr_b16 v[6:7], v162 offset:21824
  ds_read_b64_tr_b16 v[8:9], v162 offset:20608
  ds_read_b64_tr_b16 v[10:11], v162 offset:21888
  ds_read_b64_tr_b16 v[12:13], v162 offset:20672
  v_mfma_f32_32x32x16_bf16 v[208:223], v[28:31], v[112:115], v[208:223]
  ds_read_b64_tr_b16 v[14:15], v162 offset:21952
  ds_read_b64_tr_b16 v[16:17], v162 offset:20736
  ds_read_b64_tr_b16 v[18:19], v162 offset:22016
  s_waitcnt lgkmcnt(10)
  v_lshlrev_b32 v120, 16, v56
  v_and_b32 v121, v175, v56
  v_mfma_f32_32x32x16_bf16 v[224:239], v[32:35], v[112:115], v[224:239]
  v_fma_f32 v120, v120, v132, v124
  v_fma_f32 v121, v121, v133, v125
  v_cvt_pk_bf16_f32 v104, v120, v121
  v_lshlrev_b32 v122, 16, v57
  v_and_b32 v123, v175, v57
  v_fma_f32 v122, v122, v134, v126
  v_mfma_f32_32x32x16_bf16 v[240:255], v[36:39], v[112:115], v[240:255]
  v_fma_f32 v123, v123, v135, v127
  v_cvt_pk_bf16_f32 v105, v122, v123
  v_lshlrev_b32 v120, 16, v58
  v_and_b32 v121, v175, v58
  v_fma_f32 v120, v120, v136, v128
  v_fma_f32 v121, v121, v137, v129
  v_mfma_f32_32x32x16_bf16 a[0:15], v[20:23], v[116:119], a[0:15]
  v_cvt_pk_bf16_f32 v106, v120, v121
  v_lshlrev_b32 v122, 16, v59
  v_and_b32 v123, v175, v59
  v_fma_f32 v122, v122, v138, v130
  v_fma_f32 v123, v123, v139, v131
  v_cvt_pk_bf16_f32 v107, v122, v123
  v_mfma_f32_32x32x16_bf16 a[16:31], v[24:27], v[116:119], a[16:31]
  v_lshlrev_b32 v120, 16, v60
  v_and_b32 v121, v175, v60
  v_fmac_f32 v124, v120, v132
  v_fmac_f32 v125, v121, v133
  v_cvt_pk_bf16_f32 v108, v124, v125
  v_lshlrev_b32 v122, 16, v61
  v_mfma_f32_32x32x16_bf16 a[32:47], v[28:31], v[116:119], a[32:47]
  v_and_b32 v123, v175, v61
  v_fmac_f32 v126, v122, v134
  v_fmac_f32 v127, v123, v135
  v_cvt_pk_bf16_f32 v109, v126, v127
  v_lshlrev_b32 v120, 16, v62
  v_and_b32 v121, v175, v62
  v_mfma_f32_32x32x16_bf16 a[48:63], v[32:35], v[116:119], a[48:63]
  v_fmac_f32 v128, v120, v136
  v_fmac_f32 v129, v121, v137
  v_cvt_pk_bf16_f32 v110, v128, v129
  v_lshlrev_b32 v122, 16, v63
  v_and_b32 v123, v175, v63
  v_fmac_f32 v130, v122, v138
  v_mfma_f32_32x32x16_bf16 a[64:79], v[36:39], v[116:119], a[64:79]
  v_fmac_f32 v131, v123, v139
  v_cvt_pk_bf16_f32 v111, v130, v131
  ds_read_b128 v[140:143], v164 offset:320
  ds_read_b128 v[144:147], v164 offset:336
  ds_read_b128 v[148:151], v164 offset:3392
  ds_read_b128 v[152:155], v164 offset:3408
  ds_read_b64_tr_b16 v[20:21], v162 offset:25600
  ds_read_b64_tr_b16 v[22:23], v162 offset:26880
  ds_read_b64_tr_b16 v[24:25], v162 offset:25664
  ds_read_b64_tr_b16 v[26:27], v162 offset:26944
  ds_read_b64_tr_b16 v[28:29], v162 offset:25728
  ds_read_b64_tr_b16 v[30:31], v162 offset:27008
  ds_read_b64_tr_b16 v[32:33], v162 offset:25792
  ds_read_b64_tr_b16 v[34:35], v162 offset:27072
  ds_read_b64_tr_b16 v[36:37], v162 offset:25856
  ds_read_b64_tr_b16 v[38:39], v162 offset:27136
  s_waitcnt lgkmcnt(10)
  v_mfma_f32_32x32x16_bf16 v[176:191], v[0:3], v[104:107], v[176:191]
  s_waitcnt vmcnt(9)
  s_barrier
  s_mov_b32 s38, 1179648
  v_lshlrev_b32 v120, 16, v64
  v_and_b32 v121, v175, v64
  s_add_u32 m0, s56, 0
  v_mfma_f32_32x32x16_bf16 v[192:207], v[4:7], v[104:107], v[192:207]
  v_fma_f32 v120, v120, v148, v140
  v_fma_f32 v121, v121, v149, v141
  s_nop 0
  v_cvt_pk_bf16_f32 v112, v120, v121
  v_lshlrev_b32 v122, 16, v65
  buffer_load_dwordx4 v156, s[20:23], s38 offen lds
  v_mfma_f32_32x32x16_bf16 v[208:223], v[8:11], v[104:107], v[208:223]
  v_and_b32 v123, v175, v65
  v_fma_f32 v122, v122, v150, v142
  s_add_u32 m0, s56, 1024
  v_fma_f32 v123, v123, v151, v143
  v_cvt_pk_bf16_f32 v113, v122, v123
  s_nop 0
  v_lshlrev_b32 v120, 16, v66
  v_mfma_f32_32x32x16_bf16 v[224:239], v[12:15], v[104:107], v[224:239]
  buffer_load_dwordx4 v157, s[20:23], s38 offen lds
  v_and_b32 v121, v175, v66
  v_fma_f32 v120, v120, v152, v144
  s_add_u32 m0, s56, 2048
  v_fma_f32 v121, v121, v153, v145
  v_cvt_pk_bf16_f32 v114, v120, v121
  v_mfma_f32_32x32x16_bf16 v[240:255], v[16:19], v[104:107], v[240:255]
  s_nop 0
  v_lshlrev_b32 v122, 16, v67
  v_and_b32 v123, v175, v67
  buffer_load_dwordx4 v158, s[20:23], s38 offen lds
  v_fma_f32 v122, v122, v154, v146
  v_fma_f32 v123, v123, v155, v147
  s_add_u32 m0, s56, 3072
  v_mfma_f32_32x32x16_bf16 a[0:15], v[0:3], v[108:111], a[0:15]
  v_cvt_pk_bf16_f32 v115, v122, v123
  s_nop 0
  v_lshlrev_b32 v120, 16, v68
  v_and_b32 v121, v175, v68
  buffer_load_dwordx4 v159, s[20:23], s38 offen lds
  v_fmac_f32 v140, v120, v148
  v_mfma_f32_32x32x16_bf16 a[16:31], v[4:7], v[108:111], a[16:31]
  v_fmac_f32 v141, v121, v149
  s_add_u32 m0, s56, 4096
  v_cvt_pk_bf16_f32 v116, v140, v141
  v_lshlrev_b32 v122, 16, v69
  s_nop 0
  v_and_b32 v123, v175, v69
  v_mfma_f32_32x32x16_bf16 a[32:47], v[8:11], v[108:111], a[32:47]
  v_fmac_f32 v142, v122, v150
  buffer_load_dwordx4 v160, s[20:23], s38 offen lds
  v_fmac_f32 v143, v123, v151
  v_cvt_pk_bf16_f32 v117, v142, v143
  s_add_u32 s64, s63, 16384
  v_lshlrev_b32 v120, 16, v70
  s_add_u32 s65, s62, 16384
  v_mfma_f32_32x32x16_bf16 a[48:63], v[12:15], v[108:111], a[48:63]
  v_and_b32 v121, v175, v70
  v_fmac_f32 v144, v120, v152
  buffer_load_dwordx4 v[40:43], v161, s[16:19], s64 offen
  v_fmac_f32 v145, v121, v153
  v_cvt_pk_bf16_f32 v118, v144, v145
  buffer_load_dwordx4 v[44:47], v161, s[16:19], s65 offen
  v_mfma_f32_32x32x16_bf16 a[64:79], v[16:19], v[108:111], a[64:79]
  v_lshlrev_b32 v122, 16, v71
  v_and_b32 v123, v175, v71
  buffer_load_dwordx4 v[48:51], v161, s[16:19], s64 offen offset:1024
  v_fmac_f32 v146, v122, v154
  v_fmac_f32 v147, v123, v155
  buffer_load_dwordx4 v[52:55], v161, s[16:19], s65 offen offset:1024
  v_cvt_pk_bf16_f32 v119, v146, v147
  s_waitcnt lgkmcnt(0)
  v_mfma_f32_32x32x16_bf16 v[176:191], v[20:23], v[112:115], v[176:191]
  ds_read_b128 v[124:127], v164 offset:512
  ds_read_b128 v[128:131], v164 offset:528
  ds_read_b128 v[132:135], v164 offset:3584
  ds_read_b128 v[136:139], v164 offset:3600
  ds_read_b64_tr_b16 v[0:1], v163 offset:0
  v_mfma_f32_32x32x16_bf16 v[192:207], v[24:27], v[112:115], v[192:207]
  ds_read_b64_tr_b16 v[2:3], v163 offset:1280
  ds_read_b64_tr_b16 v[4:5], v163 offset:64
  ds_read_b64_tr_b16 v[6:7], v163 offset:1344
  ds_read_b64_tr_b16 v[8:9], v163 offset:128
  ds_read_b64_tr_b16 v[10:11], v163 offset:1408
  ds_read_b64_tr_b16 v[12:13], v163 offset:192
  v_mfma_f32_32x32x16_bf16 v[208:223], v[28:31], v[112:115], v[208:223]
  ds_read_b64_tr_b16 v[14:15], v163 offset:1472
  ds_read_b64_tr_b16 v[16:17], v163 offset:256
  ds_read_b64_tr_b16 v[18:19], v163 offset:1536
  s_waitcnt lgkmcnt(10)
  v_lshlrev_b32 v120, 16, v72
  v_and_b32 v121, v175, v72
  v_mfma_f32_32x32x16_bf16 v[224:239], v[32:35], v[112:115], v[224:239]
  v_fma_f32 v120, v120, v132, v124
  v_fma_f32 v121, v121, v133, v125
  v_cvt_pk_bf16_f32 v104, v120, v121
  v_lshlrev_b32 v122, 16, v73
  v_and_b32 v123, v175, v73
  v_fma_f32 v122, v122, v134, v126
  v_mfma_f32_32x32x16_bf16 v[240:255], v[36:39], v[112:115], v[240:255]
  v_fma_f32 v123, v123, v135, v127
  v_cvt_pk_bf16_f32 v105, v122, v123
  v_lshlrev_b32 v120, 16, v74
  v_and_b32 v121, v175, v74
  v_fma_f32 v120, v120, v136, v128
  v_fma_f32 v121, v121, v137, v129
  v_mfma_f32_32x32x16_bf16 a[0:15], v[20:23], v[116:119], a[0:15]
  v_cvt_pk_bf16_f32 v106, v120, v121
  v_lshlrev_b32 v122, 16, v75
  v_and_b32 v123, v175, v75
  v_fma_f32 v122, v122, v138, v130
  v_fma_f32 v123, v123, v139, v131
  v_cvt_pk_bf16_f32 v107, v122, v123
  v_mfma_f32_32x32x16_bf16 a[16:31], v[24:27], v[116:119], a[16:31]
  v_lshlrev_b32 v120, 16, v76
  v_and_b32 v121, v175, v76
  v_fmac_f32 v124, v120, v132
  v_fmac_f32 v125, v121, v133
  v_cvt_pk_bf16_f32 v108, v124, v125
  v_lshlrev_b32 v122, 16, v77
  v_mfma_f32_32x32x16_bf16 a[32:47], v[28:31], v[116:119], a[32:47]
  v_and_b32 v123, v175, v77
  v_fmac_f32 v126, v122, v134
  v_fmac_f32 v127, v123, v135
  v_cvt_pk_bf16_f32 v109, v126, v127
  v_lshlrev_b32 v120, 16, v78
  v_and_b32 v121, v175, v78
  v_mfma_f32_32x32x16_bf16 a[48:63], v[32:35], v[116:119], a[48:63]
  v_fmac_f32 v128, v120, v136
  v_fmac_f32 v129, v121, v137
  v_cvt_pk_bf16_f32 v110, v128, v129
  v_lshlrev_b32 v122, 16, v79
  v_and_b32 v123, v175, v79
  v_fmac_f32 v130, v122, v138
  v_mfma_f32_32x32x16_bf16 a[64:79], v[36:39], v[116:119], a[64:79]
  v_fmac_f32 v131, v123, v139
  v_cvt_pk_bf16_f32 v111, v130, v131
  ds_read_b128 v[140:143], v164 offset:576
  ds_read_b128 v[144:147], v164 offset:592
  ds_read_b128 v[148:151], v164 offset:3648
  ds_read_b128 v[152:155], v164 offset:3664
  ds_read_b64_tr_b16 v[20:21], v163 offset:5120
  ds_read_b64_tr_b16 v[22:23], v163 offset:6400
  ds_read_b64_tr_b16 v[24:25], v163 offset:5184
  ds_read_b64_tr_b16 v[26:27], v163 offset:6464
  ds_read_b64_tr_b16 v[28:29], v163 offset:5248
  ds_read_b64_tr_b16 v[30:31], v163 offset:6528
  ds_read_b64_tr_b16 v[32:33], v163 offset:5312
  ds_read_b64_tr_b16 v[34:35], v163 offset:6592
  ds_read_b64_tr_b16 v[36:37], v163 offset:5376
  ds_read_b64_tr_b16 v[38:39], v163 offset:6656
  s_waitcnt lgkmcnt(10)
  v_mfma_f32_32x32x16_bf16 v[176:191], v[0:3], v[104:107], v[176:191]
  s_waitcnt vmcnt(9)
  s_barrier
  s_mov_b32 s38, 1474560
  v_lshlrev_b32 v120, 16, v80
  v_and_b32 v121, v175, v80
  s_add_u32 m0, s56, 20480
  v_mfma_f32_32x32x16_bf16 v[192:207], v[4:7], v[104:107], v[192:207]
  v_fma_f32 v120, v120, v148, v140
  v_fma_f32 v121, v121, v149, v141
  s_nop 0
  v_cvt_pk_bf16_f32 v112, v120, v121
  v_lshlrev_b32 v122, 16, v81
  buffer_load_dwordx4 v156, s[20:23], s38 offen lds
  v_mfma_f32_32x32x16_bf16 v[208:223], v[8:11], v[104:107], v[208:223]
  v_and_b32 v123, v175, v81
  v_fma_f32 v122, v122, v150, v142
  s_add_u32 m0, s56, 21504
  v_fma_f32 v123, v123, v151, v143
  v_cvt_pk_bf16_f32 v113, v122, v123
  s_nop 0
  v_lshlrev_b32 v120, 16, v82
  v_mfma_f32_32x32x16_bf16 v[224:239], v[12:15], v[104:107], v[224:239]
  buffer_load_dwordx4 v157, s[20:23], s38 offen lds
  v_and_b32 v121, v175, v82
  v_fma_f32 v120, v120, v152, v144
  s_add_u32 m0, s56, 22528
  v_fma_f32 v121, v121, v153, v145
  v_cvt_pk_bf16_f32 v114, v120, v121
  v_mfma_f32_32x32x16_bf16 v[240:255], v[16:19], v[104:107], v[240:255]
  s_nop 0
  v_lshlrev_b32 v122, 16, v83
  v_and_b32 v123, v175, v83
  buffer_load_dwordx4 v158, s[20:23], s38 offen lds
  v_fma_f32 v122, v122, v154, v146
  v_fma_f32 v123, v123, v155, v147
  s_add_u32 m0, s56, 23552
  v_mfma_f32_32x32x16_bf16 a[0:15], v[0:3], v[108:111], a[0:15]
  v_cvt_pk_bf16_f32 v115, v122, v123
  s_nop 0
  v_lshlrev_b32 v120, 16, v84
  v_and_b32 v121, v175, v84
  buffer_load_dwordx4 v159, s[20:23], s38 offen lds
  v_fmac_f32 v140, v120, v148
  v_mfma_f32_32x32x16_bf16 a[16:31], v[4:7], v[108:111], a[16:31]
  v_fmac_f32 v141, v121, v149
  s_add_u32 m0, s56, 24576
  v_cvt_pk_bf16_f32 v116, v140, v141
  v_lshlrev_b32 v122, 16, v85
  s_nop 0
  v_and_b32 v123, v175, v85
  v_mfma_f32_32x32x16_bf16 a[32:47], v[8:11], v[108:111], a[32:47]
  v_fmac_f32 v142, v122, v150
  buffer_load_dwordx4 v160, s[20:23], s38 offen lds
  v_fmac_f32 v143, v123, v151
  v_cvt_pk_bf16_f32 v117, v142, v143
  s_add_u32 s64, s63, 20480
  v_lshlrev_b32 v120, 16, v86
  s_add_u32 s65, s62, 20480
  v_mfma_f32_32x32x16_bf16 a[48:63], v[12:15], v[108:111], a[48:63]
  v_and_b32 v121, v175, v86
  v_fmac_f32 v144, v120, v152
  buffer_load_dwordx4 v[56:59], v161, s[16:19], s64 offen
  v_fmac_f32 v145, v121, v153
  v_cvt_pk_bf16_f32 v118, v144, v145
  buffer_load_dwordx4 v[60:63], v161, s[16:19], s65 offen
  v_mfma_f32_32x32x16_bf16 a[64:79], v[16:19], v[108:111], a[64:79]
  v_lshlrev_b32 v122, 16, v87
  v_and_b32 v123, v175, v87
  buffer_load_dwordx4 v[64:67], v161, s[16:19], s64 offen offset:1024
  v_fmac_f32 v146, v122, v154
  v_fmac_f32 v147, v123, v155
  buffer_load_dwordx4 v[68:71], v161, s[16:19], s65 offen offset:1024
  v_cvt_pk_bf16_f32 v119, v146, v147
  s_waitcnt lgkmcnt(0)
  v_mfma_f32_32x32x16_bf16 v[176:191], v[20:23], v[112:115], v[176:191]
  ds_read_b128 v[124:127], v164 offset:768
  ds_read_b128 v[128:131], v164 offset:784
  ds_read_b128 v[132:135], v164 offset:3840
  ds_read_b128 v[136:139], v164 offset:3856
  ds_read_b64_tr_b16 v[0:1], v163 offset:20480
  v_mfma_f32_32x32x16_bf16 v[192:207], v[24:27], v[112:115], v[192:207]
  ds_read_b64_tr_b16 v[2:3], v163 offset:21760
  ds_read_b64_tr_b16 v[4:5], v163 offset:20544
  ds_read_b64_tr_b16 v[6:7], v163 offset:21824
  ds_read_b64_tr_b16 v[8:9], v163 offset:20608
  ds_read_b64_tr_b16 v[10:11], v163 offset:21888
  ds_read_b64_tr_b16 v[12:13], v163 offset:20672
  v_mfma_f32_32x32x16_bf16 v[208:223], v[28:31], v[112:115], v[208:223]
  ds_read_b64_tr_b16 v[14:15], v163 offset:21952
  ds_read_b64_tr_b16 v[16:17], v163 offset:20736
  ds_read_b64_tr_b16 v[18:19], v163 offset:22016
  s_waitcnt lgkmcnt(10)
  v_lshlrev_b32 v120, 16, v88
  v_and_b32 v121, v175, v88
  v_mfma_f32_32x32x16_bf16 v[224:239], v[32:35], v[112:115], v[224:239]
  v_fma_f32 v120, v120, v132, v124
  v_fma_f32 v121, v121, v133, v125
  v_cvt_pk_bf16_f32 v104, v120, v121
  v_lshlrev_b32 v122, 16, v89
  v_and_b32 v123, v175, v89
  v_fma_f32 v122, v122, v134, v126
  v_mfma_f32_32x32x16_bf16 v[240:255], v[36:39], v[112:115], v[240:255]
  v_fma_f32 v123, v123, v135, v127
  v_cvt_pk_bf16_f32 v105, v122, v123
  v_lshlrev_b32 v120, 16, v90
  v_and_b32 v121, v175, v90
  v_fma_f32 v120, v120, v136, v128
  v_fma_f32 v121, v121, v137, v129
  v_mfma_f32_32x32x16_bf16 a[0:15], v[20:23], v[116:119], a[0:15]
  v_cvt_pk_bf16_f32 v106, v120, v121
  v_lshlrev_b32 v122, 16, v91
  v_and_b32 v123, v175, v91
  v_fma_f32 v122, v122, v138, v130
  v_fma_f32 v123, v123, v139, v131
  v_cvt_pk_bf16_f32 v107, v122, v123
  v_mfma_f32_32x32x16_bf16 a[16:31], v[24:27], v[116:119], a[16:31]
  v_lshlrev_b32 v120, 16, v92
  v_and_b32 v121, v175, v92
  v_fmac_f32 v124, v120, v132
  v_fmac_f32 v125, v121, v133
  v_cvt_pk_bf16_f32 v108, v124, v125
  v_lshlrev_b32 v122, 16, v93
  v_mfma_f32_32x32x16_bf16 a[32:47], v[28:31], v[116:119], a[32:47]
  v_and_b32 v123, v175, v93
  v_fmac_f32 v126, v122, v134
  v_fmac_f32 v127, v123, v135
  v_cvt_pk_bf16_f32 v109, v126, v127
  v_lshlrev_b32 v120, 16, v94
  v_and_b32 v121, v175, v94
  v_mfma_f32_32x32x16_bf16 a[48:63], v[32:35], v[116:119], a[48:63]
  v_fmac_f32 v128, v120, v136
  v_fmac_f32 v129, v121, v137
  v_cvt_pk_bf16_f32 v110, v128, v129
  v_lshlrev_b32 v122, 16, v95
  v_and_b32 v123, v175, v95
  v_fmac_f32 v130, v122, v138
  v_mfma_f32_32x32x16_bf16 a[64:79], v[36:39], v[116:119], a[64:79]
  v_fmac_f32 v131, v123, v139
  v_cvt_pk_bf16_f32 v111, v130, v131
  ds_read_b128 v[140:143], v164 offset:832
  ds_read_b128 v[144:147], v164 offset:848
  ds_read_b128 v[148:151], v164 offset:3904
  ds_read_b128 v[152:155], v164 offset:3920
  ds_read_b64_tr_b16 v[20:21], v163 offset:25600
  ds_read_b64_tr_b16 v[22:23], v163 offset:26880
  ds_read_b64_tr_b16 v[24:25], v163 offset:25664
  ds_read_b64_tr_b16 v[26:27], v163 offset:26944
  ds_read_b64_tr_b16 v[28:29], v163 offset:25728
  ds_read_b64_tr_b16 v[30:31], v163 offset:27008
  ds_read_b64_tr_b16 v[32:33], v163 offset:25792
  ds_read_b64_tr_b16 v[34:35], v163 offset:27072
  ds_read_b64_tr_b16 v[36:37], v163 offset:25856
  ds_read_b64_tr_b16 v[38:39], v163 offset:27136
  s_waitcnt lgkmcnt(10)
  v_mfma_f32_32x32x16_bf16 v[176:191], v[0:3], v[104:107], v[176:191]
  s_waitcnt vmcnt(9)
  s_barrier
  s_mov_b32 s38, 1769472
  v_lshlrev_b32 v120, 16, v96
  v_and_b32 v121, v175, v96
  s_add_u32 m0, s56, 40960
  v_mfma_f32_32x32x16_bf16 v[192:207], v[4:7], v[104:107], v[192:207]
  v_fma_f32 v120, v120, v148, v140
  v_fma_f32 v121, v121, v149, v141
  s_nop 0
  v_cvt_pk_bf16_f32 v112, v120, v121
  v_lshlrev_b32 v122, 16, v97
  buffer_load_dwordx4 v156, s[20:23], s38 offen lds
  v_mfma_f32_32x32x16_bf16 v[208:223], v[8:11], v[104:107], v[208:223]
  v_and_b32 v123, v175, v97
  v_fma_f32 v122, v122, v150, v142
  s_add_u32 m0, s56, 41984
  v_fma_f32 v123, v123, v151, v143
  v_cvt_pk_bf16_f32 v113, v122, v123
  s_nop 0
  v_lshlrev_b32 v120, 16, v98
  v_mfma_f32_32x32x16_bf16 v[224:239], v[12:15], v[104:107], v[224:239]
  buffer_load_dwordx4 v157, s[20:23], s38 offen lds
  v_and_b32 v121, v175, v98
  v_fma_f32 v120, v120, v152, v144
  s_add_u32 m0, s56, 43008
  v_fma_f32 v121, v121, v153, v145
  v_cvt_pk_bf16_f32 v114, v120, v121
  v_mfma_f32_32x32x16_bf16 v[240:255], v[16:19], v[104:107], v[240:255]
  s_nop 0
  v_lshlrev_b32 v122, 16, v99
  v_and_b32 v123, v175, v99
  buffer_load_dwordx4 v158, s[20:23], s38 offen lds
  v_fma_f32 v122, v122, v154, v146
  v_fma_f32 v123, v123, v155, v147
  s_add_u32 m0, s56, 44032
  v_mfma_f32_32x32x16_bf16 a[0:15], v[0:3], v[108:111], a[0:15]
  v_cvt_pk_bf16_f32 v115, v122, v123
  s_nop 0
  v_lshlrev_b32 v120, 16, v100
  v_and_b32 v121, v175, v100
  buffer_load_dwordx4 v159, s[20:23], s38 offen lds
  v_fmac_f32 v140, v120, v148
  v_mfma_f32_32x32x16_bf16 a[16:31], v[4:7], v[108:111], a[16:31]
  v_fmac_f32 v141, v121, v149
  s_add_u32 m0, s56, 45056
  v_cvt_pk_bf16_f32 v116, v140, v141
  v_lshlrev_b32 v122, 16, v101
  s_nop 0
  v_and_b32 v123, v175, v101
  v_mfma_f32_32x32x16_bf16 a[32:47], v[8:11], v[108:111], a[32:47]
  v_fmac_f32 v142, v122, v150
  buffer_load_dwordx4 v160, s[20:23], s38 offen lds
  v_fmac_f32 v143, v123, v151
  v_cvt_pk_bf16_f32 v117, v142, v143
  s_add_u32 s64, s63, 24576
  v_lshlrev_b32 v120, 16, v102
  s_add_u32 s65, s62, 24576
  v_mfma_f32_32x32x16_bf16 a[48:63], v[12:15], v[108:111], a[48:63]
  v_and_b32 v121, v175, v102
  v_fmac_f32 v144, v120, v152
  buffer_load_dwordx4 v[72:75], v161, s[16:19], s64 offen
  v_fmac_f32 v145, v121, v153
  v_cvt_pk_bf16_f32 v118, v144, v145
  buffer_load_dwordx4 v[76:79], v161, s[16:19], s65 offen
  v_mfma_f32_32x32x16_bf16 a[64:79], v[16:19], v[108:111], a[64:79]
  v_lshlrev_b32 v122, 16, v103
  v_and_b32 v123, v175, v103
  buffer_load_dwordx4 v[80:83], v161, s[16:19], s64 offen offset:1024
  v_fmac_f32 v146, v122, v154
  v_fmac_f32 v147, v123, v155
  buffer_load_dwordx4 v[84:87], v161, s[16:19], s65 offen offset:1024
  v_cvt_pk_bf16_f32 v119, v146, v147
  s_waitcnt lgkmcnt(0)
  v_mfma_f32_32x32x16_bf16 v[176:191], v[20:23], v[112:115], v[176:191]
  ds_read_b128 v[124:127], v164 offset:1024
  ds_read_b128 v[128:131], v164 offset:1040
  ds_read_b128 v[132:135], v164 offset:4096
  ds_read_b128 v[136:139], v164 offset:4112
  ds_read_b64_tr_b16 v[0:1], v162 offset:0
  v_mfma_f32_32x32x16_bf16 v[192:207], v[24:27], v[112:115], v[192:207]
  ds_read_b64_tr_b16 v[2:3], v162 offset:1280
  ds_read_b64_tr_b16 v[4:5], v162 offset:64
  ds_read_b64_tr_b16 v[6:7], v162 offset:1344
  ds_read_b64_tr_b16 v[8:9], v162 offset:128
  ds_read_b64_tr_b16 v[10:11], v162 offset:1408
  ds_read_b64_tr_b16 v[12:13], v162 offset:192
  v_mfma_f32_32x32x16_bf16 v[208:223], v[28:31], v[112:115], v[208:223]
  ds_read_b64_tr_b16 v[14:15], v162 offset:1472
  ds_read_b64_tr_b16 v[16:17], v162 offset:256
  ds_read_b64_tr_b16 v[18:19], v162 offset:1536
  s_waitcnt lgkmcnt(10)
  v_lshlrev_b32 v120, 16, v40
  v_and_b32 v121, v175, v40
  v_mfma_f32_32x32x16_bf16 v[224:239], v[32:35], v[112:115], v[224:239]
  v_fma_f32 v120, v120, v132, v124
  v_fma_f32 v121, v121, v133, v125
  v_cvt_pk_bf16_f32 v104, v120, v121
  v_lshlrev_b32 v122, 16, v41
  v_and_b32 v123, v175, v41
  v_fma_f32 v122, v122, v134, v126
  v_mfma_f32_32x32x16_bf16 v[240:255], v[36:39], v[112:115], v[240:255]
  v_fma_f32 v123, v123, v135, v127
  v_cvt_pk_bf16_f32 v105, v122, v123
  v_lshlrev_b32 v120, 16, v42
  v_and_b32 v121, v175, v42
  v_fma_f32 v120, v120, v136, v128
  v_fma_f32 v121, v121, v137, v129
  v_mfma_f32_32x32x16_bf16 a[0:15], v[20:23], v[116:119], a[0:15]
  v_cvt_pk_bf16_f32 v106, v120, v121
  v_lshlrev_b32 v122, 16, v43
  v_and_b32 v123, v175, v43
  v_fma_f32 v122, v122, v138, v130
  v_fma_f32 v123, v123, v139, v131
  v_cvt_pk_bf16_f32 v107, v122, v123
  v_mfma_f32_32x32x16_bf16 a[16:31], v[24:27], v[116:119], a[16:31]
  v_lshlrev_b32 v120, 16, v44
  v_and_b32 v121, v175, v44
  v_fmac_f32 v124, v120, v132
  v_fmac_f32 v125, v121, v133
  v_cvt_pk_bf16_f32 v108, v124, v125
  v_lshlrev_b32 v122, 16, v45
  v_mfma_f32_32x32x16_bf16 a[32:47], v[28:31], v[116:119], a[32:47]
  v_and_b32 v123, v175, v45
  v_fmac_f32 v126, v122, v134
  v_fmac_f32 v127, v123, v135
  v_cvt_pk_bf16_f32 v109, v126, v127
  v_lshlrev_b32 v120, 16, v46
  v_and_b32 v121, v175, v46
  v_mfma_f32_32x32x16_bf16 a[48:63], v[32:35], v[116:119], a[48:63]
  v_fmac_f32 v128, v120, v136
  v_fmac_f32 v129, v121, v137
  v_cvt_pk_bf16_f32 v110, v128, v129
  v_lshlrev_b32 v122, 16, v47
  v_and_b32 v123, v175, v47
  v_fmac_f32 v130, v122, v138
  v_mfma_f32_32x32x16_bf16 a[64:79], v[36:39], v[116:119], a[64:79]
  v_fmac_f32 v131, v123, v139
  v_cvt_pk_bf16_f32 v111, v130, v131
  ds_read_b128 v[140:143], v164 offset:1088
  ds_read_b128 v[144:147], v164 offset:1104
  ds_read_b128 v[148:151], v164 offset:4160
  ds_read_b128 v[152:155], v164 offset:4176
  ds_read_b64_tr_b16 v[20:21], v162 offset:5120
  ds_read_b64_tr_b16 v[22:23], v162 offset:6400
  ds_read_b64_tr_b16 v[24:25], v162 offset:5184
  ds_read_b64_tr_b16 v[26:27], v162 offset:6464
  ds_read_b64_tr_b16 v[28:29], v162 offset:5248
  ds_read_b64_tr_b16 v[30:31], v162 offset:6528
  ds_read_b64_tr_b16 v[32:33], v162 offset:5312
  ds_read_b64_tr_b16 v[34:35], v162 offset:6592
  ds_read_b64_tr_b16 v[36:37], v162 offset:5376
  ds_read_b64_tr_b16 v[38:39], v162 offset:6656
  s_waitcnt lgkmcnt(10)
  v_mfma_f32_32x32x16_bf16 v[176:191], v[0:3], v[104:107], v[176:191]
  s_waitcnt vmcnt(9)
  s_barrier
  s_mov_b32 s38, 2064384
  v_lshlrev_b32 v120, 16, v48
  v_and_b32 v121, v175, v48
  s_add_u32 m0, s56, 61440
  v_mfma_f32_32x32x16_bf16 v[192:207], v[4:7], v[104:107], v[192:207]
  v_fma_f32 v120, v120, v148, v140
  v_fma_f32 v121, v121, v149, v141
  s_nop 0
  v_cvt_pk_bf16_f32 v112, v120, v121
  v_lshlrev_b32 v122, 16, v49
  buffer_load_dwordx4 v156, s[20:23], s38 offen lds
  v_mfma_f32_32x32x16_bf16 v[208:223], v[8:11], v[104:107], v[208:223]
  v_and_b32 v123, v175, v49
  v_fma_f32 v122, v122, v150, v142
  s_add_u32 m0, s56, 62464
  v_fma_f32 v123, v123, v151, v143
  v_cvt_pk_bf16_f32 v113, v122, v123
  s_nop 0
  v_lshlrev_b32 v120, 16, v50
  v_mfma_f32_32x32x16_bf16 v[224:239], v[12:15], v[104:107], v[224:239]
  buffer_load_dwordx4 v157, s[20:23], s38 offen lds
  v_and_b32 v121, v175, v50
  v_fma_f32 v120, v120, v152, v144
  s_add_u32 m0, s56, 63488
  v_fma_f32 v121, v121, v153, v145
  v_cvt_pk_bf16_f32 v114, v120, v121
  v_mfma_f32_32x32x16_bf16 v[240:255], v[16:19], v[104:107], v[240:255]
  s_nop 0
  v_lshlrev_b32 v122, 16, v51
  v_and_b32 v123, v175, v51
  buffer_load_dwordx4 v158, s[20:23], s38 offen lds
  v_fma_f32 v122, v122, v154, v146
  v_fma_f32 v123, v123, v155, v147
  s_add_u32 m0, s56, 64512
  v_mfma_f32_32x32x16_bf16 a[0:15], v[0:3], v[108:111], a[0:15]
  v_cvt_pk_bf16_f32 v115, v122, v123
  s_nop 0
  v_lshlrev_b32 v120, 16, v52
  v_and_b32 v121, v175, v52
  buffer_load_dwordx4 v159, s[20:23], s38 offen lds
  v_fmac_f32 v140, v120, v148
  v_mfma_f32_32x32x16_bf16 a[16:31], v[4:7], v[108:111], a[16:31]
  v_fmac_f32 v141, v121, v149
  s_add_u32 m0, s56, 65536
  v_cvt_pk_bf16_f32 v116, v140, v141
  v_lshlrev_b32 v122, 16, v53
  s_nop 0
  v_and_b32 v123, v175, v53
  v_mfma_f32_32x32x16_bf16 a[32:47], v[8:11], v[108:111], a[32:47]
  v_fmac_f32 v142, v122, v150
  buffer_load_dwordx4 v160, s[20:23], s38 offen lds
  v_fmac_f32 v143, v123, v151
  v_cvt_pk_bf16_f32 v117, v142, v143
  s_add_u32 s64, s63, 28672
  v_lshlrev_b32 v120, 16, v54
  s_add_u32 s65, s62, 28672
  v_mfma_f32_32x32x16_bf16 a[48:63], v[12:15], v[108:111], a[48:63]
  v_and_b32 v121, v175, v54
  v_fmac_f32 v144, v120, v152
  buffer_load_dwordx4 v[88:91], v161, s[16:19], s64 offen
  v_fmac_f32 v145, v121, v153
  v_cvt_pk_bf16_f32 v118, v144, v145
  buffer_load_dwordx4 v[92:95], v161, s[16:19], s65 offen
  v_mfma_f32_32x32x16_bf16 a[64:79], v[16:19], v[108:111], a[64:79]
  v_lshlrev_b32 v122, 16, v55
  v_and_b32 v123, v175, v55
  buffer_load_dwordx4 v[96:99], v161, s[16:19], s64 offen offset:1024
  v_fmac_f32 v146, v122, v154
  v_fmac_f32 v147, v123, v155
  buffer_load_dwordx4 v[100:103], v161, s[16:19], s65 offen offset:1024
  v_cvt_pk_bf16_f32 v119, v146, v147
  s_waitcnt lgkmcnt(0)
  v_mfma_f32_32x32x16_bf16 v[176:191], v[20:23], v[112:115], v[176:191]
  ds_read_b128 v[124:127], v164 offset:1280
  ds_read_b128 v[128:131], v164 offset:1296
  ds_read_b128 v[132:135], v164 offset:4352
  ds_read_b128 v[136:139], v164 offset:4368
  ds_read_b64_tr_b16 v[0:1], v162 offset:20480
  v_mfma_f32_32x32x16_bf16 v[192:207], v[24:27], v[112:115], v[192:207]
  ds_read_b64_tr_b16 v[2:3], v162 offset:21760
  ds_read_b64_tr_b16 v[4:5], v162 offset:20544
  ds_read_b64_tr_b16 v[6:7], v162 offset:21824
  ds_read_b64_tr_b16 v[8:9], v162 offset:20608
  ds_read_b64_tr_b16 v[10:11], v162 offset:21888
  ds_read_b64_tr_b16 v[12:13], v162 offset:20672
  v_mfma_f32_32x32x16_bf16 v[208:223], v[28:31], v[112:115], v[208:223]
  ds_read_b64_tr_b16 v[14:15], v162 offset:21952
  ds_read_b64_tr_b16 v[16:17], v162 offset:20736
  ds_read_b64_tr_b16 v[18:19], v162 offset:22016
  s_waitcnt lgkmcnt(10)
  v_lshlrev_b32 v120, 16, v56
  v_and_b32 v121, v175, v56
  v_mfma_f32_32x32x16_bf16 v[224:239], v[32:35], v[112:115], v[224:239]
  v_fma_f32 v120, v120, v132, v124
  v_fma_f32 v121, v121, v133, v125
  v_cvt_pk_bf16_f32 v104, v120, v121
  v_lshlrev_b32 v122, 16, v57
  v_and_b32 v123, v175, v57
  v_fma_f32 v122, v122, v134, v126
  v_mfma_f32_32x32x16_bf16 v[240:255], v[36:39], v[112:115], v[240:255]
  v_fma_f32 v123, v123, v135, v127
  v_cvt_pk_bf16_f32 v105, v122, v123
  v_lshlrev_b32 v120, 16, v58
  v_and_b32 v121, v175, v58
  v_fma_f32 v120, v120, v136, v128
  v_fma_f32 v121, v121, v137, v129
  v_mfma_f32_32x32x16_bf16 a[0:15], v[20:23], v[116:119], a[0:15]
  v_cvt_pk_bf16_f32 v106, v120, v121
  v_lshlrev_b32 v122, 16, v59
  v_and_b32 v123, v175, v59
  v_fma_f32 v122, v122, v138, v130
  v_fma_f32 v123, v123, v139, v131
  v_cvt_pk_bf16_f32 v107, v122, v123
  v_mfma_f32_32x32x16_bf16 a[16:31], v[24:27], v[116:119], a[16:31]
  v_lshlrev_b32 v120, 16, v60
  v_and_b32 v121, v175, v60
  v_fmac_f32 v124, v120, v132
  v_fmac_f32 v125, v121, v133
  v_cvt_pk_bf16_f32 v108, v124, v125
  v_lshlrev_b32 v122, 16, v61
  v_mfma_f32_32x32x16_bf16 a[32:47], v[28:31], v[116:119], a[32:47]
  v_and_b32 v123, v175, v61
  v_fmac_f32 v126, v122, v134
  v_fmac_f32 v127, v123, v135
  v_cvt_pk_bf16_f32 v109, v126, v127
  v_lshlrev_b32 v120, 16, v62
  v_and_b32 v121, v175, v62
  v_mfma_f32_32x32x16_bf16 a[48:63], v[32:35], v[116:119], a[48:63]
  v_fmac_f32 v128, v120, v136
  v_fmac_f32 v129, v121, v137
  v_cvt_pk_bf16_f32 v110, v128, v129
  v_lshlrev_b32 v122, 16, v63
  v_and_b32 v123, v175, v63
  v_fmac_f32 v130, v122, v138
  v_mfma_f32_32x32x16_bf16 a[64:79], v[36:39], v[116:119], a[64:79]
  v_fmac_f32 v131, v123, v139
  v_cvt_pk_bf16_f32 v111, v130, v131
  ds_read_b128 v[140:143], v164 offset:1344
  ds_read_b128 v[144:147], v164 offset:1360
  ds_read_b128 v[148:151], v164 offset:4416
  ds_read_b128 v[152:155], v164 offset:4432
  ds_read_b64_tr_b16 v[20:21], v162 offset:25600
  ds_read_b64_tr_b16 v[22:23], v162 offset:26880
  ds_read_b64_tr_b16 v[24:25], v162 offset:25664
  ds_read_b64_tr_b16 v[26:27], v162 offset:26944
  ds_read_b64_tr_b16 v[28:29], v162 offset:25728
  ds_read_b64_tr_b16 v[30:31], v162 offset:27008
  ds_read_b64_tr_b16 v[32:33], v162 offset:25792
  ds_read_b64_tr_b16 v[34:35], v162 offset:27072
  ds_read_b64_tr_b16 v[36:37], v162 offset:25856
  ds_read_b64_tr_b16 v[38:39], v162 offset:27136
  s_waitcnt lgkmcnt(10)
  v_mfma_f32_32x32x16_bf16 v[176:191], v[0:3], v[104:107], v[176:191]
  s_waitcnt vmcnt(9)
  s_barrier
  s_mov_b32 s38, 2359296
  v_lshlrev_b32 v120, 16, v64
  v_and_b32 v121, v175, v64
  s_add_u32 m0, s56, 0
  v_mfma_f32_32x32x16_bf16 v[192:207], v[4:7], v[104:107], v[192:207]
  v_fma_f32 v120, v120, v148, v140
  v_fma_f32 v121, v121, v149, v141
  s_nop 0
  v_cvt_pk_bf16_f32 v112, v120, v121
  v_lshlrev_b32 v122, 16, v65
  buffer_load_dwordx4 v156, s[20:23], s38 offen lds
  v_mfma_f32_32x32x16_bf16 v[208:223], v[8:11], v[104:107], v[208:223]
  v_and_b32 v123, v175, v65
  v_fma_f32 v122, v122, v150, v142
  s_add_u32 m0, s56, 1024
  v_fma_f32 v123, v123, v151, v143
  v_cvt_pk_bf16_f32 v113, v122, v123
  s_nop 0
  v_lshlrev_b32 v120, 16, v66
  v_mfma_f32_32x32x16_bf16 v[224:239], v[12:15], v[104:107], v[224:239]
  buffer_load_dwordx4 v157, s[20:23], s38 offen lds
  v_and_b32 v121, v175, v66
  v_fma_f32 v120, v120, v152, v144
  s_add_u32 m0, s56, 2048
  v_fma_f32 v121, v121, v153, v145
  v_cvt_pk_bf16_f32 v114, v120, v121
  v_mfma_f32_32x32x16_bf16 v[240:255], v[16:19], v[104:107], v[240:255]
  s_nop 0
  v_lshlrev_b32 v122, 16, v67
  v_and_b32 v123, v175, v67
  buffer_load_dwordx4 v158, s[20:23], s38 offen lds
  v_fma_f32 v122, v122, v154, v146
  v_fma_f32 v123, v123, v155, v147
  s_add_u32 m0, s56, 3072
  v_mfma_f32_32x32x16_bf16 a[0:15], v[0:3], v[108:111], a[0:15]
  v_cvt_pk_bf16_f32 v115, v122, v123
  s_nop 0
  v_lshlrev_b32 v120, 16, v68
  v_and_b32 v121, v175, v68
  buffer_load_dwordx4 v159, s[20:23], s38 offen lds
  v_fmac_f32 v140, v120, v148
  v_mfma_f32_32x32x16_bf16 a[16:31], v[4:7], v[108:111], a[16:31]
  v_fmac_f32 v141, v121, v149
  s_add_u32 m0, s56, 4096
  v_cvt_pk_bf16_f32 v116, v140, v141
  v_lshlrev_b32 v122, 16, v69
  s_nop 0
  v_and_b32 v123, v175, v69
  v_mfma_f32_32x32x16_bf16 a[32:47], v[8:11], v[108:111], a[32:47]
  v_fmac_f32 v142, v122, v150
  buffer_load_dwordx4 v160, s[20:23], s38 offen lds
  v_fmac_f32 v143, v123, v151
  v_cvt_pk_bf16_f32 v117, v142, v143
  s_add_u32 s64, s63, 32768
  v_lshlrev_b32 v120, 16, v70
  s_add_u32 s65, s62, 32768
  v_mfma_f32_32x32x16_bf16 a[48:63], v[12:15], v[108:111], a[48:63]
  v_and_b32 v121, v175, v70
  v_fmac_f32 v144, v120, v152
  buffer_load_dwordx4 v[40:43], v161, s[16:19], s64 offen
  v_fmac_f32 v145, v121, v153
  v_cvt_pk_bf16_f32 v118, v144, v145
  buffer_load_dwordx4 v[44:47], v161, s[16:19], s65 offen
  v_mfma_f32_32x32x16_bf16 a[64:79], v[16:19], v[108:111], a[64:79]
  v_lshlrev_b32 v122, 16, v71
  v_and_b32 v123, v175, v71
  buffer_load_dwordx4 v[48:51], v161, s[16:19], s64 offen offset:1024
  v_fmac_f32 v146, v122, v154
  v_fmac_f32 v147, v123, v155
  buffer_load_dwordx4 v[52:55], v161, s[16:19], s65 offen offset:1024
  v_cvt_pk_bf16_f32 v119, v146, v147
  s_waitcnt lgkmcnt(0)
  v_mfma_f32_32x32x16_bf16 v[176:191], v[20:23], v[112:115], v[176:191]
  ds_read_b128 v[124:127], v164 offset:1536
  ds_read_b128 v[128:131], v164 offset:1552
  ds_read_b128 v[132:135], v164 offset:4608
  ds_read_b128 v[136:139], v164 offset:4624
  ds_read_b64_tr_b16 v[0:1], v163 offset:0
  v_mfma_f32_32x32x16_bf16 v[192:207], v[24:27], v[112:115], v[192:207]
  ds_read_b64_tr_b16 v[2:3], v163 offset:1280
  ds_read_b64_tr_b16 v[4:5], v163 offset:64
  ds_read_b64_tr_b16 v[6:7], v163 offset:1344
  ds_read_b64_tr_b16 v[8:9], v163 offset:128
  ds_read_b64_tr_b16 v[10:11], v163 offset:1408
  ds_read_b64_tr_b16 v[12:13], v163 offset:192
  v_mfma_f32_32x32x16_bf16 v[208:223], v[28:31], v[112:115], v[208:223]
  ds_read_b64_tr_b16 v[14:15], v163 offset:1472
  ds_read_b64_tr_b16 v[16:17], v163 offset:256
  ds_read_b64_tr_b16 v[18:19], v163 offset:1536
  s_waitcnt lgkmcnt(10)
  v_lshlrev_b32 v120, 16, v72
  v_and_b32 v121, v175, v72
  v_mfma_f32_32x32x16_bf16 v[224:239], v[32:35], v[112:115], v[224:239]
  v_fma_f32 v120, v120, v132, v124
  v_fma_f32 v121, v121, v133, v125
  v_cvt_pk_bf16_f32 v104, v120, v121
  v_lshlrev_b32 v122, 16, v73
  v_and_b32 v123, v175, v73
  v_fma_f32 v122, v122, v134, v126
  v_mfma_f32_32x32x16_bf16 v[240:255], v[36:39], v[112:115], v[240:255]
  v_fma_f32 v123, v123, v135, v127
  v_cvt_pk_bf16_f32 v105, v122, v123
  v_lshlrev_b32 v120, 16, v74
  v_and_b32 v121, v175, v74
  v_fma_f32 v120, v120, v136, v128
  v_fma_f32 v121, v121, v137, v129
  v_mfma_f32_32x32x16_bf16 a[0:15], v[20:23], v[116:119], a[0:15]
  v_cvt_pk_bf16_f32 v106, v120, v121
  v_lshlrev_b32 v122, 16, v75
  v_and_b32 v123, v175, v75
  v_fma_f32 v122, v122, v138, v130
  v_fma_f32 v123, v123, v139, v131
  v_cvt_pk_bf16_f32 v107, v122, v123
  v_mfma_f32_32x32x16_bf16 a[16:31], v[24:27], v[116:119], a[16:31]
  v_lshlrev_b32 v120, 16, v76
  v_and_b32 v121, v175, v76
  v_fmac_f32 v124, v120, v132
  v_fmac_f32 v125, v121, v133
  v_cvt_pk_bf16_f32 v108, v124, v125
  v_lshlrev_b32 v122, 16, v77
  v_mfma_f32_32x32x16_bf16 a[32:47], v[28:31], v[116:119], a[32:47]
  v_and_b32 v123, v175, v77
  v_fmac_f32 v126, v122, v134
  v_fmac_f32 v127, v123, v135
  v_cvt_pk_bf16_f32 v109, v126, v127
  v_lshlrev_b32 v120, 16, v78
  v_and_b32 v121, v175, v78
  v_mfma_f32_32x32x16_bf16 a[48:63], v[32:35], v[116:119], a[48:63]
  v_fmac_f32 v128, v120, v136
  v_fmac_f32 v129, v121, v137
  v_cvt_pk_bf16_f32 v110, v128, v129
  v_lshlrev_b32 v122, 16, v79
  v_and_b32 v123, v175, v79
  v_fmac_f32 v130, v122, v138
  v_mfma_f32_32x32x16_bf16 a[64:79], v[36:39], v[116:119], a[64:79]
  v_fmac_f32 v131, v123, v139
  v_cvt_pk_bf16_f32 v111, v130, v131
  ds_read_b128 v[140:143], v164 offset:1600
  ds_read_b128 v[144:147], v164 offset:1616
  ds_read_b128 v[148:151], v164 offset:4672
  ds_read_b128 v[152:155], v164 offset:4688
  ds_read_b64_tr_b16 v[20:21], v163 offset:5120
  ds_read_b64_tr_b16 v[22:23], v163 offset:6400
  ds_read_b64_tr_b16 v[24:25], v163 offset:5184
  ds_read_b64_tr_b16 v[26:27], v163 offset:6464
  ds_read_b64_tr_b16 v[28:29], v163 offset:5248
  ds_read_b64_tr_b16 v[30:31], v163 offset:6528
  ds_read_b64_tr_b16 v[32:33], v163 offset:5312
  ds_read_b64_tr_b16 v[34:35], v163 offset:6592
  ds_read_b64_tr_b16 v[36:37], v163 offset:5376
  ds_read_b64_tr_b16 v[38:39], v163 offset:6656
  s_waitcnt lgkmcnt(10)
  v_mfma_f32_32x32x16_bf16 v[176:191], v[0:3], v[104:107], v[176:191]
  s_waitcnt vmcnt(9)
  s_barrier
  s_mov_b32 s38, 2654208
  v_lshlrev_b32 v120, 16, v80
  v_and_b32 v121, v175, v80
  s_add_u32 m0, s56, 20480
  v_mfma_f32_32x32x16_bf16 v[192:207], v[4:7], v[104:107], v[192:207]
  v_fma_f32 v120, v120, v148, v140
  v_fma_f32 v121, v121, v149, v141
  s_nop 0
  v_cvt_pk_bf16_f32 v112, v120, v121
  v_lshlrev_b32 v122, 16, v81
  buffer_load_dwordx4 v156, s[20:23], s38 offen lds
  v_mfma_f32_32x32x16_bf16 v[208:223], v[8:11], v[104:107], v[208:223]
  v_and_b32 v123, v175, v81
  v_fma_f32 v122, v122, v150, v142
  s_add_u32 m0, s56, 21504
  v_fma_f32 v123, v123, v151, v143
  v_cvt_pk_bf16_f32 v113, v122, v123
  s_nop 0
  v_lshlrev_b32 v120, 16, v82
  v_mfma_f32_32x32x16_bf16 v[224:239], v[12:15], v[104:107], v[224:239]
  buffer_load_dwordx4 v157, s[20:23], s38 offen lds
  v_and_b32 v121, v175, v82
  v_fma_f32 v120, v120, v152, v144
  s_add_u32 m0, s56, 22528
  v_fma_f32 v121, v121, v153, v145
  v_cvt_pk_bf16_f32 v114, v120, v121
  v_mfma_f32_32x32x16_bf16 v[240:255], v[16:19], v[104:107], v[240:255]
  s_nop 0
  v_lshlrev_b32 v122, 16, v83
  v_and_b32 v123, v175, v83
  buffer_load_dwordx4 v158, s[20:23], s38 offen lds
  v_fma_f32 v122, v122, v154, v146
  v_fma_f32 v123, v123, v155, v147
  s_add_u32 m0, s56, 23552
  v_mfma_f32_32x32x16_bf16 a[0:15], v[0:3], v[108:111], a[0:15]
  v_cvt_pk_bf16_f32 v115, v122, v123
  s_nop 0
  v_lshlrev_b32 v120, 16, v84
  v_and_b32 v121, v175, v84
  buffer_load_dwordx4 v159, s[20:23], s38 offen lds
  v_fmac_f32 v140, v120, v148
  v_mfma_f32_32x32x16_bf16 a[16:31], v[4:7], v[108:111], a[16:31]
  v_fmac_f32 v141, v121, v149
  s_add_u32 m0, s56, 24576
  v_cvt_pk_bf16_f32 v116, v140, v141
  v_lshlrev_b32 v122, 16, v85
  s_nop 0
  v_and_b32 v123, v175, v85
  v_mfma_f32_32x32x16_bf16 a[32:47], v[8:11], v[108:111], a[32:47]
  v_fmac_f32 v142, v122, v150
  buffer_load_dwordx4 v160, s[20:23], s38 offen lds
  v_fmac_f32 v143, v123, v151
  v_cvt_pk_bf16_f32 v117, v142, v143
  s_add_u32 s64, s63, 36864
  v_lshlrev_b32 v120, 16, v86
  s_add_u32 s65, s62, 36864
  v_mfma_f32_32x32x16_bf16 a[48:63], v[12:15], v[108:111], a[48:63]
  v_and_b32 v121, v175, v86
  v_fmac_f32 v144, v120, v152
  buffer_load_dwordx4 v[56:59], v161, s[16:19], s64 offen
  v_fmac_f32 v145, v121, v153
  v_cvt_pk_bf16_f32 v118, v144, v145
  buffer_load_dwordx4 v[60:63], v161, s[16:19], s65 offen
  v_mfma_f32_32x32x16_bf16 a[64:79], v[16:19], v[108:111], a[64:79]
  v_lshlrev_b32 v122, 16, v87
  v_and_b32 v123, v175, v87
  buffer_load_dwordx4 v[64:67], v161, s[16:19], s64 offen offset:1024
  v_fmac_f32 v146, v122, v154
  v_fmac_f32 v147, v123, v155
  buffer_load_dwordx4 v[68:71], v161, s[16:19], s65 offen offset:1024
  v_cvt_pk_bf16_f32 v119, v146, v147
  s_waitcnt lgkmcnt(0)
  v_mfma_f32_32x32x16_bf16 v[176:191], v[20:23], v[112:115], v[176:191]
  ds_read_b128 v[124:127], v164 offset:1792
  ds_read_b128 v[128:131], v164 offset:1808
  ds_read_b128 v[132:135], v164 offset:4864
  ds_read_b128 v[136:139], v164 offset:4880
  ds_read_b64_tr_b16 v[0:1], v163 offset:20480
  v_mfma_f32_32x32x16_bf16 v[192:207], v[24:27], v[112:115], v[192:207]
  ds_read_b64_tr_b16 v[2:3], v163 offset:21760
  ds_read_b64_tr_b16 v[4:5], v163 offset:20544
  ds_read_b64_tr_b16 v[6:7], v163 offset:21824
  ds_read_b64_tr_b16 v[8:9], v163 offset:20608
  ds_read_b64_tr_b16 v[10:11], v163 offset:21888
  ds_read_b64_tr_b16 v[12:13], v163 offset:20672
  v_mfma_f32_32x32x16_bf16 v[208:223], v[28:31], v[112:115], v[208:223]
  ds_read_b64_tr_b16 v[14:15], v163 offset:21952
  ds_read_b64_tr_b16 v[16:17], v163 offset:20736
  ds_read_b64_tr_b16 v[18:19], v163 offset:22016
  s_waitcnt lgkmcnt(10)
  v_lshlrev_b32 v120, 16, v88
  v_and_b32 v121, v175, v88
  v_mfma_f32_32x32x16_bf16 v[224:239], v[32:35], v[112:115], v[224:239]
  v_fma_f32 v120, v120, v132, v124
  v_fma_f32 v121, v121, v133, v125
  v_cvt_pk_bf16_f32 v104, v120, v121
  v_lshlrev_b32 v122, 16, v89
  v_and_b32 v123, v175, v89
  v_fma_f32 v122, v122, v134, v126
  v_mfma_f32_32x32x16_bf16 v[240:255], v[36:39], v[112:115], v[240:255]
  v_fma_f32 v123, v123, v135, v127
  v_cvt_pk_bf16_f32 v105, v122, v123
  v_lshlrev_b32 v120, 16, v90
  v_and_b32 v121, v175, v90
  v_fma_f32 v120, v120, v136, v128
  v_fma_f32 v121, v121, v137, v129
  v_mfma_f32_32x32x16_bf16 a[0:15], v[20:23], v[116:119], a[0:15]
  v_cvt_pk_bf16_f32 v106, v120, v121
  v_lshlrev_b32 v122, 16, v91
  v_and_b32 v123, v175, v91
  v_fma_f32 v122, v122, v138, v130
  v_fma_f32 v123, v123, v139, v131
  v_cvt_pk_bf16_f32 v107, v122, v123
  v_mfma_f32_32x32x16_bf16 a[16:31], v[24:27], v[116:119], a[16:31]
  v_lshlrev_b32 v120, 16, v92
  v_and_b32 v121, v175, v92
  v_fmac_f32 v124, v120, v132
  v_fmac_f32 v125, v121, v133
  v_cvt_pk_bf16_f32 v108, v124, v125
  v_lshlrev_b32 v122, 16, v93
  v_mfma_f32_32x32x16_bf16 a[32:47], v[28:31], v[116:119], a[32:47]
  v_and_b32 v123, v175, v93
  v_fmac_f32 v126, v122, v134
  v_fmac_f32 v127, v123, v135
  v_cvt_pk_bf16_f32 v109, v126, v127
  v_lshlrev_b32 v120, 16, v94
  v_and_b32 v121, v175, v94
  v_mfma_f32_32x32x16_bf16 a[48:63], v[32:35], v[116:119], a[48:63]
  v_fmac_f32 v128, v120, v136
  v_fmac_f32 v129, v121, v137
  v_cvt_pk_bf16_f32 v110, v128, v129
  v_lshlrev_b32 v122, 16, v95
  v_and_b32 v123, v175, v95
  v_fmac_f32 v130, v122, v138
  v_mfma_f32_32x32x16_bf16 a[64:79], v[36:39], v[116:119], a[64:79]
  v_fmac_f32 v131, v123, v139
  v_cvt_pk_bf16_f32 v111, v130, v131
  ds_read_b128 v[140:143], v164 offset:1856
  ds_read_b128 v[144:147], v164 offset:1872
  ds_read_b128 v[148:151], v164 offset:4928
  ds_read_b128 v[152:155], v164 offset:4944
  ds_read_b64_tr_b16 v[20:21], v163 offset:25600
  ds_read_b64_tr_b16 v[22:23], v163 offset:26880
  ds_read_b64_tr_b16 v[24:25], v163 offset:25664
  ds_read_b64_tr_b16 v[26:27], v163 offset:26944
  ds_read_b64_tr_b16 v[28:29], v163 offset:25728
  ds_read_b64_tr_b16 v[30:31], v163 offset:27008
  ds_read_b64_tr_b16 v[32:33], v163 offset:25792
  ds_read_b64_tr_b16 v[34:35], v163 offset:27072
  ds_read_b64_tr_b16 v[36:37], v163 offset:25856
  ds_read_b64_tr_b16 v[38:39], v163 offset:27136
  s_waitcnt lgkmcnt(10)
  v_mfma_f32_32x32x16_bf16 v[176:191], v[0:3], v[104:107], v[176:191]
  s_waitcnt vmcnt(9)
  s_barrier
  s_mov_b32 s38, 2949120
  v_lshlrev_b32 v120, 16, v96
  v_and_b32 v121, v175, v96
  s_add_u32 m0, s56, 40960
  v_mfma_f32_32x32x16_bf16 v[192:207], v[4:7], v[104:107], v[192:207]
  v_fma_f32 v120, v120, v148, v140
  v_fma_f32 v121, v121, v149, v141
  s_nop 0
  v_cvt_pk_bf16_f32 v112, v120, v121
  v_lshlrev_b32 v122, 16, v97
  buffer_load_dwordx4 v156, s[20:23], s38 offen lds
  v_mfma_f32_32x32x16_bf16 v[208:223], v[8:11], v[104:107], v[208:223]
  v_and_b32 v123, v175, v97
  v_fma_f32 v122, v122, v150, v142
  s_add_u32 m0, s56, 41984
  v_fma_f32 v123, v123, v151, v143
  v_cvt_pk_bf16_f32 v113, v122, v123
  s_nop 0
  v_lshlrev_b32 v120, 16, v98
  v_mfma_f32_32x32x16_bf16 v[224:239], v[12:15], v[104:107], v[224:239]
  buffer_load_dwordx4 v157, s[20:23], s38 offen lds
  v_and_b32 v121, v175, v98
  v_fma_f32 v120, v120, v152, v144
  s_add_u32 m0, s56, 43008
  v_fma_f32 v121, v121, v153, v145
  v_cvt_pk_bf16_f32 v114, v120, v121
  v_mfma_f32_32x32x16_bf16 v[240:255], v[16:19], v[104:107], v[240:255]
  s_nop 0
  v_lshlrev_b32 v122, 16, v99
  v_and_b32 v123, v175, v99
  buffer_load_dwordx4 v158, s[20:23], s38 offen lds
  v_fma_f32 v122, v122, v154, v146
  v_fma_f32 v123, v123, v155, v147
  s_add_u32 m0, s56, 44032
  v_mfma_f32_32x32x16_bf16 a[0:15], v[0:3], v[108:111], a[0:15]
  v_cvt_pk_bf16_f32 v115, v122, v123
  s_nop 0
  v_lshlrev_b32 v120, 16, v100
  v_and_b32 v121, v175, v100
  buffer_load_dwordx4 v159, s[20:23], s38 offen lds
  v_fmac_f32 v140, v120, v148
  v_mfma_f32_32x32x16_bf16 a[16:31], v[4:7], v[108:111], a[16:31]
  v_fmac_f32 v141, v121, v149
  s_add_u32 m0, s56, 45056
  v_cvt_pk_bf16_f32 v116, v140, v141
  v_lshlrev_b32 v122, 16, v101
  s_nop 0
  v_and_b32 v123, v175, v101
  v_mfma_f32_32x32x16_bf16 a[32:47], v[8:11], v[108:111], a[32:47]
  v_fmac_f32 v142, v122, v150
  buffer_load_dwordx4 v160, s[20:23], s38 offen lds
  v_fmac_f32 v143, v123, v151
  v_cvt_pk_bf16_f32 v117, v142, v143
  s_add_u32 s64, s63, 40960
  v_lshlrev_b32 v120, 16, v102
  s_add_u32 s65, s62, 40960
  v_mfma_f32_32x32x16_bf16 a[48:63], v[12:15], v[108:111], a[48:63]
  v_and_b32 v121, v175, v102
  v_fmac_f32 v144, v120, v152
  buffer_load_dwordx4 v[72:75], v161, s[16:19], s64 offen
  v_fmac_f32 v145, v121, v153
  v_cvt_pk_bf16_f32 v118, v144, v145
  buffer_load_dwordx4 v[76:79], v161, s[16:19], s65 offen
  v_mfma_f32_32x32x16_bf16 a[64:79], v[16:19], v[108:111], a[64:79]
  v_lshlrev_b32 v122, 16, v103
  v_and_b32 v123, v175, v103
  buffer_load_dwordx4 v[80:83], v161, s[16:19], s64 offen offset:1024
  v_fmac_f32 v146, v122, v154
  v_fmac_f32 v147, v123, v155
  buffer_load_dwordx4 v[84:87], v161, s[16:19], s65 offen offset:1024
  v_cvt_pk_bf16_f32 v119, v146, v147
  s_waitcnt lgkmcnt(0)
  v_mfma_f32_32x32x16_bf16 v[176:191], v[20:23], v[112:115], v[176:191]
  ds_read_b128 v[124:127], v164 offset:2048
  ds_read_b128 v[128:131], v164 offset:2064
  ds_read_b128 v[132:135], v164 offset:5120
  ds_read_b128 v[136:139], v164 offset:5136
  ds_read_b64_tr_b16 v[0:1], v162 offset:0
  v_mfma_f32_32x32x16_bf16 v[192:207], v[24:27], v[112:115], v[192:207]
  ds_read_b64_tr_b16 v[2:3], v162 offset:1280
  ds_read_b64_tr_b16 v[4:5], v162 offset:64
  ds_read_b64_tr_b16 v[6:7], v162 offset:1344
  ds_read_b64_tr_b16 v[8:9], v162 offset:128
  ds_read_b64_tr_b16 v[10:11], v162 offset:1408
  ds_read_b64_tr_b16 v[12:13], v162 offset:192
  v_mfma_f32_32x32x16_bf16 v[208:223], v[28:31], v[112:115], v[208:223]
  ds_read_b64_tr_b16 v[14:15], v162 offset:1472
  ds_read_b64_tr_b16 v[16:17], v162 offset:256
  ds_read_b64_tr_b16 v[18:19], v162 offset:1536
  s_waitcnt lgkmcnt(10)
  v_lshlrev_b32 v120, 16, v40
  v_and_b32 v121, v175, v40
  v_mfma_f32_32x32x16_bf16 v[224:239], v[32:35], v[112:115], v[224:239]
  v_fma_f32 v120, v120, v132, v124
  v_fma_f32 v121, v121, v133, v125
  v_cvt_pk_bf16_f32 v104, v120, v121
  v_lshlrev_b32 v122, 16, v41
  v_and_b32 v123, v175, v41
  v_fma_f32 v122, v122, v134, v126
  v_mfma_f32_32x32x16_bf16 v[240:255], v[36:39], v[112:115], v[240:255]
  v_fma_f32 v123, v123, v135, v127
  v_cvt_pk_bf16_f32 v105, v122, v123
  v_lshlrev_b32 v120, 16, v42
  v_and_b32 v121, v175, v42
  v_fma_f32 v120, v120, v136, v128
  v_fma_f32 v121, v121, v137, v129
  v_mfma_f32_32x32x16_bf16 a[0:15], v[20:23], v[116:119], a[0:15]
  v_cvt_pk_bf16_f32 v106, v120, v121
  v_lshlrev_b32 v122, 16, v43
  v_and_b32 v123, v175, v43
  v_fma_f32 v122, v122, v138, v130
  v_fma_f32 v123, v123, v139, v131
  v_cvt_pk_bf16_f32 v107, v122, v123
  v_mfma_f32_32x32x16_bf16 a[16:31], v[24:27], v[116:119], a[16:31]
  v_lshlrev_b32 v120, 16, v44
  v_and_b32 v121, v175, v44
  v_fmac_f32 v124, v120, v132
  v_fmac_f32 v125, v121, v133
  v_cvt_pk_bf16_f32 v108, v124, v125
  v_lshlrev_b32 v122, 16, v45
  v_mfma_f32_32x32x16_bf16 a[32:47], v[28:31], v[116:119], a[32:47]
  v_and_b32 v123, v175, v45
  v_fmac_f32 v126, v122, v134
  v_fmac_f32 v127, v123, v135
  v_cvt_pk_bf16_f32 v109, v126, v127
  v_lshlrev_b32 v120, 16, v46
  v_and_b32 v121, v175, v46
  v_mfma_f32_32x32x16_bf16 a[48:63], v[32:35], v[116:119], a[48:63]
  v_fmac_f32 v128, v120, v136
  v_fmac_f32 v129, v121, v137
  v_cvt_pk_bf16_f32 v110, v128, v129
  v_lshlrev_b32 v122, 16, v47
  v_and_b32 v123, v175, v47
  v_fmac_f32 v130, v122, v138
  v_mfma_f32_32x32x16_bf16 a[64:79], v[36:39], v[116:119], a[64:79]
  v_fmac_f32 v131, v123, v139
  v_cvt_pk_bf16_f32 v111, v130, v131
  ds_read_b128 v[140:143], v164 offset:2112
  ds_read_b128 v[144:147], v164 offset:2128
  ds_read_b128 v[148:151], v164 offset:5184
  ds_read_b128 v[152:155], v164 offset:5200
  ds_read_b64_tr_b16 v[20:21], v162 offset:5120
  ds_read_b64_tr_b16 v[22:23], v162 offset:6400
  ds_read_b64_tr_b16 v[24:25], v162 offset:5184
  ds_read_b64_tr_b16 v[26:27], v162 offset:6464
  ds_read_b64_tr_b16 v[28:29], v162 offset:5248
  ds_read_b64_tr_b16 v[30:31], v162 offset:6528
  ds_read_b64_tr_b16 v[32:33], v162 offset:5312
  ds_read_b64_tr_b16 v[34:35], v162 offset:6592
  ds_read_b64_tr_b16 v[36:37], v162 offset:5376
  ds_read_b64_tr_b16 v[38:39], v162 offset:6656
  s_waitcnt lgkmcnt(10)
  v_mfma_f32_32x32x16_bf16 v[176:191], v[0:3], v[104:107], v[176:191]
  s_waitcnt vmcnt(9)
  s_barrier
  s_mov_b32 s38, 3244032
  v_lshlrev_b32 v120, 16, v48
  v_and_b32 v121, v175, v48
  s_add_u32 m0, s56, 61440
  v_mfma_f32_32x32x16_bf16 v[192:207], v[4:7], v[104:107], v[192:207]
  v_fma_f32 v120, v120, v148, v140
  v_fma_f32 v121, v121, v149, v141
  s_nop 0
  v_cvt_pk_bf16_f32 v112, v120, v121
  v_lshlrev_b32 v122, 16, v49
  buffer_load_dwordx4 v156, s[20:23], s38 offen lds
  v_mfma_f32_32x32x16_bf16 v[208:223], v[8:11], v[104:107], v[208:223]
  v_and_b32 v123, v175, v49
  v_fma_f32 v122, v122, v150, v142
  s_add_u32 m0, s56, 62464
  v_fma_f32 v123, v123, v151, v143
  v_cvt_pk_bf16_f32 v113, v122, v123
  s_nop 0
  v_lshlrev_b32 v120, 16, v50
  v_mfma_f32_32x32x16_bf16 v[224:239], v[12:15], v[104:107], v[224:239]
  buffer_load_dwordx4 v157, s[20:23], s38 offen lds
  v_and_b32 v121, v175, v50
  v_fma_f32 v120, v120, v152, v144
  s_add_u32 m0, s56, 63488
  v_fma_f32 v121, v121, v153, v145
  v_cvt_pk_bf16_f32 v114, v120, v121
  v_mfma_f32_32x32x16_bf16 v[240:255], v[16:19], v[104:107], v[240:255]
  s_nop 0
  v_lshlrev_b32 v122, 16, v51
  v_and_b32 v123, v175, v51
  buffer_load_dwordx4 v158, s[20:23], s38 offen lds
  v_fma_f32 v122, v122, v154, v146
  v_fma_f32 v123, v123, v155, v147
  s_add_u32 m0, s56, 64512
  v_mfma_f32_32x32x16_bf16 a[0:15], v[0:3], v[108:111], a[0:15]
  v_cvt_pk_bf16_f32 v115, v122, v123
  s_nop 0
  v_lshlrev_b32 v120, 16, v52
  v_and_b32 v121, v175, v52
  buffer_load_dwordx4 v159, s[20:23], s38 offen lds
  v_fmac_f32 v140, v120, v148
  v_mfma_f32_32x32x16_bf16 a[16:31], v[4:7], v[108:111], a[16:31]
  v_fmac_f32 v141, v121, v149
  s_add_u32 m0, s56, 65536
  v_cvt_pk_bf16_f32 v116, v140, v141
  v_lshlrev_b32 v122, 16, v53
  s_nop 0
  v_and_b32 v123, v175, v53
  v_mfma_f32_32x32x16_bf16 a[32:47], v[8:11], v[108:111], a[32:47]
  v_fmac_f32 v142, v122, v150
  buffer_load_dwordx4 v160, s[20:23], s38 offen lds
  v_fmac_f32 v143, v123, v151
  v_cvt_pk_bf16_f32 v117, v142, v143
  s_add_u32 s64, s63, 45056
  v_lshlrev_b32 v120, 16, v54
  s_add_u32 s65, s62, 45056
  v_mfma_f32_32x32x16_bf16 a[48:63], v[12:15], v[108:111], a[48:63]
  v_and_b32 v121, v175, v54
  v_fmac_f32 v144, v120, v152
  buffer_load_dwordx4 v[88:91], v161, s[16:19], s64 offen
  v_fmac_f32 v145, v121, v153
  v_cvt_pk_bf16_f32 v118, v144, v145
  buffer_load_dwordx4 v[92:95], v161, s[16:19], s65 offen
  v_mfma_f32_32x32x16_bf16 a[64:79], v[16:19], v[108:111], a[64:79]
  v_lshlrev_b32 v122, 16, v55
  v_and_b32 v123, v175, v55
  buffer_load_dwordx4 v[96:99], v161, s[16:19], s64 offen offset:1024
  v_fmac_f32 v146, v122, v154
  v_fmac_f32 v147, v123, v155
  buffer_load_dwordx4 v[100:103], v161, s[16:19], s65 offen offset:1024
  v_cvt_pk_bf16_f32 v119, v146, v147
  s_waitcnt lgkmcnt(0)
  v_mfma_f32_32x32x16_bf16 v[176:191], v[20:23], v[112:115], v[176:191]
  ds_read_b128 v[124:127], v164 offset:2304
  ds_read_b128 v[128:131], v164 offset:2320
  ds_read_b128 v[132:135], v164 offset:5376
  ds_read_b128 v[136:139], v164 offset:5392
  ds_read_b64_tr_b16 v[0:1], v162 offset:20480
  v_mfma_f32_32x32x16_bf16 v[192:207], v[24:27], v[112:115], v[192:207]
  ds_read_b64_tr_b16 v[2:3], v162 offset:21760
  ds_read_b64_tr_b16 v[4:5], v162 offset:20544
  ds_read_b64_tr_b16 v[6:7], v162 offset:21824
  ds_read_b64_tr_b16 v[8:9], v162 offset:20608
  ds_read_b64_tr_b16 v[10:11], v162 offset:21888
  ds_read_b64_tr_b16 v[12:13], v162 offset:20672
  v_mfma_f32_32x32x16_bf16 v[208:223], v[28:31], v[112:115], v[208:223]
  ds_read_b64_tr_b16 v[14:15], v162 offset:21952
  ds_read_b64_tr_b16 v[16:17], v162 offset:20736
  ds_read_b64_tr_b16 v[18:19], v162 offset:22016
  s_waitcnt lgkmcnt(10)
  v_lshlrev_b32 v120, 16, v56
  v_and_b32 v121, v175, v56
  v_mfma_f32_32x32x16_bf16 v[224:239], v[32:35], v[112:115], v[224:239]
  v_fma_f32 v120, v120, v132, v124
  v_fma_f32 v121, v121, v133, v125
  v_cvt_pk_bf16_f32 v104, v120, v121
  v_lshlrev_b32 v122, 16, v57
  v_and_b32 v123, v175, v57
  v_fma_f32 v122, v122, v134, v126
  v_mfma_f32_32x32x16_bf16 v[240:255], v[36:39], v[112:115], v[240:255]
  v_fma_f32 v123, v123, v135, v127
  v_cvt_pk_bf16_f32 v105, v122, v123
  v_lshlrev_b32 v120, 16, v58
  v_and_b32 v121, v175, v58
  v_fma_f32 v120, v120, v136, v128
  v_fma_f32 v121, v121, v137, v129
  v_mfma_f32_32x32x16_bf16 a[0:15], v[20:23], v[116:119], a[0:15]
  v_cvt_pk_bf16_f32 v106, v120, v121
  v_lshlrev_b32 v122, 16, v59
  v_and_b32 v123, v175, v59
  v_fma_f32 v122, v122, v138, v130
  v_fma_f32 v123, v123, v139, v131
  v_cvt_pk_bf16_f32 v107, v122, v123
  v_mfma_f32_32x32x16_bf16 a[16:31], v[24:27], v[116:119], a[16:31]
  v_lshlrev_b32 v120, 16, v60
  v_and_b32 v121, v175, v60
  v_fmac_f32 v124, v120, v132
  v_fmac_f32 v125, v121, v133
  v_cvt_pk_bf16_f32 v108, v124, v125
  v_lshlrev_b32 v122, 16, v61
  v_mfma_f32_32x32x16_bf16 a[32:47], v[28:31], v[116:119], a[32:47]
  v_and_b32 v123, v175, v61
  v_fmac_f32 v126, v122, v134
  v_fmac_f32 v127, v123, v135
  v_cvt_pk_bf16_f32 v109, v126, v127
  v_lshlrev_b32 v120, 16, v62
  v_and_b32 v121, v175, v62
  v_mfma_f32_32x32x16_bf16 a[48:63], v[32:35], v[116:119], a[48:63]
  v_fmac_f32 v128, v120, v136
  v_fmac_f32 v129, v121, v137
  v_cvt_pk_bf16_f32 v110, v128, v129
  v_lshlrev_b32 v122, 16, v63
  v_and_b32 v123, v175, v63
  v_fmac_f32 v130, v122, v138
  v_mfma_f32_32x32x16_bf16 a[64:79], v[36:39], v[116:119], a[64:79]
  v_fmac_f32 v131, v123, v139
  v_cvt_pk_bf16_f32 v111, v130, v131
  ds_read_b128 v[140:143], v164 offset:2368
  ds_read_b128 v[144:147], v164 offset:2384
  ds_read_b128 v[148:151], v164 offset:5440
  ds_read_b128 v[152:155], v164 offset:5456
  ds_read_b64_tr_b16 v[20:21], v162 offset:25600
  ds_read_b64_tr_b16 v[22:23], v162 offset:26880
  ds_read_b64_tr_b16 v[24:25], v162 offset:25664
  ds_read_b64_tr_b16 v[26:27], v162 offset:26944
  ds_read_b64_tr_b16 v[28:29], v162 offset:25728
  ds_read_b64_tr_b16 v[30:31], v162 offset:27008
  ds_read_b64_tr_b16 v[32:33], v162 offset:25792
  ds_read_b64_tr_b16 v[34:35], v162 offset:27072
  ds_read_b64_tr_b16 v[36:37], v162 offset:25856
  ds_read_b64_tr_b16 v[38:39], v162 offset:27136
  s_waitcnt lgkmcnt(10)
  v_mfma_f32_32x32x16_bf16 v[176:191], v[0:3], v[104:107], v[176:191]
  s_waitcnt vmcnt(9)
  s_barrier
  v_lshlrev_b32 v120, 16, v64
  v_and_b32 v121, v175, v64
  v_mfma_f32_32x32x16_bf16 v[192:207], v[4:7], v[104:107], v[192:207]
  v_fma_f32 v120, v120, v148, v140
  v_fma_f32 v121, v121, v149, v141
  v_cvt_pk_bf16_f32 v112, v120, v121
  v_lshlrev_b32 v122, 16, v65
  v_mfma_f32_32x32x16_bf16 v[208:223], v[8:11], v[104:107], v[208:223]
  v_and_b32 v123, v175, v65
  v_fma_f32 v122, v122, v150, v142
  v_fma_f32 v123, v123, v151, v143
  v_cvt_pk_bf16_f32 v113, v122, v123
  v_mfma_f32_32x32x16_bf16 v[224:239], v[12:15], v[104:107], v[224:239]
  v_lshlrev_b32 v120, 16, v66
  v_and_b32 v121, v175, v66
  v_fma_f32 v120, v120, v152, v144
  v_fma_f32 v121, v121, v153, v145
  v_mfma_f32_32x32x16_bf16 v[240:255], v[16:19], v[104:107], v[240:255]
  v_cvt_pk_bf16_f32 v114, v120, v121
  v_lshlrev_b32 v122, 16, v67
  v_and_b32 v123, v175, v67
  v_fma_f32 v122, v122, v154, v146
  v_fma_f32 v123, v123, v155, v147
  v_mfma_f32_32x32x16_bf16 a[0:15], v[0:3], v[108:111], a[0:15]
  v_cvt_pk_bf16_f32 v115, v122, v123
  v_lshlrev_b32 v120, 16, v68
  v_and_b32 v121, v175, v68
  v_fmac_f32 v140, v120, v148
  v_mfma_f32_32x32x16_bf16 a[16:31], v[4:7], v[108:111], a[16:31]
  v_fmac_f32 v141, v121, v149
  v_cvt_pk_bf16_f32 v116, v140, v141
  v_lshlrev_b32 v122, 16, v69
  v_and_b32 v123, v175, v69
  v_mfma_f32_32x32x16_bf16 a[32:47], v[8:11], v[108:111], a[32:47]
  v_fmac_f32 v142, v122, v150
  v_fmac_f32 v143, v123, v151
  v_cvt_pk_bf16_f32 v117, v142, v143
  v_lshlrev_b32 v120, 16, v70
  v_mfma_f32_32x32x16_bf16 a[48:63], v[12:15], v[108:111], a[48:63]
  v_and_b32 v121, v175, v70
  v_fmac_f32 v144, v120, v152
  v_fmac_f32 v145, v121, v153
  v_cvt_pk_bf16_f32 v118, v144, v145
  v_mfma_f32_32x32x16_bf16 a[64:79], v[16:19], v[108:111], a[64:79]
  v_lshlrev_b32 v122, 16, v71
  v_and_b32 v123, v175, v71
  v_fmac_f32 v146, v122, v154
  v_fmac_f32 v147, v123, v155
  v_cvt_pk_bf16_f32 v119, v146, v147
  s_waitcnt lgkmcnt(0)
  v_mfma_f32_32x32x16_bf16 v[176:191], v[20:23], v[112:115], v[176:191]
  ds_read_b128 v[124:127], v164 offset:2560
  ds_read_b128 v[128:131], v164 offset:2576
  ds_read_b128 v[132:135], v164 offset:5632
  ds_read_b128 v[136:139], v164 offset:5648
  ds_read_b64_tr_b16 v[0:1], v163 offset:0
  v_mfma_f32_32x32x16_bf16 v[192:207], v[24:27], v[112:115], v[192:207]
  ds_read_b64_tr_b16 v[2:3], v163 offset:1280
  ds_read_b64_tr_b16 v[4:5], v163 offset:64
  ds_read_b64_tr_b16 v[6:7], v163 offset:1344
  ds_read_b64_tr_b16 v[8:9], v163 offset:128
  ds_read_b64_tr_b16 v[10:11], v163 offset:1408
  ds_read_b64_tr_b16 v[12:13], v163 offset:192
  v_mfma_f32_32x32x16_bf16 v[208:223], v[28:31], v[112:115], v[208:223]
  ds_read_b64_tr_b16 v[14:15], v163 offset:1472
  ds_read_b64_tr_b16 v[16:17], v163 offset:256
  ds_read_b64_tr_b16 v[18:19], v163 offset:1536
  s_waitcnt lgkmcnt(10)
  v_lshlrev_b32 v120, 16, v72
  v_and_b32 v121, v175, v72
  v_mfma_f32_32x32x16_bf16 v[224:239], v[32:35], v[112:115], v[224:239]
  v_fma_f32 v120, v120, v132, v124
  v_fma_f32 v121, v121, v133, v125
  v_cvt_pk_bf16_f32 v104, v120, v121
  v_lshlrev_b32 v122, 16, v73
  v_and_b32 v123, v175, v73
  v_fma_f32 v122, v122, v134, v126
  v_mfma_f32_32x32x16_bf16 v[240:255], v[36:39], v[112:115], v[240:255]
  v_fma_f32 v123, v123, v135, v127
  v_cvt_pk_bf16_f32 v105, v122, v123
  v_lshlrev_b32 v120, 16, v74
  v_and_b32 v121, v175, v74
  v_fma_f32 v120, v120, v136, v128
  v_fma_f32 v121, v121, v137, v129
  v_mfma_f32_32x32x16_bf16 a[0:15], v[20:23], v[116:119], a[0:15]
  v_cvt_pk_bf16_f32 v106, v120, v121
  v_lshlrev_b32 v122, 16, v75
  v_and_b32 v123, v175, v75
  v_fma_f32 v122, v122, v138, v130
  v_fma_f32 v123, v123, v139, v131
  v_cvt_pk_bf16_f32 v107, v122, v123
  v_mfma_f32_32x32x16_bf16 a[16:31], v[24:27], v[116:119], a[16:31]
  v_lshlrev_b32 v120, 16, v76
  v_and_b32 v121, v175, v76
  v_fmac_f32 v124, v120, v132
  v_fmac_f32 v125, v121, v133
  v_cvt_pk_bf16_f32 v108, v124, v125
  v_lshlrev_b32 v122, 16, v77
  v_mfma_f32_32x32x16_bf16 a[32:47], v[28:31], v[116:119], a[32:47]
  v_and_b32 v123, v175, v77
  v_fmac_f32 v126, v122, v134
  v_fmac_f32 v127, v123, v135
  v_cvt_pk_bf16_f32 v109, v126, v127
  v_lshlrev_b32 v120, 16, v78
  v_and_b32 v121, v175, v78
  v_mfma_f32_32x32x16_bf16 a[48:63], v[32:35], v[116:119], a[48:63]
  v_fmac_f32 v128, v120, v136
  v_fmac_f32 v129, v121, v137
  v_cvt_pk_bf16_f32 v110, v128, v129
  v_lshlrev_b32 v122, 16, v79
  v_and_b32 v123, v175, v79
  v_fmac_f32 v130, v122, v138
  v_mfma_f32_32x32x16_bf16 a[64:79], v[36:39], v[116:119], a[64:79]
  v_fmac_f32 v131, v123, v139
  v_cvt_pk_bf16_f32 v111, v130, v131
  ds_read_b128 v[140:143], v164 offset:2624
  ds_read_b128 v[144:147], v164 offset:2640
  ds_read_b128 v[148:151], v164 offset:5696
  ds_read_b128 v[152:155], v164 offset:5712
  ds_read_b64_tr_b16 v[20:21], v163 offset:5120
  ds_read_b64_tr_b16 v[22:23], v163 offset:6400
  ds_read_b64_tr_b16 v[24:25], v163 offset:5184
  ds_read_b64_tr_b16 v[26:27], v163 offset:6464
  ds_read_b64_tr_b16 v[28:29], v163 offset:5248
  ds_read_b64_tr_b16 v[30:31], v163 offset:6528
  ds_read_b64_tr_b16 v[32:33], v163 offset:5312
  ds_read_b64_tr_b16 v[34:35], v163 offset:6592
  ds_read_b64_tr_b16 v[36:37], v163 offset:5376
  ds_read_b64_tr_b16 v[38:39], v163 offset:6656
  s_waitcnt lgkmcnt(10)
  v_mfma_f32_32x32x16_bf16 v[176:191], v[0:3], v[104:107], v[176:191]
  s_waitcnt vmcnt(0)
  s_barrier
  v_lshlrev_b32 v120, 16, v80
  v_and_b32 v121, v175, v80
  v_mfma_f32_32x32x16_bf16 v[192:207], v[4:7], v[104:107], v[192:207]
  v_fma_f32 v120, v120, v148, v140
  v_fma_f32 v121, v121, v149, v141
  v_cvt_pk_bf16_f32 v112, v120, v121
  v_lshlrev_b32 v122, 16, v81
  v_mfma_f32_32x32x16_bf16 v[208:223], v[8:11], v[104:107], v[208:223]
  v_and_b32 v123, v175, v81
  v_fma_f32 v122, v122, v150, v142
  v_fma_f32 v123, v123, v151, v143
  v_cvt_pk_bf16_f32 v113, v122, v123
  v_mfma_f32_32x32x16_bf16 v[224:239], v[12:15], v[104:107], v[224:239]
  v_lshlrev_b32 v120, 16, v82
  v_and_b32 v121, v175, v82
  v_fma_f32 v120, v120, v152, v144
  v_fma_f32 v121, v121, v153, v145
  v_mfma_f32_32x32x16_bf16 v[240:255], v[16:19], v[104:107], v[240:255]
  v_cvt_pk_bf16_f32 v114, v120, v121
  v_lshlrev_b32 v122, 16, v83
  v_and_b32 v123, v175, v83
  v_fma_f32 v122, v122, v154, v146
  v_fma_f32 v123, v123, v155, v147
  v_mfma_f32_32x32x16_bf16 a[0:15], v[0:3], v[108:111], a[0:15]
  v_cvt_pk_bf16_f32 v115, v122, v123
  v_lshlrev_b32 v120, 16, v84
  v_and_b32 v121, v175, v84
  v_fmac_f32 v140, v120, v148
  v_mfma_f32_32x32x16_bf16 a[16:31], v[4:7], v[108:111], a[16:31]
  v_fmac_f32 v141, v121, v149
  v_cvt_pk_bf16_f32 v116, v140, v141
  v_lshlrev_b32 v122, 16, v85
  v_and_b32 v123, v175, v85
  v_mfma_f32_32x32x16_bf16 a[32:47], v[8:11], v[108:111], a[32:47]
  v_fmac_f32 v142, v122, v150
  v_fmac_f32 v143, v123, v151
  v_cvt_pk_bf16_f32 v117, v142, v143
  v_lshlrev_b32 v120, 16, v86
  v_mfma_f32_32x32x16_bf16 a[48:63], v[12:15], v[108:111], a[48:63]
  v_and_b32 v121, v175, v86
  v_fmac_f32 v144, v120, v152
  v_fmac_f32 v145, v121, v153
  v_cvt_pk_bf16_f32 v118, v144, v145
  v_mfma_f32_32x32x16_bf16 a[64:79], v[16:19], v[108:111], a[64:79]
  v_lshlrev_b32 v122, 16, v87
  v_and_b32 v123, v175, v87
  v_fmac_f32 v146, v122, v154
  v_fmac_f32 v147, v123, v155
  v_cvt_pk_bf16_f32 v119, v146, v147
  s_waitcnt lgkmcnt(0)
  v_mfma_f32_32x32x16_bf16 v[176:191], v[20:23], v[112:115], v[176:191]
  ds_read_b128 v[124:127], v164 offset:2816
  ds_read_b128 v[128:131], v164 offset:2832
  ds_read_b128 v[132:135], v164 offset:5888
  ds_read_b128 v[136:139], v164 offset:5904
  ds_read_b64_tr_b16 v[0:1], v163 offset:20480
  v_mfma_f32_32x32x16_bf16 v[192:207], v[24:27], v[112:115], v[192:207]
  ds_read_b64_tr_b16 v[2:3], v163 offset:21760
  ds_read_b64_tr_b16 v[4:5], v163 offset:20544
  ds_read_b64_tr_b16 v[6:7], v163 offset:21824
  ds_read_b64_tr_b16 v[8:9], v163 offset:20608
  ds_read_b64_tr_b16 v[10:11], v163 offset:21888
  ds_read_b64_tr_b16 v[12:13], v163 offset:20672
  v_mfma_f32_32x32x16_bf16 v[208:223], v[28:31], v[112:115], v[208:223]
  ds_read_b64_tr_b16 v[14:15], v163 offset:21952
  ds_read_b64_tr_b16 v[16:17], v163 offset:20736
  ds_read_b64_tr_b16 v[18:19], v163 offset:22016
  s_waitcnt lgkmcnt(10)
  v_lshlrev_b32 v120, 16, v88
  v_and_b32 v121, v175, v88
  v_mfma_f32_32x32x16_bf16 v[224:239], v[32:35], v[112:115], v[224:239]
  v_fma_f32 v120, v120, v132, v124
  v_fma_f32 v121, v121, v133, v125
  v_cvt_pk_bf16_f32 v104, v120, v121
  v_lshlrev_b32 v122, 16, v89
  v_and_b32 v123, v175, v89
  v_fma_f32 v122, v122, v134, v126
  v_mfma_f32_32x32x16_bf16 v[240:255], v[36:39], v[112:115], v[240:255]
  v_fma_f32 v123, v123, v135, v127
  v_cvt_pk_bf16_f32 v105, v122, v123
  v_lshlrev_b32 v120, 16, v90
  v_and_b32 v121, v175, v90
  v_fma_f32 v120, v120, v136, v128
  v_fma_f32 v121, v121, v137, v129
  v_mfma_f32_32x32x16_bf16 a[0:15], v[20:23], v[116:119], a[0:15]
  v_cvt_pk_bf16_f32 v106, v120, v121
  v_lshlrev_b32 v122, 16, v91
  v_and_b32 v123, v175, v91
  v_fma_f32 v122, v122, v138, v130
  v_fma_f32 v123, v123, v139, v131
  v_cvt_pk_bf16_f32 v107, v122, v123
  v_mfma_f32_32x32x16_bf16 a[16:31], v[24:27], v[116:119], a[16:31]
  v_lshlrev_b32 v120, 16, v92
  v_and_b32 v121, v175, v92
  v_fmac_f32 v124, v120, v132
  v_fmac_f32 v125, v121, v133
  v_cvt_pk_bf16_f32 v108, v124, v125
  v_lshlrev_b32 v122, 16, v93
  v_mfma_f32_32x32x16_bf16 a[32:47], v[28:31], v[116:119], a[32:47]
  v_and_b32 v123, v175, v93
  v_fmac_f32 v126, v122, v134
  v_fmac_f32 v127, v123, v135
  v_cvt_pk_bf16_f32 v109, v126, v127
  v_lshlrev_b32 v120, 16, v94
  v_and_b32 v121, v175, v94
  v_mfma_f32_32x32x16_bf16 a[48:63], v[32:35], v[116:119], a[48:63]
  v_fmac_f32 v128, v120, v136
  v_fmac_f32 v129, v121, v137
  v_cvt_pk_bf16_f32 v110, v128, v129
  v_lshlrev_b32 v122, 16, v95
  v_and_b32 v123, v175, v95
  v_fmac_f32 v130, v122, v138
  v_mfma_f32_32x32x16_bf16 a[64:79], v[36:39], v[116:119], a[64:79]
  v_fmac_f32 v131, v123, v139
  v_cvt_pk_bf16_f32 v111, v130, v131
  ds_read_b128 v[140:143], v164 offset:2880
  ds_read_b128 v[144:147], v164 offset:2896
  ds_read_b128 v[148:151], v164 offset:5952
  ds_read_b128 v[152:155], v164 offset:5968
  ds_read_b64_tr_b16 v[20:21], v163 offset:25600
  ds_read_b64_tr_b16 v[22:23], v163 offset:26880
  ds_read_b64_tr_b16 v[24:25], v163 offset:25664
  ds_read_b64_tr_b16 v[26:27], v163 offset:26944
  ds_read_b64_tr_b16 v[28:29], v163 offset:25728
  ds_read_b64_tr_b16 v[30:31], v163 offset:27008
  ds_read_b64_tr_b16 v[32:33], v163 offset:25792
  ds_read_b64_tr_b16 v[34:35], v163 offset:27072
  ds_read_b64_tr_b16 v[36:37], v163 offset:25856
  ds_read_b64_tr_b16 v[38:39], v163 offset:27136
  s_waitcnt lgkmcnt(10)
  v_mfma_f32_32x32x16_bf16 v[176:191], v[0:3], v[104:107], v[176:191]
  v_lshlrev_b32 v120, 16, v96
  v_and_b32 v121, v175, v96
  v_fma_f32 v120, v120, v148, v140
  v_fma_f32 v121, v121, v149, v141
  v_mfma_f32_32x32x16_bf16 v[192:207], v[4:7], v[104:107], v[192:207]
  v_cvt_pk_bf16_f32 v112, v120, v121
  v_lshlrev_b32 v122, 16, v97
  v_and_b32 v123, v175, v97
  v_fma_f32 v122, v122, v150, v142
  v_mfma_f32_32x32x16_bf16 v[208:223], v[8:11], v[104:107], v[208:223]
  v_fma_f32 v123, v123, v151, v143
  v_cvt_pk_bf16_f32 v113, v122, v123
  v_lshlrev_b32 v120, 16, v98
  v_and_b32 v121, v175, v98
  v_mfma_f32_32x32x16_bf16 v[224:239], v[12:15], v[104:107], v[224:239]
  v_fma_f32 v120, v120, v152, v144
  v_fma_f32 v121, v121, v153, v145
  v_cvt_pk_bf16_f32 v114, v120, v121
  v_lshlrev_b32 v122, 16, v99
  v_mfma_f32_32x32x16_bf16 v[240:255], v[16:19], v[104:107], v[240:255]
  v_and_b32 v123, v175, v99
  v_fma_f32 v122, v122, v154, v146
  v_fma_f32 v123, v123, v155, v147
  v_cvt_pk_bf16_f32 v115, v122, v123
  v_mfma_f32_32x32x16_bf16 a[0:15], v[0:3], v[108:111], a[0:15]
  v_lshlrev_b32 v120, 16, v100
  v_and_b32 v121, v175, v100
  v_fmac_f32 v140, v120, v148
  v_fmac_f32 v141, v121, v149
  v_mfma_f32_32x32x16_bf16 a[16:31], v[4:7], v[108:111], a[16:31]
  v_cvt_pk_bf16_f32 v116, v140, v141
  v_lshlrev_b32 v122, 16, v101
  v_and_b32 v123, v175, v101
  v_fmac_f32 v142, v122, v150
  v_mfma_f32_32x32x16_bf16 a[32:47], v[8:11], v[108:111], a[32:47]
  v_fmac_f32 v143, v123, v151
  v_cvt_pk_bf16_f32 v117, v142, v143
  v_lshlrev_b32 v120, 16, v102
  v_and_b32 v121, v175, v102
  v_mfma_f32_32x32x16_bf16 a[48:63], v[12:15], v[108:111], a[48:63]
  v_fmac_f32 v144, v120, v152
  v_fmac_f32 v145, v121, v153
  v_cvt_pk_bf16_f32 v118, v144, v145
  v_lshlrev_b32 v122, 16, v103
  v_mfma_f32_32x32x16_bf16 a[64:79], v[16:19], v[108:111], a[64:79]
  v_and_b32 v123, v175, v103
  v_fmac_f32 v146, v122, v154
  v_fmac_f32 v147, v123, v155
  v_cvt_pk_bf16_f32 v119, v146, v147
  s_waitcnt lgkmcnt(0)
  v_mfma_f32_32x32x16_bf16 v[176:191], v[20:23], v[112:115], v[176:191]
  v_mfma_f32_32x32x16_bf16 v[192:207], v[24:27], v[112:115], v[192:207]
  v_mfma_f32_32x32x16_bf16 v[208:223], v[28:31], v[112:115], v[208:223]
  v_mfma_f32_32x32x16_bf16 v[224:239], v[32:35], v[112:115], v[224:239]
  v_mfma_f32_32x32x16_bf16 v[240:255], v[36:39], v[112:115], v[240:255]
  v_mfma_f32_32x32x16_bf16 a[0:15], v[20:23], v[116:119], a[0:15]
  v_mfma_f32_32x32x16_bf16 a[16:31], v[24:27], v[116:119], a[16:31]
  v_mfma_f32_32x32x16_bf16 a[32:47], v[28:31], v[116:119], a[32:47]
  v_mfma_f32_32x32x16_bf16 a[48:63], v[32:35], v[116:119], a[48:63]
  v_mfma_f32_32x32x16_bf16 a[64:79], v[36:39], v[116:119], a[64:79]
  s_nop 15
  s_nop 7
  s_barrier

  v_lshlrev_b32 v168, 4, v165
  s_mul_i32 s62, s40, 20480
  v_add_u32 v169, s62, v168
  s_xor_b32 s63, s40, 2
  s_mul_i32 s63, s63, 20480
  v_add_u32 v168, s63, v168

  ds_write_b128 v169, a[0:3] offset:0
  ds_write_b128 v169, a[4:7] offset:1024
  ds_write_b128 v169, a[8:11] offset:2048
  ds_write_b128 v169, a[12:15] offset:3072
  ds_write_b128 v169, a[16:19] offset:4096
  ds_write_b128 v169, a[20:23] offset:5120
  ds_write_b128 v169, a[24:27] offset:6144
  ds_write_b128 v169, a[28:31] offset:7168
  ds_write_b128 v169, a[32:35] offset:8192
  ds_write_b128 v169, a[36:39] offset:9216
  ds_write_b128 v169, a[40:43] offset:10240
  ds_write_b128 v169, a[44:47] offset:11264
  ds_write_b128 v169, a[48:51] offset:12288
  ds_write_b128 v169, a[52:55] offset:13312
  ds_write_b128 v169, a[56:59] offset:14336
  ds_write_b128 v169, a[60:63] offset:15360
  ds_write_b128 v169, a[64:67] offset:16384
  ds_write_b128 v169, a[68:71] offset:17408
  ds_write_b128 v169, a[72:75] offset:18432
  ds_write_b128 v169, a[76:79] offset:19456
  s_lshr_b32 s100, s2, 3
  s_cmp_ge_u32 s100, 18
  s_cbranch_scc1 PFW_k2
  s_lshl_b32 s100, s100, 8
  v_add_u32 v172, s100, v167
  v_mul_u32_u24 v173, 10923, v172
  v_lshrrev_b32 v173, 16, v173
  v_mul_u32_u24 v174, 6, v173
  v_sub_u32 v174, v172, v174
  v_mul_u32_u24 v173, 1536, v173
  v_lshl_add_u32 v173, v174, 7, v173
  s_and_b32 s100, s2, 1
  s_mul_i32 s100, s100, 768
  v_add_u32 v173, s100, v173
  s_waitcnt lgkmcnt(0)
  global_load_dword v174, v173, s[36:37]
PFW_k2:

  s_waitcnt lgkmcnt(0)
  s_barrier
  ds_read_b128 v[0:3], v168 offset:0
  ds_read_b128 v[4:7], v168 offset:1024
  ds_read_b128 v[8:11], v168 offset:2048
  ds_read_b128 v[12:15], v168 offset:3072
  ds_read_b128 v[16:19], v168 offset:4096
  ds_read_b128 v[20:23], v168 offset:5120
  ds_read_b128 v[24:27], v168 offset:6144
  ds_read_b128 v[28:31], v168 offset:7168
  ds_read_b128 v[32:35], v168 offset:8192
  ds_read_b128 v[36:39], v168 offset:9216
  ds_read_b128 v[40:43], v168 offset:10240
  ds_read_b128 v[44:47], v168 offset:11264
  ds_read_b128 v[48:51], v168 offset:12288
  ds_read_b128 v[52:55], v168 offset:13312
  ds_read_b128 v[56:59], v168 offset:14336
  ds_read_b128 v[60:63], v168 offset:15360
  ds_read_b128 v[64:67], v168 offset:16384
  ds_read_b128 v[68:71], v168 offset:17408
  ds_read_b128 v[72:75], v168 offset:18432
  ds_read_b128 v[76:79], v168 offset:19456
  v_and_b32 v170, 31, v165
  v_add_u32 v170, s51, v170
  s_movk_i32 s62, 4608
  v_mul_lo_u32 v170, v170, s62
  v_lshrrev_b32 v171, 5, v165
  v_lshl_add_u32 v170, v171, 4, v170
  s_cmp_eq_u32 s52, 0
  s_cbranch_scc1 K2_skip_1

  s_waitcnt lgkmcnt(15)
  v_add_f32 v0, v0, v176
  v_add_f32 v1, v1, v177
  v_add_f32 v2, v2, v178
  v_add_f32 v3, v3, v179
  v_add_f32 v4, v4, v180
  v_add_f32 v5, v5, v181
  v_add_f32 v6, v6, v182
  v_add_f32 v7, v7, v183
  v_cvt_pk_bf16_f32 v96, v0, v1
  v_cvt_pk_bf16_f32 v97, v2, v3
  v_cvt_pk_bf16_f32 v98, v4, v5
  v_cvt_pk_bf16_f32 v99, v6, v7
  s_nop 1
  v_permlane32_swap_b32 v96, v98
  v_permlane32_swap_b32 v97, v99
  buffer_store_dwordx4 v[96:99], v170, s[28:31], s55 offen offset:0

  s_waitcnt lgkmcnt(15)
  v_add_f32 v8, v8, v184
  v_add_f32 v9, v9, v185
  v_add_f32 v10, v10, v186
  v_add_f32 v11, v11, v187
  v_add_f32 v12, v12, v188
  v_add_f32 v13, v13, v189
  v_add_f32 v14, v14, v190
  v_add_f32 v15, v15, v191
  v_cvt_pk_bf16_f32 v100, v8, v9
  v_cvt_pk_bf16_f32 v101, v10, v11
  v_cvt_pk_bf16_f32 v102, v12, v13
  v_cvt_pk_bf16_f32 v103, v14, v15
  s_nop 1
  v_permlane32_swap_b32 v100, v102
  v_permlane32_swap_b32 v101, v103
  buffer_store_dwordx4 v[100:103], v170, s[28:31], s55 offen offset:32

  s_waitcnt lgkmcnt(14)
  v_add_f32 v16, v16, v192
  v_add_f32 v17, v17, v193
  v_add_f32 v18, v18, v194
  v_add_f32 v19, v19, v195
  v_add_f32 v20, v20, v196
  v_add_f32 v21, v21, v197
  v_add_f32 v22, v22, v198
  v_add_f32 v23, v23, v199
  v_cvt_pk_bf16_f32 v104, v16, v17
  v_cvt_pk_bf16_f32 v105, v18, v19
  v_cvt_pk_bf16_f32 v106, v20, v21
  v_cvt_pk_bf16_f32 v107, v22, v23
  s_nop 1
  v_permlane32_swap_b32 v104, v106
  v_permlane32_swap_b32 v105, v107
  buffer_store_dwordx4 v[104:107], v170, s[28:31], s55 offen offset:64

  s_waitcnt lgkmcnt(12)
  v_add_f32 v24, v24, v200
  v_add_f32 v25, v25, v201
  v_add_f32 v26, v26, v202
  v_add_f32 v27, v27, v203
  v_add_f32 v28, v28, v204
  v_add_f32 v29, v29, v205
  v_add_f32 v30, v30, v206
  v_add_f32 v31, v31, v207
  v_cvt_pk_bf16_f32 v108, v24, v25
  v_cvt_pk_bf16_f32 v109, v26, v27
  v_cvt_pk_bf16_f32 v110, v28, v29
  v_cvt_pk_bf16_f32 v111, v30, v31
  s_nop 1
  v_permlane32_swap_b32 v108, v110
  v_permlane32_swap_b32 v109, v111
  buffer_store_dwordx4 v[108:111], v170, s[28:31], s55 offen offset:96

  s_waitcnt lgkmcnt(10)
  v_add_f32 v32, v32, v208
  v_add_f32 v33, v33, v209
  v_add_f32 v34, v34, v210
  v_add_f32 v35, v35, v211
  v_add_f32 v36, v36, v212
  v_add_f32 v37, v37, v213
  v_add_f32 v38, v38, v214
  v_add_f32 v39, v39, v215
  v_cvt_pk_bf16_f32 v96, v32, v33
  v_cvt_pk_bf16_f32 v97, v34, v35
  v_cvt_pk_bf16_f32 v98, v36, v37
  v_cvt_pk_bf16_f32 v99, v38, v39
  s_nop 1
  v_permlane32_swap_b32 v96, v98
  v_permlane32_swap_b32 v97, v99
  buffer_store_dwordx4 v[96:99], v170, s[28:31], s55 offen offset:128

  s_waitcnt lgkmcnt(8)
  v_add_f32 v40, v40, v216
  v_add_f32 v41, v41, v217
  v_add_f32 v42, v42, v218
  v_add_f32 v43, v43, v219
  v_add_f32 v44, v44, v220
  v_add_f32 v45, v45, v221
  v_add_f32 v46, v46, v222
  v_add_f32 v47, v47, v223
  v_cvt_pk_bf16_f32 v100, v40, v41
  v_cvt_pk_bf16_f32 v101, v42, v43
  v_cvt_pk_bf16_f32 v102, v44, v45
  v_cvt_pk_bf16_f32 v103, v46, v47
  s_nop 1
  v_permlane32_swap_b32 v100, v102
  v_permlane32_swap_b32 v101, v103
  buffer_store_dwordx4 v[100:103], v170, s[28:31], s55 offen offset:160

  s_waitcnt lgkmcnt(6)
  v_add_f32 v48, v48, v224
  v_add_f32 v49, v49, v225
  v_add_f32 v50, v50, v226
  v_add_f32 v51, v51, v227
  v_add_f32 v52, v52, v228
  v_add_f32 v53, v53, v229
  v_add_f32 v54, v54, v230
  v_add_f32 v55, v55, v231
  v_cvt_pk_bf16_f32 v104, v48, v49
  v_cvt_pk_bf16_f32 v105, v50, v51
  v_cvt_pk_bf16_f32 v106, v52, v53
  v_cvt_pk_bf16_f32 v107, v54, v55
  s_nop 1
  v_permlane32_swap_b32 v104, v106
  v_permlane32_swap_b32 v105, v107
  buffer_store_dwordx4 v[104:107], v170, s[28:31], s55 offen offset:192

  s_waitcnt lgkmcnt(4)
  v_add_f32 v56, v56, v232
  v_add_f32 v57, v57, v233
  v_add_f32 v58, v58, v234
  v_add_f32 v59, v59, v235
  v_add_f32 v60, v60, v236
  v_add_f32 v61, v61, v237
  v_add_f32 v62, v62, v238
  v_add_f32 v63, v63, v239
  v_cvt_pk_bf16_f32 v108, v56, v57
  v_cvt_pk_bf16_f32 v109, v58, v59
  v_cvt_pk_bf16_f32 v110, v60, v61
  v_cvt_pk_bf16_f32 v111, v62, v63
  s_nop 1
  v_permlane32_swap_b32 v108, v110
  v_permlane32_swap_b32 v109, v111
  buffer_store_dwordx4 v[108:111], v170, s[28:31], s55 offen offset:224

  s_waitcnt lgkmcnt(2)
  v_add_f32 v64, v64, v240
  v_add_f32 v65, v65, v241
  v_add_f32 v66, v66, v242
  v_add_f32 v67, v67, v243
  v_add_f32 v68, v68, v244
  v_add_f32 v69, v69, v245
  v_add_f32 v70, v70, v246
  v_add_f32 v71, v71, v247
  v_cvt_pk_bf16_f32 v96, v64, v65
  v_cvt_pk_bf16_f32 v97, v66, v67
  v_cvt_pk_bf16_f32 v98, v68, v69
  v_cvt_pk_bf16_f32 v99, v70, v71
  s_nop 1
  v_permlane32_swap_b32 v96, v98
  v_permlane32_swap_b32 v97, v99
  buffer_store_dwordx4 v[96:99], v170, s[28:31], s55 offen offset:256

  s_waitcnt lgkmcnt(0)
  v_add_f32 v72, v72, v248
  v_add_f32 v73, v73, v249
  v_add_f32 v74, v74, v250
  v_add_f32 v75, v75, v251
  v_add_f32 v76, v76, v252
  v_add_f32 v77, v77, v253
  v_add_f32 v78, v78, v254
  v_add_f32 v79, v79, v255
  v_cvt_pk_bf16_f32 v100, v72, v73
  v_cvt_pk_bf16_f32 v101, v74, v75
  v_cvt_pk_bf16_f32 v102, v76, v77
  v_cvt_pk_bf16_f32 v103, v78, v79
  s_nop 1
  v_permlane32_swap_b32 v100, v102
  v_permlane32_swap_b32 v101, v103
  buffer_store_dwordx4 v[100:103], v170, s[28:31], s55 offen offset:288

K2_skip_1:
K2_done:
K2_end:
  s_endpgm

k2_kernel_END:
.globl k3_kernel
.p2align 8
.type k3_kernel,@function
k3_kernel:
  s_cmp_ge_u32 s2, 256
  s_cbranch_scc1 K3_end
  s_load_dwordx4 s[8:11], s[0:1], 40
  s_load_dwordx2 s[12:13], s[0:1], 88
  v_and_b32 v200, 63, v0
  v_lshrrev_b32 v201, 6, v0
  s_nop 0
  v_readfirstlane_b32 s40, v201
  s_and_b32 s57, s2, 7
  s_lshr_b32 s58, s2, 3
  s_cmp_ge_u32 s58, 28
  s_cbranch_scc1 K3_extra
  s_cmp_ge_u32 s58, 16
  s_cbranch_scc1 K3_Vimg
  s_lshr_b32 s43, s57, 2
  s_bfe_u32 s42, s57, 0x10001
  s_lshl_b32 s42, s42, 2
  s_lshr_b32 s59, s58, 2
  s_add_u32 s42, s42, s59
  s_and_b32 s41, s57, 1
  s_lshl_b32 s41, s41, 2
  s_and_b32 s59, s58, 3
  s_add_u32 s41, s41, s59
  s_branch K3_Sgo
K3_Vimg:
  s_sub_u32 s58, s58, 16
  s_lshr_b32 s44, s57, 1
  s_lshl_b32 s44, s44, 2
  s_and_b32 s59, s58, 3
  s_add_u32 s44, s44, s59
  s_lshr_b32 s43, s44, 3
  s_and_b32 s44, s44, 7
  s_and_b32 s45, s57, 1
  s_mul_i32 s45, s45, 3
  s_lshr_b32 s59, s58, 2
  s_add_u32 s45, s45, s59
  s_lshl_b32 s44, s44, 7
  s_lshl_b32 s59, s40, 5
  s_add_u32 s44, s44, s59
  s_mov_b32 s42, 1
  s_branch K3_V
K3_extra:
  s_lshl_b32 s57, s57, 2
  s_add_u32 s57, s57, s58
  s_sub_u32 s57, s57, 28
  s_cmp_eq_u32 s57, 28
  s_cbranch_scc1 K3_gate
  s_cmp_ge_u32 s57, 28
  s_cbranch_scc1 K3_end
  s_cmp_ge_u32 s57, 22
  s_cbranch_scc1 K3_Vtxt
  s_cmp_ge_u32 s57, 11
  s_cselect_b32 s43, 1, 0
  s_mul_i32 s59, s43, 11
  s_sub_u32 s41, s57, s59
  s_movk_i32 s42, 8
  s_branch K3_Sgo
K3_Vtxt:
  s_sub_u32 s45, s57, 22
  s_mov_b32 s43, s40
  s_movk_i32 s44, 1024
  s_cmp_lt_u32 s40, 2
  s_cselect_b32 s42, 1, 0
  s_branch K3_V
K3_Sgo:
  s_waitcnt lgkmcnt(0)

  s_add_u32 s16, s12, 1048576
  s_addc_u32 s17, s13, 0
  s_mov_b32 s18, 9732096
  s_mov_b32 s19, 0x00020000
  s_add_u32 s20, s12, 16777216
  s_addc_u32 s21, s13, 0
  s_mov_b32 s22, 4595712
  s_mov_b32 s23, 0x00020000
  s_add_u32 s24, s12, 25165824
  s_addc_u32 s25, s13, 0
  s_mov_b32 s26, 135168
  s_mov_b32 s27, 0x00020000
  s_cmp_eq_u32 s42, 8
  s_cbranch_scc1 K3_S3
  s_cmp_eq_u32 s41, 7
  s_cbranch_scc1 K3_S5

  v_lshrrev_b32 v202, 3, v200
  v_and_b32 v203, 7, v200
  v_lshrrev_b32 v204, 4, v200
  v_xor_b32 v205, v203, v204
  v_xor_b32 v206, 4, v205
  v_mul_u32_u24 v202, 4608, v202
  v_lshl_add_u32 v190, v205, 4, v202
  v_lshl_add_u32 v191, v206, 4, v202

  s_mul_i32 s45, s43, 1056
  s_lshl_b32 s46, s42, 7
  s_add_u32 s46, s46, s45
  s_mul_i32 s47, s41, 128
  s_add_u32 s47, s47, s45
  s_mul_i32 s48, s46, 4608
  s_mul_i32 s49, s47, 4608
  s_add_u32 s49, s49, 1536
  s_mul_i32 s50, s40, 147456
  s_add_u32 s48, s48, s50
  s_mul_i32 s50, s40, 147456
  s_add_u32 s49, s49, s50
  s_lshl_b32 s51, s40, 12
  s_mul_i32 s52, s40, 4096
  s_add_u32 s52, s52, 16384

  v_mov_b32 v192, v190
  v_mov_b32 v193, v191
  s_add_u32 m0, s51, 0
  s_add_u32 s56, s48, 0
  buffer_load_dwordx4 v190, s[16:19], s56 offen lds
  s_add_u32 m0, s51, 1024
  s_add_u32 s56, s48, 36864
  buffer_load_dwordx4 v191, s[16:19], s56 offen lds
  s_add_u32 m0, s51, 2048
  s_add_u32 s56, s48, 73728
  buffer_load_dwordx4 v190, s[16:19], s56 offen lds
  s_add_u32 m0, s51, 3072
  s_add_u32 s56, s48, 110592
  buffer_load_dwordx4 v191, s[16:19], s56 offen lds
  s_add_u32 m0, s52, 0
  s_add_u32 s56, s49, 0
  buffer_load_dwordx4 v192, s[16:19], s56 offen lds
  s_add_u32 m0, s52, 1024
  s_add_u32 s56, s49, 36864
  buffer_load_dwordx4 v193, s[16:19], s56 offen lds
  s_add_u32 m0, s52, 2048
  s_add_u32 s56, s49, 73728
  buffer_load_dwordx4 v192, s[16:19], s56 offen lds
  s_add_u32 m0, s52, 3072
  s_add_u32 s56, s49, 110592
  buffer_load_dwordx4 v193, s[16:19], s56 offen lds
  s_add_u32 m0, s51, 36864
  s_add_u32 s56, s48, 128
  buffer_load_dwordx4 v190, s[16:19], s56 offen lds
  s_add_u32 m0, s51, 37888
  s_add_u32 s56, s48, 36992
  buffer_load_dwordx4 v191, s[16:19], s56 offen lds
  s_add_u32 m0, s51, 38912
  s_add_u32 s56, s48, 73856
  buffer_load_dwordx4 v190, s[16:19], s56 offen lds
  s_add_u32 m0, s51, 39936
  s_add_u32 s56, s48, 110720
  buffer_load_dwordx4 v191, s[16:19], s56 offen lds
  s_add_u32 m0, s52, 36864
  s_add_u32 s56, s49, 128
  buffer_load_dwordx4 v192, s[16:19], s56 offen lds
  s_add_u32 m0, s52, 37888
  s_add_u32 s56, s49, 36992
  buffer_load_dwordx4 v193, s[16:19], s56 offen lds
  s_add_u32 m0, s52, 38912
  s_add_u32 s56, s49, 73856
  buffer_load_dwordx4 v192, s[16:19], s56 offen lds
  s_add_u32 m0, s52, 39936
  s_add_u32 s56, s49, 110720
  buffer_load_dwordx4 v193, s[16:19], s56 offen lds
  v_and_b32 v202, 31, v200
  v_lshrrev_b32 v203, 5, v200
  v_bfe_u32 v204, v202, 1, 3
  v_xor_b32 v204, v204, v203
  v_lshlrev_b32 v204, 4, v204
  v_lshl_add_u32 v204, v202, 7, v204
  s_lshl_b32 s53, s40, 12
  v_add_u32 v130, s53, v204

  v_and_b32 v204, 3, v202
  v_bfe_u32 v205, v202, 2, 1
  v_lshl_add_u32 v204, v205, 3, v204
  v_bfe_u32 v205, v202, 3, 1
  v_lshl_add_u32 v204, v205, 2, v204
  v_bfe_u32 v205, v202, 4, 1
  v_lshl_add_u32 v204, v205, 4, v204

  v_bfe_u32 v205, v204, 1, 3
  v_xor_b32 v205, v205, v203
  v_lshlrev_b32 v205, 4, v205
  v_lshl_add_u32 v205, v204, 7, v205
  v_add_u32 v134, 16384, v205

  v_xor_b32 v131, 32, v130
  v_xor_b32 v135, 32, v134
  v_xor_b32 v132, 64, v130
  v_xor_b32 v136, 64, v134
  v_xor_b32 v133, 96, v130
  v_xor_b32 v137, 96, v134
  s_add_u32 m0, s51, 73728
  s_add_u32 s56, s48, 256
  buffer_load_dwordx4 v190, s[16:19], s56 offen lds
  s_add_u32 m0, s51, 74752
  s_add_u32 s56, s48, 37120
  buffer_load_dwordx4 v191, s[16:19], s56 offen lds
  s_add_u32 m0, s51, 75776
  s_add_u32 s56, s48, 73984
  buffer_load_dwordx4 v190, s[16:19], s56 offen lds
  s_add_u32 m0, s51, 76800
  s_add_u32 s56, s48, 110848
  buffer_load_dwordx4 v191, s[16:19], s56 offen lds
  s_add_u32 m0, s52, 73728
  s_add_u32 s56, s49, 256
  buffer_load_dwordx4 v192, s[16:19], s56 offen lds
  s_add_u32 m0, s52, 74752
  s_add_u32 s56, s49, 37120
  buffer_load_dwordx4 v193, s[16:19], s56 offen lds
  s_add_u32 m0, s52, 75776
  s_add_u32 s56, s49, 73984
  buffer_load_dwordx4 v192, s[16:19], s56 offen lds
  s_add_u32 m0, s52, 76800
  s_add_u32 s56, s49, 110848
  buffer_load_dwordx4 v193, s[16:19], s56 offen lds
  s_add_u32 m0, s51, 110592
  s_add_u32 s56, s48, 384
  buffer_load_dwordx4 v190, s[16:19], s56 offen lds
  s_add_u32 m0, s51, 111616
  s_add_u32 s56, s48, 37248
  buffer_load_dwordx4 v191, s[16:19], s56 offen lds
  s_add_u32 m0, s51, 112640
  s_add_u32 s56, s48, 74112
  buffer_load_dwordx4 v190, s[16:19], s56 offen lds
  s_add_u32 m0, s51, 113664
  s_add_u32 s56, s48, 110976
  buffer_load_dwordx4 v191, s[16:19], s56 offen lds
  s_add_u32 m0, s52, 110592
  s_add_u32 s56, s49, 384
  buffer_load_dwordx4 v192, s[16:19], s56 offen lds
  s_add_u32 m0, s52, 111616
  s_add_u32 s56, s49, 37248
  buffer_load_dwordx4 v193, s[16:19], s56 offen lds
  s_add_u32 m0, s52, 112640
  s_add_u32 s56, s49, 74112
  buffer_load_dwordx4 v192, s[16:19], s56 offen lds
  s_add_u32 m0, s52, 113664
  s_add_u32 s56, s49, 110976
  buffer_load_dwordx4 v193, s[16:19], s56 offen lds
  s_waitcnt vmcnt(24)
  s_barrier
  v_add_u32 v138, 0, v130
  v_add_u32 v142, 0, v134
  ds_read_b128 v[80:83], v138
  ds_read_b128 v[84:87], v142 offset:0
  ds_read_b128 v[88:91], v142 offset:4096
  ds_read_b128 v[92:95], v142 offset:8192
  ds_read_b128 v[96:99], v142 offset:12288
  v_add_u32 v138, 0, v131
  v_add_u32 v142, 0, v135
  ds_read_b128 v[104:107], v138
  ds_read_b128 v[108:111], v142 offset:0
  ds_read_b128 v[112:115], v142 offset:4096
  ds_read_b128 v[116:119], v142 offset:8192
  ds_read_b128 v[120:123], v142 offset:12288
  s_waitcnt lgkmcnt(5)
  v_mfma_f32_32x32x16_bf16 v[0:15], v[84:87], v[80:83], 0
  v_mfma_f32_32x32x16_bf16 v[16:31], v[88:91], v[80:83], 0
  v_mfma_f32_32x32x16_bf16 v[32:47], v[92:95], v[80:83], 0
  v_mfma_f32_32x32x16_bf16 v[48:63], v[96:99], v[80:83], 0
  v_add_u32 v138, 0, v132
  v_add_u32 v142, 0, v136
  ds_read_b128 v[80:83], v138
  ds_read_b128 v[84:87], v142 offset:0
  ds_read_b128 v[88:91], v142 offset:4096
  ds_read_b128 v[92:95], v142 offset:8192
  ds_read_b128 v[96:99], v142 offset:12288
  s_waitcnt lgkmcnt(5)
  v_mfma_f32_32x32x16_bf16 v[0:15], v[108:111], v[104:107], v[0:15]
  s_waitcnt vmcnt(16)
  s_barrier
  v_mfma_f32_32x32x16_bf16 v[16:31], v[112:115], v[104:107], v[16:31]
  v_mfma_f32_32x32x16_bf16 v[32:47], v[116:119], v[104:107], v[32:47]
  v_mfma_f32_32x32x16_bf16 v[48:63], v[120:123], v[104:107], v[48:63]
  v_add_u32 v138, 0, v133
  v_add_u32 v142, 0, v137
  ds_read_b128 v[104:107], v138
  ds_read_b128 v[108:111], v142 offset:0
  ds_read_b128 v[112:115], v142 offset:4096
  ds_read_b128 v[116:119], v142 offset:8192
  ds_read_b128 v[120:123], v142 offset:12288
  s_waitcnt lgkmcnt(5)
  v_mfma_f32_32x32x16_bf16 v[0:15], v[84:87], v[80:83], v[0:15]
  v_mfma_f32_32x32x16_bf16 v[16:31], v[88:91], v[80:83], v[16:31]
  v_mfma_f32_32x32x16_bf16 v[32:47], v[92:95], v[80:83], v[32:47]
  v_mfma_f32_32x32x16_bf16 v[48:63], v[96:99], v[80:83], v[48:63]
  v_add_u32 v138, 36864, v130
  v_add_u32 v142, 36864, v134
  ds_read_b128 v[80:83], v138
  ds_read_b128 v[84:87], v142 offset:0
  ds_read_b128 v[88:91], v142 offset:4096
  ds_read_b128 v[92:95], v142 offset:8192
  ds_read_b128 v[96:99], v142 offset:12288
  s_waitcnt lgkmcnt(5)
  v_mfma_f32_32x32x16_bf16 v[0:15], v[108:111], v[104:107], v[0:15]
  v_mfma_f32_32x32x16_bf16 v[16:31], v[112:115], v[104:107], v[16:31]
  v_mfma_f32_32x32x16_bf16 v[32:47], v[116:119], v[104:107], v[32:47]
  v_mfma_f32_32x32x16_bf16 v[48:63], v[120:123], v[104:107], v[48:63]
  v_add_u32 v138, 36864, v131
  v_add_u32 v142, 36864, v135
  ds_read_b128 v[104:107], v138
  ds_read_b128 v[108:111], v142 offset:0
  ds_read_b128 v[112:115], v142 offset:4096
  ds_read_b128 v[116:119], v142 offset:8192
  ds_read_b128 v[120:123], v142 offset:12288
  s_waitcnt lgkmcnt(5)
  v_mfma_f32_32x32x16_bf16 v[0:15], v[84:87], v[80:83], v[0:15]
  v_mfma_f32_32x32x16_bf16 v[16:31], v[88:91], v[80:83], v[16:31]
  v_mfma_f32_32x32x16_bf16 v[32:47], v[92:95], v[80:83], v[32:47]
  v_mfma_f32_32x32x16_bf16 v[48:63], v[96:99], v[80:83], v[48:63]
  v_add_u32 v138, 36864, v132
  v_add_u32 v142, 36864, v136
  ds_read_b128 v[80:83], v138
  ds_read_b128 v[84:87], v142 offset:0
  ds_read_b128 v[88:91], v142 offset:4096
  ds_read_b128 v[92:95], v142 offset:8192
  ds_read_b128 v[96:99], v142 offset:12288
  s_waitcnt lgkmcnt(5)
  v_mfma_f32_32x32x16_bf16 v[0:15], v[108:111], v[104:107], v[0:15]
  s_waitcnt vmcnt(8)
  s_barrier
  v_mfma_f32_32x32x16_bf16 v[16:31], v[112:115], v[104:107], v[16:31]
  s_add_u32 m0, s51, 0
  s_add_u32 s56, s48, 512
  buffer_load_dwordx4 v190, s[16:19], s56 offen lds
  s_add_u32 m0, s51, 1024
  v_mfma_f32_32x32x16_bf16 v[32:47], v[116:119], v[104:107], v[32:47]
  s_add_u32 s56, s48, 37376
  buffer_load_dwordx4 v191, s[16:19], s56 offen lds
  s_add_u32 m0, s51, 2048
  s_add_u32 s56, s48, 74240
  v_mfma_f32_32x32x16_bf16 v[48:63], v[120:123], v[104:107], v[48:63]
  buffer_load_dwordx4 v190, s[16:19], s56 offen lds
  s_add_u32 m0, s51, 3072
  s_add_u32 s56, s48, 111104
  buffer_load_dwordx4 v191, s[16:19], s56 offen lds
  v_add_u32 v138, 36864, v133
  v_add_u32 v142, 36864, v137
  ds_read_b128 v[104:107], v138
  ds_read_b128 v[108:111], v142 offset:0
  ds_read_b128 v[112:115], v142 offset:4096
  ds_read_b128 v[116:119], v142 offset:8192
  ds_read_b128 v[120:123], v142 offset:12288
  s_waitcnt lgkmcnt(5)
  v_mfma_f32_32x32x16_bf16 v[0:15], v[84:87], v[80:83], v[0:15]
  s_add_u32 m0, s52, 0
  s_add_u32 s56, s49, 512
  buffer_load_dwordx4 v192, s[16:19], s56 offen lds
  s_add_u32 m0, s52, 1024
  v_mfma_f32_32x32x16_bf16 v[16:31], v[88:91], v[80:83], v[16:31]
  s_add_u32 s56, s49, 37376
  buffer_load_dwordx4 v193, s[16:19], s56 offen lds
  s_add_u32 m0, s52, 2048
  s_add_u32 s56, s49, 74240
  v_mfma_f32_32x32x16_bf16 v[32:47], v[92:95], v[80:83], v[32:47]
  buffer_load_dwordx4 v192, s[16:19], s56 offen lds
  s_add_u32 m0, s52, 3072
  s_add_u32 s56, s49, 111104
  buffer_load_dwordx4 v193, s[16:19], s56 offen lds
  v_mfma_f32_32x32x16_bf16 v[48:63], v[96:99], v[80:83], v[48:63]
  v_add_u32 v138, 73728, v130
  v_add_u32 v142, 73728, v134
  ds_read_b128 v[80:83], v138
  ds_read_b128 v[84:87], v142 offset:0
  ds_read_b128 v[88:91], v142 offset:4096
  ds_read_b128 v[92:95], v142 offset:8192
  ds_read_b128 v[96:99], v142 offset:12288
  s_waitcnt lgkmcnt(5)
  v_mfma_f32_32x32x16_bf16 v[0:15], v[108:111], v[104:107], v[0:15]
  v_mfma_f32_32x32x16_bf16 v[16:31], v[112:115], v[104:107], v[16:31]
  v_mfma_f32_32x32x16_bf16 v[32:47], v[116:119], v[104:107], v[32:47]
  v_mfma_f32_32x32x16_bf16 v[48:63], v[120:123], v[104:107], v[48:63]
  v_add_u32 v138, 73728, v131
  v_add_u32 v142, 73728, v135
  ds_read_b128 v[104:107], v138
  ds_read_b128 v[108:111], v142 offset:0
  ds_read_b128 v[112:115], v142 offset:4096
  ds_read_b128 v[116:119], v142 offset:8192
  ds_read_b128 v[120:123], v142 offset:12288
  s_waitcnt lgkmcnt(5)
  v_mfma_f32_32x32x16_bf16 v[0:15], v[84:87], v[80:83], v[0:15]
  v_mfma_f32_32x32x16_bf16 v[16:31], v[88:91], v[80:83], v[16:31]
  v_mfma_f32_32x32x16_bf16 v[32:47], v[92:95], v[80:83], v[32:47]
  v_mfma_f32_32x32x16_bf16 v[48:63], v[96:99], v[80:83], v[48:63]
  v_add_u32 v138, 73728, v132
  v_add_u32 v142, 73728, v136
  ds_read_b128 v[80:83], v138
  ds_read_b128 v[84:87], v142 offset:0
  ds_read_b128 v[88:91], v142 offset:4096
  ds_read_b128 v[92:95], v142 offset:8192
  ds_read_b128 v[96:99], v142 offset:12288
  s_waitcnt lgkmcnt(5)
  v_mfma_f32_32x32x16_bf16 v[0:15], v[108:111], v[104:107], v[0:15]
  s_waitcnt vmcnt(8)
  s_barrier
  v_mfma_f32_32x32x16_bf16 v[16:31], v[112:115], v[104:107], v[16:31]
  s_add_u32 m0, s51, 36864
  s_add_u32 s56, s48, 640
  buffer_load_dwordx4 v190, s[16:19], s56 offen lds
  s_add_u32 m0, s51, 37888
  v_mfma_f32_32x32x16_bf16 v[32:47], v[116:119], v[104:107], v[32:47]
  s_add_u32 s56, s48, 37504
  buffer_load_dwordx4 v191, s[16:19], s56 offen lds
  s_add_u32 m0, s51, 38912
  s_add_u32 s56, s48, 74368
  v_mfma_f32_32x32x16_bf16 v[48:63], v[120:123], v[104:107], v[48:63]
  buffer_load_dwordx4 v190, s[16:19], s56 offen lds
  s_add_u32 m0, s51, 39936
  s_add_u32 s56, s48, 111232
  buffer_load_dwordx4 v191, s[16:19], s56 offen lds
  v_add_u32 v138, 73728, v133
  v_add_u32 v142, 73728, v137
  ds_read_b128 v[104:107], v138
  ds_read_b128 v[108:111], v142 offset:0
  ds_read_b128 v[112:115], v142 offset:4096
  ds_read_b128 v[116:119], v142 offset:8192
  ds_read_b128 v[120:123], v142 offset:12288
  s_waitcnt lgkmcnt(5)
  v_mfma_f32_32x32x16_bf16 v[0:15], v[84:87], v[80:83], v[0:15]
  s_add_u32 m0, s52, 36864
  s_add_u32 s56, s49, 640
  buffer_load_dwordx4 v192, s[16:19], s56 offen lds
  s_add_u32 m0, s52, 37888
  v_mfma_f32_32x32x16_bf16 v[16:31], v[88:91], v[80:83], v[16:31]
  s_add_u32 s56, s49, 37504
  buffer_load_dwordx4 v193, s[16:19], s56 offen lds
  s_add_u32 m0, s52, 38912
  s_add_u32 s56, s49, 74368
  v_mfma_f32_32x32x16_bf16 v[32:47], v[92:95], v[80:83], v[32:47]
  buffer_load_dwordx4 v192, s[16:19], s56 offen lds
  s_add_u32 m0, s52, 39936
  s_add_u32 s56, s49, 111232
  buffer_load_dwordx4 v193, s[16:19], s56 offen lds
  v_mfma_f32_32x32x16_bf16 v[48:63], v[96:99], v[80:83], v[48:63]
  v_add_u32 v138, 110592, v130
  v_add_u32 v142, 110592, v134
  ds_read_b128 v[80:83], v138
  ds_read_b128 v[84:87], v142 offset:0
  ds_read_b128 v[88:91], v142 offset:4096
  ds_read_b128 v[92:95], v142 offset:8192
  ds_read_b128 v[96:99], v142 offset:12288
  s_waitcnt lgkmcnt(5)
  v_mfma_f32_32x32x16_bf16 v[0:15], v[108:111], v[104:107], v[0:15]
  v_mfma_f32_32x32x16_bf16 v[16:31], v[112:115], v[104:107], v[16:31]
  v_mfma_f32_32x32x16_bf16 v[32:47], v[116:119], v[104:107], v[32:47]
  v_mfma_f32_32x32x16_bf16 v[48:63], v[120:123], v[104:107], v[48:63]
  v_add_u32 v138, 110592, v131
  v_add_u32 v142, 110592, v135
  ds_read_b128 v[104:107], v138
  ds_read_b128 v[108:111], v142 offset:0
  ds_read_b128 v[112:115], v142 offset:4096
  ds_read_b128 v[116:119], v142 offset:8192
  ds_read_b128 v[120:123], v142 offset:12288
  s_waitcnt lgkmcnt(5)
  v_mfma_f32_32x32x16_bf16 v[0:15], v[84:87], v[80:83], v[0:15]
  v_mfma_f32_32x32x16_bf16 v[16:31], v[88:91], v[80:83], v[16:31]
  v_mfma_f32_32x32x16_bf16 v[32:47], v[92:95], v[80:83], v[32:47]
  v_mfma_f32_32x32x16_bf16 v[48:63], v[96:99], v[80:83], v[48:63]
  v_add_u32 v138, 110592, v132
  v_add_u32 v142, 110592, v136
  ds_read_b128 v[80:83], v138
  ds_read_b128 v[84:87], v142 offset:0
  ds_read_b128 v[88:91], v142 offset:4096
  ds_read_b128 v[92:95], v142 offset:8192
  ds_read_b128 v[96:99], v142 offset:12288
  s_waitcnt lgkmcnt(5)
  v_mfma_f32_32x32x16_bf16 v[0:15], v[108:111], v[104:107], v[0:15]
  s_waitcnt vmcnt(8)
  s_barrier
  v_mfma_f32_32x32x16_bf16 v[16:31], v[112:115], v[104:107], v[16:31]
  s_add_u32 m0, s51, 73728
  s_add_u32 s56, s48, 768
  buffer_load_dwordx4 v190, s[16:19], s56 offen lds
  s_add_u32 m0, s51, 74752
  v_mfma_f32_32x32x16_bf16 v[32:47], v[116:119], v[104:107], v[32:47]
  s_add_u32 s56, s48, 37632
  buffer_load_dwordx4 v191, s[16:19], s56 offen lds
  s_add_u32 m0, s51, 75776
  s_add_u32 s56, s48, 74496
  v_mfma_f32_32x32x16_bf16 v[48:63], v[120:123], v[104:107], v[48:63]
  buffer_load_dwordx4 v190, s[16:19], s56 offen lds
  s_add_u32 m0, s51, 76800
  s_add_u32 s56, s48, 111360
  buffer_load_dwordx4 v191, s[16:19], s56 offen lds
  v_add_u32 v138, 110592, v133
  v_add_u32 v142, 110592, v137
  ds_read_b128 v[104:107], v138
  ds_read_b128 v[108:111], v142 offset:0
  ds_read_b128 v[112:115], v142 offset:4096
  ds_read_b128 v[116:119], v142 offset:8192
  ds_read_b128 v[120:123], v142 offset:12288
  s_waitcnt lgkmcnt(5)
  v_mfma_f32_32x32x16_bf16 v[0:15], v[84:87], v[80:83], v[0:15]
  s_add_u32 m0, s52, 73728
  s_add_u32 s56, s49, 768
  buffer_load_dwordx4 v192, s[16:19], s56 offen lds
  s_add_u32 m0, s52, 74752
  v_mfma_f32_32x32x16_bf16 v[16:31], v[88:91], v[80:83], v[16:31]
  s_add_u32 s56, s49, 37632
  buffer_load_dwordx4 v193, s[16:19], s56 offen lds
  s_add_u32 m0, s52, 75776
  s_add_u32 s56, s49, 74496
  v_mfma_f32_32x32x16_bf16 v[32:47], v[92:95], v[80:83], v[32:47]
  buffer_load_dwordx4 v192, s[16:19], s56 offen lds
  s_add_u32 m0, s52, 76800
  s_add_u32 s56, s49, 111360
  buffer_load_dwordx4 v193, s[16:19], s56 offen lds
  v_mfma_f32_32x32x16_bf16 v[48:63], v[96:99], v[80:83], v[48:63]
  v_add_u32 v138, 0, v130
  v_add_u32 v142, 0, v134
  ds_read_b128 v[80:83], v138
  ds_read_b128 v[84:87], v142 offset:0
  ds_read_b128 v[88:91], v142 offset:4096
  ds_read_b128 v[92:95], v142 offset:8192
  ds_read_b128 v[96:99], v142 offset:12288
  s_waitcnt lgkmcnt(5)
  v_mfma_f32_32x32x16_bf16 v[0:15], v[108:111], v[104:107], v[0:15]
  v_mfma_f32_32x32x16_bf16 v[16:31], v[112:115], v[104:107], v[16:31]
  v_mfma_f32_32x32x16_bf16 v[32:47], v[116:119], v[104:107], v[32:47]
  v_mfma_f32_32x32x16_bf16 v[48:63], v[120:123], v[104:107], v[48:63]
  v_add_u32 v138, 0, v131
  v_add_u32 v142, 0, v135
  ds_read_b128 v[104:107], v138
  ds_read_b128 v[108:111], v142 offset:0
  ds_read_b128 v[112:115], v142 offset:4096
  ds_read_b128 v[116:119], v142 offset:8192
  ds_read_b128 v[120:123], v142 offset:12288
  s_waitcnt lgkmcnt(5)
  v_mfma_f32_32x32x16_bf16 v[0:15], v[84:87], v[80:83], v[0:15]
  v_mfma_f32_32x32x16_bf16 v[16:31], v[88:91], v[80:83], v[16:31]
  v_mfma_f32_32x32x16_bf16 v[32:47], v[92:95], v[80:83], v[32:47]
  v_mfma_f32_32x32x16_bf16 v[48:63], v[96:99], v[80:83], v[48:63]
  v_add_u32 v138, 0, v132
  v_add_u32 v142, 0, v136
  ds_read_b128 v[80:83], v138
  ds_read_b128 v[84:87], v142 offset:0
  ds_read_b128 v[88:91], v142 offset:4096
  ds_read_b128 v[92:95], v142 offset:8192
  ds_read_b128 v[96:99], v142 offset:12288
  s_waitcnt lgkmcnt(5)
  v_mfma_f32_32x32x16_bf16 v[0:15], v[108:111], v[104:107], v[0:15]
  s_waitcnt vmcnt(8)
  s_barrier
  v_mfma_f32_32x32x16_bf16 v[16:31], v[112:115], v[104:107], v[16:31]
  s_add_u32 m0, s51, 110592
  s_add_u32 s56, s48, 896
  buffer_load_dwordx4 v190, s[16:19], s56 offen lds
  s_add_u32 m0, s51, 111616
  v_mfma_f32_32x32x16_bf16 v[32:47], v[116:119], v[104:107], v[32:47]
  s_add_u32 s56, s48, 37760
  buffer_load_dwordx4 v191, s[16:19], s56 offen lds
  s_add_u32 m0, s51, 112640
  s_add_u32 s56, s48, 74624
  v_mfma_f32_32x32x16_bf16 v[48:63], v[120:123], v[104:107], v[48:63]
  buffer_load_dwordx4 v190, s[16:19], s56 offen lds
  s_add_u32 m0, s51, 113664
  s_add_u32 s56, s48, 111488
  buffer_load_dwordx4 v191, s[16:19], s56 offen lds
  v_add_u32 v138, 0, v133
  v_add_u32 v142, 0, v137
  ds_read_b128 v[104:107], v138
  ds_read_b128 v[108:111], v142 offset:0
  ds_read_b128 v[112:115], v142 offset:4096
  ds_read_b128 v[116:119], v142 offset:8192
  ds_read_b128 v[120:123], v142 offset:12288
  s_waitcnt lgkmcnt(5)
  v_mfma_f32_32x32x16_bf16 v[0:15], v[84:87], v[80:83], v[0:15]
  s_add_u32 m0, s52, 110592
  s_add_u32 s56, s49, 896
  buffer_load_dwordx4 v192, s[16:19], s56 offen lds
  s_add_u32 m0, s52, 111616
  v_mfma_f32_32x32x16_bf16 v[16:31], v[88:91], v[80:83], v[16:31]
  s_add_u32 s56, s49, 37760
  buffer_load_dwordx4 v193, s[16:19], s56 offen lds
  s_add_u32 m0, s52, 112640
  s_add_u32 s56, s49, 74624
  v_mfma_f32_32x32x16_bf16 v[32:47], v[92:95], v[80:83], v[32:47]
  buffer_load_dwordx4 v192, s[16:19], s56 offen lds
  s_add_u32 m0, s52, 113664
  s_add_u32 s56, s49, 111488
  buffer_load_dwordx4 v193, s[16:19], s56 offen lds
  v_mfma_f32_32x32x16_bf16 v[48:63], v[96:99], v[80:83], v[48:63]
  v_add_u32 v138, 36864, v130
  v_add_u32 v142, 36864, v134
  ds_read_b128 v[80:83], v138
  ds_read_b128 v[84:87], v142 offset:0
  ds_read_b128 v[88:91], v142 offset:4096
  ds_read_b128 v[92:95], v142 offset:8192
  ds_read_b128 v[96:99], v142 offset:12288
  s_waitcnt lgkmcnt(5)
  v_mfma_f32_32x32x16_bf16 v[0:15], v[108:111], v[104:107], v[0:15]
  v_mfma_f32_32x32x16_bf16 v[16:31], v[112:115], v[104:107], v[16:31]
  v_mfma_f32_32x32x16_bf16 v[32:47], v[116:119], v[104:107], v[32:47]
  v_mfma_f32_32x32x16_bf16 v[48:63], v[120:123], v[104:107], v[48:63]
  v_add_u32 v138, 36864, v131
  v_add_u32 v142, 36864, v135
  ds_read_b128 v[104:107], v138
  ds_read_b128 v[108:111], v142 offset:0
  ds_read_b128 v[112:115], v142 offset:4096
  ds_read_b128 v[116:119], v142 offset:8192
  ds_read_b128 v[120:123], v142 offset:12288
  s_waitcnt lgkmcnt(5)
  v_mfma_f32_32x32x16_bf16 v[0:15], v[84:87], v[80:83], v[0:15]
  v_mfma_f32_32x32x16_bf16 v[16:31], v[88:91], v[80:83], v[16:31]
  v_mfma_f32_32x32x16_bf16 v[32:47], v[92:95], v[80:83], v[32:47]
  v_mfma_f32_32x32x16_bf16 v[48:63], v[96:99], v[80:83], v[48:63]
  v_add_u32 v138, 36864, v132
  v_add_u32 v142, 36864, v136
  ds_read_b128 v[80:83], v138
  ds_read_b128 v[84:87], v142 offset:0
  ds_read_b128 v[88:91], v142 offset:4096
  ds_read_b128 v[92:95], v142 offset:8192
  ds_read_b128 v[96:99], v142 offset:12288
  s_waitcnt lgkmcnt(5)
  v_mfma_f32_32x32x16_bf16 v[0:15], v[108:111], v[104:107], v[0:15]
  s_waitcnt vmcnt(8)
  s_barrier
  v_mfma_f32_32x32x16_bf16 v[16:31], v[112:115], v[104:107], v[16:31]
  s_add_u32 m0, s51, 0
  s_add_u32 s56, s48, 1024
  buffer_load_dwordx4 v190, s[16:19], s56 offen lds
  s_add_u32 m0, s51, 1024
  v_mfma_f32_32x32x16_bf16 v[32:47], v[116:119], v[104:107], v[32:47]
  s_add_u32 s56, s48, 37888
  buffer_load_dwordx4 v191, s[16:19], s56 offen lds
  s_add_u32 m0, s51, 2048
  s_add_u32 s56, s48, 74752
  v_mfma_f32_32x32x16_bf16 v[48:63], v[120:123], v[104:107], v[48:63]
  buffer_load_dwordx4 v190, s[16:19], s56 offen lds
  s_add_u32 m0, s51, 3072
  s_add_u32 s56, s48, 111616
  buffer_load_dwordx4 v191, s[16:19], s56 offen lds
  v_add_u32 v138, 36864, v133
  v_add_u32 v142, 36864, v137
  ds_read_b128 v[104:107], v138
  ds_read_b128 v[108:111], v142 offset:0
  ds_read_b128 v[112:115], v142 offset:4096
  ds_read_b128 v[116:119], v142 offset:8192
  ds_read_b128 v[120:123], v142 offset:12288
  s_waitcnt lgkmcnt(5)
  v_mfma_f32_32x32x16_bf16 v[0:15], v[84:87], v[80:83], v[0:15]
  s_add_u32 m0, s52, 0
  s_add_u32 s56, s49, 1024
  buffer_load_dwordx4 v192, s[16:19], s56 offen lds
  s_add_u32 m0, s52, 1024
  v_mfma_f32_32x32x16_bf16 v[16:31], v[88:91], v[80:83], v[16:31]
  s_add_u32 s56, s49, 37888
  buffer_load_dwordx4 v193, s[16:19], s56 offen lds
  s_add_u32 m0, s52, 2048
  s_add_u32 s56, s49, 74752
  v_mfma_f32_32x32x16_bf16 v[32:47], v[92:95], v[80:83], v[32:47]
  buffer_load_dwordx4 v192, s[16:19], s56 offen lds
  s_add_u32 m0, s52, 3072
  s_add_u32 s56, s49, 111616
  buffer_load_dwordx4 v193, s[16:19], s56 offen lds
  v_mfma_f32_32x32x16_bf16 v[48:63], v[96:99], v[80:83], v[48:63]
  v_add_u32 v138, 73728, v130
  v_add_u32 v142, 73728, v134
  ds_read_b128 v[80:83], v138
  ds_read_b128 v[84:87], v142 offset:0
  ds_read_b128 v[88:91], v142 offset:4096
  ds_read_b128 v[92:95], v142 offset:8192
  ds_read_b128 v[96:99], v142 offset:12288
  s_waitcnt lgkmcnt(5)
  v_mfma_f32_32x32x16_bf16 v[0:15], v[108:111], v[104:107], v[0:15]
  v_mfma_f32_32x32x16_bf16 v[16:31], v[112:115], v[104:107], v[16:31]
  v_mfma_f32_32x32x16_bf16 v[32:47], v[116:119], v[104:107], v[32:47]
  v_mfma_f32_32x32x16_bf16 v[48:63], v[120:123], v[104:107], v[48:63]
  v_add_u32 v138, 73728, v131
  v_add_u32 v142, 73728, v135
  ds_read_b128 v[104:107], v138
  ds_read_b128 v[108:111], v142 offset:0
  ds_read_b128 v[112:115], v142 offset:4096
  ds_read_b128 v[116:119], v142 offset:8192
  ds_read_b128 v[120:123], v142 offset:12288
  s_waitcnt lgkmcnt(5)
  v_mfma_f32_32x32x16_bf16 v[0:15], v[84:87], v[80:83], v[0:15]
  v_mfma_f32_32x32x16_bf16 v[16:31], v[88:91], v[80:83], v[16:31]
  v_mfma_f32_32x32x16_bf16 v[32:47], v[92:95], v[80:83], v[32:47]
  v_mfma_f32_32x32x16_bf16 v[48:63], v[96:99], v[80:83], v[48:63]
  v_add_u32 v138, 73728, v132
  v_add_u32 v142, 73728, v136
  ds_read_b128 v[80:83], v138
  ds_read_b128 v[84:87], v142 offset:0
  ds_read_b128 v[88:91], v142 offset:4096
  ds_read_b128 v[92:95], v142 offset:8192
  ds_read_b128 v[96:99], v142 offset:12288
  s_waitcnt lgkmcnt(5)
  v_mfma_f32_32x32x16_bf16 v[0:15], v[108:111], v[104:107], v[0:15]
  s_waitcnt vmcnt(8)
  s_barrier
  v_mfma_f32_32x32x16_bf16 v[16:31], v[112:115], v[104:107], v[16:31]
  s_add_u32 m0, s51, 36864
  s_add_u32 s56, s48, 1152
  buffer_load_dwordx4 v190, s[16:19], s56 offen lds
  s_add_u32 m0, s51, 37888
  v_mfma_f32_32x32x16_bf16 v[32:47], v[116:119], v[104:107], v[32:47]
  s_add_u32 s56, s48, 38016
  buffer_load_dwordx4 v191, s[16:19], s56 offen lds
  s_add_u32 m0, s51, 38912
  s_add_u32 s56, s48, 74880
  v_mfma_f32_32x32x16_bf16 v[48:63], v[120:123], v[104:107], v[48:63]
  buffer_load_dwordx4 v190, s[16:19], s56 offen lds
  s_add_u32 m0, s51, 39936
  s_add_u32 s56, s48, 111744
  buffer_load_dwordx4 v191, s[16:19], s56 offen lds
  v_add_u32 v138, 73728, v133
  v_add_u32 v142, 73728, v137
  ds_read_b128 v[104:107], v138
  ds_read_b128 v[108:111], v142 offset:0
  ds_read_b128 v[112:115], v142 offset:4096
  ds_read_b128 v[116:119], v142 offset:8192
  ds_read_b128 v[120:123], v142 offset:12288
  s_waitcnt lgkmcnt(5)
  v_mfma_f32_32x32x16_bf16 v[0:15], v[84:87], v[80:83], v[0:15]
  s_add_u32 m0, s52, 36864
  s_add_u32 s56, s49, 1152
  buffer_load_dwordx4 v192, s[16:19], s56 offen lds
  s_add_u32 m0, s52, 37888
  v_mfma_f32_32x32x16_bf16 v[16:31], v[88:91], v[80:83], v[16:31]
  s_add_u32 s56, s49, 38016
  buffer_load_dwordx4 v193, s[16:19], s56 offen lds
  s_add_u32 m0, s52, 38912
  s_add_u32 s56, s49, 74880
  v_mfma_f32_32x32x16_bf16 v[32:47], v[92:95], v[80:83], v[32:47]
  buffer_load_dwordx4 v192, s[16:19], s56 offen lds
  s_add_u32 m0, s52, 39936
  s_add_u32 s56, s49, 111744
  buffer_load_dwordx4 v193, s[16:19], s56 offen lds
  v_mfma_f32_32x32x16_bf16 v[48:63], v[96:99], v[80:83], v[48:63]
  v_add_u32 v138, 110592, v130
  v_add_u32 v142, 110592, v134
  ds_read_b128 v[80:83], v138
  ds_read_b128 v[84:87], v142 offset:0
  ds_read_b128 v[88:91], v142 offset:4096
  ds_read_b128 v[92:95], v142 offset:8192
  ds_read_b128 v[96:99], v142 offset:12288
  s_waitcnt lgkmcnt(5)
  v_mfma_f32_32x32x16_bf16 v[0:15], v[108:111], v[104:107], v[0:15]
  v_mfma_f32_32x32x16_bf16 v[16:31], v[112:115], v[104:107], v[16:31]
  v_mfma_f32_32x32x16_bf16 v[32:47], v[116:119], v[104:107], v[32:47]
  v_mfma_f32_32x32x16_bf16 v[48:63], v[120:123], v[104:107], v[48:63]
  v_add_u32 v138, 110592, v131
  v_add_u32 v142, 110592, v135
  ds_read_b128 v[104:107], v138
  ds_read_b128 v[108:111], v142 offset:0
  ds_read_b128 v[112:115], v142 offset:4096
  ds_read_b128 v[116:119], v142 offset:8192
  ds_read_b128 v[120:123], v142 offset:12288
  s_waitcnt lgkmcnt(5)
  v_mfma_f32_32x32x16_bf16 v[0:15], v[84:87], v[80:83], v[0:15]
  v_mfma_f32_32x32x16_bf16 v[16:31], v[88:91], v[80:83], v[16:31]
  v_mfma_f32_32x32x16_bf16 v[32:47], v[92:95], v[80:83], v[32:47]
  v_mfma_f32_32x32x16_bf16 v[48:63], v[96:99], v[80:83], v[48:63]
  v_add_u32 v138, 110592, v132
  v_add_u32 v142, 110592, v136
  ds_read_b128 v[80:83], v138
  ds_read_b128 v[84:87], v142 offset:0
  ds_read_b128 v[88:91], v142 offset:4096
  ds_read_b128 v[92:95], v142 offset:8192
  ds_read_b128 v[96:99], v142 offset:12288
  s_waitcnt lgkmcnt(5)
  v_mfma_f32_32x32x16_bf16 v[0:15], v[108:111], v[104:107], v[0:15]
  s_waitcnt vmcnt(8)
  s_barrier
  v_mfma_f32_32x32x16_bf16 v[16:31], v[112:115], v[104:107], v[16:31]
  s_add_u32 m0, s51, 73728
  s_add_u32 s56, s48, 1280
  buffer_load_dwordx4 v190, s[16:19], s56 offen lds
  s_add_u32 m0, s51, 74752
  v_mfma_f32_32x32x16_bf16 v[32:47], v[116:119], v[104:107], v[32:47]
  s_add_u32 s56, s48, 38144
  buffer_load_dwordx4 v191, s[16:19], s56 offen lds
  s_add_u32 m0, s51, 75776
  s_add_u32 s56, s48, 75008
  v_mfma_f32_32x32x16_bf16 v[48:63], v[120:123], v[104:107], v[48:63]
  buffer_load_dwordx4 v190, s[16:19], s56 offen lds
  s_add_u32 m0, s51, 76800
  s_add_u32 s56, s48, 111872
  buffer_load_dwordx4 v191, s[16:19], s56 offen lds
  v_add_u32 v138, 110592, v133
  v_add_u32 v142, 110592, v137
  ds_read_b128 v[104:107], v138
  ds_read_b128 v[108:111], v142 offset:0
  ds_read_b128 v[112:115], v142 offset:4096
  ds_read_b128 v[116:119], v142 offset:8192
  ds_read_b128 v[120:123], v142 offset:12288
  s_waitcnt lgkmcnt(5)
  v_mfma_f32_32x32x16_bf16 v[0:15], v[84:87], v[80:83], v[0:15]
  s_add_u32 m0, s52, 73728
  s_add_u32 s56, s49, 1280
  buffer_load_dwordx4 v192, s[16:19], s56 offen lds
  s_add_u32 m0, s52, 74752
  v_mfma_f32_32x32x16_bf16 v[16:31], v[88:91], v[80:83], v[16:31]
  s_add_u32 s56, s49, 38144
  buffer_load_dwordx4 v193, s[16:19], s56 offen lds
  s_add_u32 m0, s52, 75776
  s_add_u32 s56, s49, 75008
  v_mfma_f32_32x32x16_bf16 v[32:47], v[92:95], v[80:83], v[32:47]
  buffer_load_dwordx4 v192, s[16:19], s56 offen lds
  s_add_u32 m0, s52, 76800
  s_add_u32 s56, s49, 111872
  buffer_load_dwordx4 v193, s[16:19], s56 offen lds
  v_mfma_f32_32x32x16_bf16 v[48:63], v[96:99], v[80:83], v[48:63]
  v_add_u32 v138, 0, v130
  v_add_u32 v142, 0, v134
  ds_read_b128 v[80:83], v138
  ds_read_b128 v[84:87], v142 offset:0
  ds_read_b128 v[88:91], v142 offset:4096
  ds_read_b128 v[92:95], v142 offset:8192
  ds_read_b128 v[96:99], v142 offset:12288
  s_waitcnt lgkmcnt(5)
  v_mfma_f32_32x32x16_bf16 v[0:15], v[108:111], v[104:107], v[0:15]
  v_mfma_f32_32x32x16_bf16 v[16:31], v[112:115], v[104:107], v[16:31]
  v_mfma_f32_32x32x16_bf16 v[32:47], v[116:119], v[104:107], v[32:47]
  v_mfma_f32_32x32x16_bf16 v[48:63], v[120:123], v[104:107], v[48:63]
  v_add_u32 v138, 0, v131
  v_add_u32 v142, 0, v135
  ds_read_b128 v[104:107], v138
  ds_read_b128 v[108:111], v142 offset:0
  ds_read_b128 v[112:115], v142 offset:4096
  ds_read_b128 v[116:119], v142 offset:8192
  ds_read_b128 v[120:123], v142 offset:12288
  s_waitcnt lgkmcnt(5)
  v_mfma_f32_32x32x16_bf16 v[0:15], v[84:87], v[80:83], v[0:15]
  v_mfma_f32_32x32x16_bf16 v[16:31], v[88:91], v[80:83], v[16:31]
  v_mfma_f32_32x32x16_bf16 v[32:47], v[92:95], v[80:83], v[32:47]
  v_mfma_f32_32x32x16_bf16 v[48:63], v[96:99], v[80:83], v[48:63]
  v_add_u32 v138, 0, v132
  v_add_u32 v142, 0, v136
  ds_read_b128 v[80:83], v138
  ds_read_b128 v[84:87], v142 offset:0
  ds_read_b128 v[88:91], v142 offset:4096
  ds_read_b128 v[92:95], v142 offset:8192
  ds_read_b128 v[96:99], v142 offset:12288
  s_waitcnt lgkmcnt(5)
  v_mfma_f32_32x32x16_bf16 v[0:15], v[108:111], v[104:107], v[0:15]
  s_waitcnt vmcnt(8)
  s_barrier
  v_mfma_f32_32x32x16_bf16 v[16:31], v[112:115], v[104:107], v[16:31]
  s_add_u32 m0, s51, 110592
  s_add_u32 s56, s48, 1408
  buffer_load_dwordx4 v190, s[16:19], s56 offen lds
  s_add_u32 m0, s51, 111616
  v_mfma_f32_32x32x16_bf16 v[32:47], v[116:119], v[104:107], v[32:47]
  s_add_u32 s56, s48, 38272
  buffer_load_dwordx4 v191, s[16:19], s56 offen lds
  s_add_u32 m0, s51, 112640
  s_add_u32 s56, s48, 75136
  v_mfma_f32_32x32x16_bf16 v[48:63], v[120:123], v[104:107], v[48:63]
  buffer_load_dwordx4 v190, s[16:19], s56 offen lds
  s_add_u32 m0, s51, 113664
  s_add_u32 s56, s48, 112000
  buffer_load_dwordx4 v191, s[16:19], s56 offen lds
  v_add_u32 v138, 0, v133
  v_add_u32 v142, 0, v137
  ds_read_b128 v[104:107], v138
  ds_read_b128 v[108:111], v142 offset:0
  ds_read_b128 v[112:115], v142 offset:4096
  ds_read_b128 v[116:119], v142 offset:8192
  ds_read_b128 v[120:123], v142 offset:12288
  s_waitcnt lgkmcnt(5)
  v_mfma_f32_32x32x16_bf16 v[0:15], v[84:87], v[80:83], v[0:15]
  s_add_u32 m0, s52, 110592
  s_add_u32 s56, s49, 1408
  buffer_load_dwordx4 v192, s[16:19], s56 offen lds
  s_add_u32 m0, s52, 111616
  v_mfma_f32_32x32x16_bf16 v[16:31], v[88:91], v[80:83], v[16:31]
  s_add_u32 s56, s49, 38272
  buffer_load_dwordx4 v193, s[16:19], s56 offen lds
  s_add_u32 m0, s52, 112640
  s_add_u32 s56, s49, 75136
  v_mfma_f32_32x32x16_bf16 v[32:47], v[92:95], v[80:83], v[32:47]
  buffer_load_dwordx4 v192, s[16:19], s56 offen lds
  s_add_u32 m0, s52, 113664
  s_add_u32 s56, s49, 112000
  buffer_load_dwordx4 v193, s[16:19], s56 offen lds
  v_mfma_f32_32x32x16_bf16 v[48:63], v[96:99], v[80:83], v[48:63]
  v_add_u32 v138, 36864, v130
  v_add_u32 v142, 36864, v134
  ds_read_b128 v[80:83], v138
  ds_read_b128 v[84:87], v142 offset:0
  ds_read_b128 v[88:91], v142 offset:4096
  ds_read_b128 v[92:95], v142 offset:8192
  ds_read_b128 v[96:99], v142 offset:12288
  s_waitcnt lgkmcnt(5)
  v_mfma_f32_32x32x16_bf16 v[0:15], v[108:111], v[104:107], v[0:15]
  v_mfma_f32_32x32x16_bf16 v[16:31], v[112:115], v[104:107], v[16:31]
  v_mfma_f32_32x32x16_bf16 v[32:47], v[116:119], v[104:107], v[32:47]
  v_mfma_f32_32x32x16_bf16 v[48:63], v[120:123], v[104:107], v[48:63]
  v_add_u32 v138, 36864, v131
  v_add_u32 v142, 36864, v135
  ds_read_b128 v[104:107], v138
  ds_read_b128 v[108:111], v142 offset:0
  ds_read_b128 v[112:115], v142 offset:4096
  ds_read_b128 v[116:119], v142 offset:8192
  ds_read_b128 v[120:123], v142 offset:12288
  s_waitcnt lgkmcnt(5)
  v_mfma_f32_32x32x16_bf16 v[0:15], v[84:87], v[80:83], v[0:15]
  v_mfma_f32_32x32x16_bf16 v[16:31], v[88:91], v[80:83], v[16:31]
  v_mfma_f32_32x32x16_bf16 v[32:47], v[92:95], v[80:83], v[32:47]
  v_mfma_f32_32x32x16_bf16 v[48:63], v[96:99], v[80:83], v[48:63]
  v_add_u32 v138, 36864, v132
  v_add_u32 v142, 36864, v136
  ds_read_b128 v[80:83], v138
  ds_read_b128 v[84:87], v142 offset:0
  ds_read_b128 v[88:91], v142 offset:4096
  ds_read_b128 v[92:95], v142 offset:8192
  ds_read_b128 v[96:99], v142 offset:12288
  s_waitcnt lgkmcnt(5)
  v_mfma_f32_32x32x16_bf16 v[0:15], v[108:111], v[104:107], v[0:15]
  s_waitcnt vmcnt(8)
  s_barrier
  v_mfma_f32_32x32x16_bf16 v[16:31], v[112:115], v[104:107], v[16:31]
  v_mfma_f32_32x32x16_bf16 v[32:47], v[116:119], v[104:107], v[32:47]
  v_mfma_f32_32x32x16_bf16 v[48:63], v[120:123], v[104:107], v[48:63]
  v_add_u32 v138, 36864, v133
  v_add_u32 v142, 36864, v137
  ds_read_b128 v[104:107], v138
  ds_read_b128 v[108:111], v142 offset:0
  ds_read_b128 v[112:115], v142 offset:4096
  ds_read_b128 v[116:119], v142 offset:8192
  ds_read_b128 v[120:123], v142 offset:12288
  s_waitcnt lgkmcnt(5)
  v_mfma_f32_32x32x16_bf16 v[0:15], v[84:87], v[80:83], v[0:15]
  v_mfma_f32_32x32x16_bf16 v[16:31], v[88:91], v[80:83], v[16:31]
  v_mfma_f32_32x32x16_bf16 v[32:47], v[92:95], v[80:83], v[32:47]
  v_mfma_f32_32x32x16_bf16 v[48:63], v[96:99], v[80:83], v[48:63]
  v_add_u32 v138, 73728, v130
  v_add_u32 v142, 73728, v134
  ds_read_b128 v[80:83], v138
  ds_read_b128 v[84:87], v142 offset:0
  ds_read_b128 v[88:91], v142 offset:4096
  ds_read_b128 v[92:95], v142 offset:8192
  ds_read_b128 v[96:99], v142 offset:12288
  s_waitcnt lgkmcnt(5)
  v_mfma_f32_32x32x16_bf16 v[0:15], v[108:111], v[104:107], v[0:15]
  v_mfma_f32_32x32x16_bf16 v[16:31], v[112:115], v[104:107], v[16:31]
  v_mfma_f32_32x32x16_bf16 v[32:47], v[116:119], v[104:107], v[32:47]
  v_mfma_f32_32x32x16_bf16 v[48:63], v[120:123], v[104:107], v[48:63]
  v_add_u32 v138, 73728, v131
  v_add_u32 v142, 73728, v135
  ds_read_b128 v[104:107], v138
  ds_read_b128 v[108:111], v142 offset:0
  ds_read_b128 v[112:115], v142 offset:4096
  ds_read_b128 v[116:119], v142 offset:8192
  ds_read_b128 v[120:123], v142 offset:12288
  s_waitcnt lgkmcnt(5)
  v_mfma_f32_32x32x16_bf16 v[0:15], v[84:87], v[80:83], v[0:15]
  v_mfma_f32_32x32x16_bf16 v[16:31], v[88:91], v[80:83], v[16:31]
  v_mfma_f32_32x32x16_bf16 v[32:47], v[92:95], v[80:83], v[32:47]
  v_mfma_f32_32x32x16_bf16 v[48:63], v[96:99], v[80:83], v[48:63]
  v_add_u32 v138, 73728, v132
  v_add_u32 v142, 73728, v136
  ds_read_b128 v[80:83], v138
  ds_read_b128 v[84:87], v142 offset:0
  ds_read_b128 v[88:91], v142 offset:4096
  ds_read_b128 v[92:95], v142 offset:8192
  ds_read_b128 v[96:99], v142 offset:12288
  s_waitcnt lgkmcnt(5)
  v_mfma_f32_32x32x16_bf16 v[0:15], v[108:111], v[104:107], v[0:15]
  s_waitcnt vmcnt(0)
  s_barrier
  v_mfma_f32_32x32x16_bf16 v[16:31], v[112:115], v[104:107], v[16:31]
  v_mfma_f32_32x32x16_bf16 v[32:47], v[116:119], v[104:107], v[32:47]
  v_mfma_f32_32x32x16_bf16 v[48:63], v[120:123], v[104:107], v[48:63]
  v_add_u32 v138, 73728, v133
  v_add_u32 v142, 73728, v137
  ds_read_b128 v[104:107], v138
  ds_read_b128 v[108:111], v142 offset:0
  ds_read_b128 v[112:115], v142 offset:4096
  ds_read_b128 v[116:119], v142 offset:8192
  ds_read_b128 v[120:123], v142 offset:12288
  s_waitcnt lgkmcnt(5)
  v_mfma_f32_32x32x16_bf16 v[0:15], v[84:87], v[80:83], v[0:15]
  v_mfma_f32_32x32x16_bf16 v[16:31], v[88:91], v[80:83], v[16:31]
  v_mfma_f32_32x32x16_bf16 v[32:47], v[92:95], v[80:83], v[32:47]
  v_mfma_f32_32x32x16_bf16 v[48:63], v[96:99], v[80:83], v[48:63]
  v_add_u32 v138, 110592, v130
  v_add_u32 v142, 110592, v134
  ds_read_b128 v[80:83], v138
  ds_read_b128 v[84:87], v142 offset:0
  ds_read_b128 v[88:91], v142 offset:4096
  ds_read_b128 v[92:95], v142 offset:8192
  ds_read_b128 v[96:99], v142 offset:12288
  s_waitcnt lgkmcnt(5)
  v_mfma_f32_32x32x16_bf16 v[0:15], v[108:111], v[104:107], v[0:15]
  v_mfma_f32_32x32x16_bf16 v[16:31], v[112:115], v[104:107], v[16:31]
  v_mfma_f32_32x32x16_bf16 v[32:47], v[116:119], v[104:107], v[32:47]
  v_mfma_f32_32x32x16_bf16 v[48:63], v[120:123], v[104:107], v[48:63]
  v_add_u32 v138, 110592, v131
  v_add_u32 v142, 110592, v135
  ds_read_b128 v[104:107], v138
  ds_read_b128 v[108:111], v142 offset:0
  ds_read_b128 v[112:115], v142 offset:4096
  ds_read_b128 v[116:119], v142 offset:8192
  ds_read_b128 v[120:123], v142 offset:12288
  s_waitcnt lgkmcnt(5)
  v_mfma_f32_32x32x16_bf16 v[0:15], v[84:87], v[80:83], v[0:15]
  v_mfma_f32_32x32x16_bf16 v[16:31], v[88:91], v[80:83], v[16:31]
  v_mfma_f32_32x32x16_bf16 v[32:47], v[92:95], v[80:83], v[32:47]
  v_mfma_f32_32x32x16_bf16 v[48:63], v[96:99], v[80:83], v[48:63]
  v_add_u32 v138, 110592, v132
  v_add_u32 v142, 110592, v136
  ds_read_b128 v[80:83], v138
  ds_read_b128 v[84:87], v142 offset:0
  ds_read_b128 v[88:91], v142 offset:4096
  ds_read_b128 v[92:95], v142 offset:8192
  ds_read_b128 v[96:99], v142 offset:12288
  s_waitcnt lgkmcnt(5)
  v_mfma_f32_32x32x16_bf16 v[0:15], v[108:111], v[104:107], v[0:15]
  v_mfma_f32_32x32x16_bf16 v[16:31], v[112:115], v[104:107], v[16:31]
  v_mfma_f32_32x32x16_bf16 v[32:47], v[116:119], v[104:107], v[32:47]
  v_mfma_f32_32x32x16_bf16 v[48:63], v[120:123], v[104:107], v[48:63]
  v_add_u32 v138, 110592, v133
  v_add_u32 v142, 110592, v137
  ds_read_b128 v[104:107], v138
  ds_read_b128 v[108:111], v142 offset:0
  ds_read_b128 v[112:115], v142 offset:4096
  ds_read_b128 v[116:119], v142 offset:8192
  ds_read_b128 v[120:123], v142 offset:12288
  s_waitcnt lgkmcnt(5)
  v_mfma_f32_32x32x16_bf16 v[0:15], v[84:87], v[80:83], v[0:15]
  v_mfma_f32_32x32x16_bf16 v[16:31], v[88:91], v[80:83], v[16:31]
  v_mfma_f32_32x32x16_bf16 v[32:47], v[92:95], v[80:83], v[32:47]
  v_mfma_f32_32x32x16_bf16 v[48:63], v[96:99], v[80:83], v[48:63]
  s_waitcnt lgkmcnt(0)
  v_mfma_f32_32x32x16_bf16 v[0:15], v[108:111], v[104:107], v[0:15]
  v_mfma_f32_32x32x16_bf16 v[16:31], v[112:115], v[104:107], v[16:31]
  v_mfma_f32_32x32x16_bf16 v[32:47], v[116:119], v[104:107], v[32:47]
  v_mfma_f32_32x32x16_bf16 v[48:63], v[120:123], v[104:107], v[48:63]
  v_lshlrev_b32 v208, 6, v201
  v_add_u32 v208, v208, v200
  v_lshlrev_b32 v208, 6, v201
  v_add_u32 v208, v208, v200
  s_lshr_b32 s100, s2, 3
  s_cmp_ge_u32 s100, 18
  s_cbranch_scc1 PFW_k3S4
  s_lshl_b32 s100, s100, 8
  v_add_u32 v209, s100, v208
  v_mul_u32_u24 v210, 10923, v209
  v_lshrrev_b32 v210, 16, v210
  v_mul_u32_u24 v211, 6, v210
  v_sub_u32 v211, v209, v211
  v_mul_u32_u24 v210, 1536, v210
  v_lshl_add_u32 v210, v211, 7, v210
  s_and_b32 s100, s2, 1
  s_mul_i32 s100, s100, 768
  v_add_u32 v210, s100, v210
  s_waitcnt lgkmcnt(0)
  global_load_dword v211, v210, s[10:11]
PFW_k3S4:

  s_nop 15
  s_nop 7
  v_max3_f32 v150, v0, v1, v2
  v_max3_f32 v151, v3, v4, v5
  v_max3_f32 v150, v150, v6, v7
  v_max3_f32 v151, v151, v8, v9
  v_max3_f32 v150, v150, v10, v11
  v_max3_f32 v151, v151, v12, v13
  v_max3_f32 v150, v150, v14, v15
  v_max3_f32 v151, v151, v16, v17
  v_max3_f32 v150, v150, v18, v19
  v_max3_f32 v151, v151, v20, v21
  v_max3_f32 v150, v150, v22, v23
  v_max3_f32 v151, v151, v24, v25
  v_max3_f32 v150, v150, v26, v27
  v_max3_f32 v151, v151, v28, v29
  v_max3_f32 v150, v150, v30, v31
  v_max3_f32 v151, v151, v32, v33
  v_max3_f32 v150, v150, v34, v35
  v_max3_f32 v151, v151, v36, v37
  v_max3_f32 v150, v150, v38, v39
  v_max3_f32 v151, v151, v40, v41
  v_max3_f32 v150, v150, v42, v43
  v_max3_f32 v151, v151, v44, v45
  v_max3_f32 v150, v150, v46, v47
  v_max3_f32 v151, v151, v48, v49
  v_max3_f32 v150, v150, v50, v51
  v_max3_f32 v151, v151, v52, v53
  v_max3_f32 v150, v150, v54, v55
  v_max3_f32 v151, v151, v56, v57
  v_max3_f32 v150, v150, v58, v59
  v_max3_f32 v151, v151, v60, v61
  v_max3_f32 v150, v150, v62, v63
  v_max_f32 v150, v150, v151
  v_mov_b32 v151, v150
  s_nop 1
  v_permlane32_swap_b32 v150, v151
  s_nop 1
  v_max_f32 v150, v150, v151
  s_mov_b32 s53, 0x3d553b95
  v_mul_f32 v150, s53, v150
  v_sub_f32 v152, 0, v150
  v_mov_b32 v153, s53

  v_fma_f32 v0, v0, v153, v152
  v_fma_f32 v1, v1, v153, v152
  v_fma_f32 v2, v2, v153, v152
  v_fma_f32 v3, v3, v153, v152
  v_fma_f32 v4, v4, v153, v152
  v_fma_f32 v5, v5, v153, v152
  v_fma_f32 v6, v6, v153, v152
  v_fma_f32 v7, v7, v153, v152
  v_fma_f32 v8, v8, v153, v152
  v_fma_f32 v9, v9, v153, v152
  v_fma_f32 v10, v10, v153, v152
  v_fma_f32 v11, v11, v153, v152
  v_fma_f32 v12, v12, v153, v152
  v_fma_f32 v13, v13, v153, v152
  v_fma_f32 v14, v14, v153, v152
  v_fma_f32 v15, v15, v153, v152
  v_fma_f32 v16, v16, v153, v152
  v_fma_f32 v17, v17, v153, v152
  v_fma_f32 v18, v18, v153, v152
  v_fma_f32 v19, v19, v153, v152
  v_fma_f32 v20, v20, v153, v152
  v_fma_f32 v21, v21, v153, v152
  v_fma_f32 v22, v22, v153, v152
  v_fma_f32 v23, v23, v153, v152
  v_fma_f32 v24, v24, v153, v152
  v_fma_f32 v25, v25, v153, v152
  v_fma_f32 v26, v26, v153, v152
  v_fma_f32 v27, v27, v153, v152
  v_fma_f32 v28, v28, v153, v152
  v_fma_f32 v29, v29, v153, v152
  v_fma_f32 v30, v30, v153, v152
  v_fma_f32 v31, v31, v153, v152
  v_fma_f32 v32, v32, v153, v152
  v_fma_f32 v33, v33, v153, v152
  v_fma_f32 v34, v34, v153, v152
  v_fma_f32 v35, v35, v153, v152
  v_fma_f32 v36, v36, v153, v152
  v_fma_f32 v37, v37, v153, v152
  v_fma_f32 v38, v38, v153, v152
  v_fma_f32 v39, v39, v153, v152
  v_fma_f32 v40, v40, v153, v152
  v_fma_f32 v41, v41, v153, v152
  v_fma_f32 v42, v42, v153, v152
  v_fma_f32 v43, v43, v153, v152
  v_fma_f32 v44, v44, v153, v152
  v_fma_f32 v45, v45, v153, v152
  v_fma_f32 v46, v46, v153, v152
  v_fma_f32 v47, v47, v153, v152
  v_fma_f32 v48, v48, v153, v152
  v_fma_f32 v49, v49, v153, v152
  v_fma_f32 v50, v50, v153, v152
  v_fma_f32 v51, v51, v153, v152
  v_fma_f32 v52, v52, v153, v152
  v_fma_f32 v53, v53, v153, v152
  v_fma_f32 v54, v54, v153, v152
  v_fma_f32 v55, v55, v153, v152
  v_fma_f32 v56, v56, v153, v152
  v_fma_f32 v57, v57, v153, v152
  v_fma_f32 v58, v58, v153, v152
  v_fma_f32 v59, v59, v153, v152
  v_fma_f32 v60, v60, v153, v152
  v_fma_f32 v61, v61, v153, v152
  v_fma_f32 v62, v62, v153, v152
  v_fma_f32 v63, v63, v153, v152
  v_exp_f32 v0, v0
  v_exp_f32 v1, v1
  v_exp_f32 v2, v2
  v_exp_f32 v3, v3
  v_exp_f32 v4, v4
  v_exp_f32 v5, v5
  v_exp_f32 v6, v6
  v_exp_f32 v7, v7
  v_exp_f32 v8, v8
  v_exp_f32 v9, v9
  v_exp_f32 v10, v10
  v_exp_f32 v11, v11
  v_exp_f32 v12, v12
  v_exp_f32 v13, v13
  v_exp_f32 v14, v14
  v_exp_f32 v15, v15
  v_exp_f32 v16, v16
  v_exp_f32 v17, v17
  v_exp_f32 v18, v18
  v_exp_f32 v19, v19
  v_exp_f32 v20, v20
  v_exp_f32 v21, v21
  v_exp_f32 v22, v22
  v_exp_f32 v23, v23
  v_exp_f32 v24, v24
  v_exp_f32 v25, v25
  v_exp_f32 v26, v26
  v_exp_f32 v27, v27
  v_exp_f32 v28, v28
  v_exp_f32 v29, v29
  v_exp_f32 v30, v30
  v_exp_f32 v31, v31
  v_exp_f32 v32, v32
  v_exp_f32 v33, v33
  v_exp_f32 v34, v34
  v_exp_f32 v35, v35
  v_exp_f32 v36, v36
  v_exp_f32 v37, v37
  v_exp_f32 v38, v38
  v_exp_f32 v39, v39
  v_exp_f32 v40, v40
  v_exp_f32 v41, v41
  v_exp_f32 v42, v42
  v_exp_f32 v43, v43
  v_exp_f32 v44, v44
  v_exp_f32 v45, v45
  v_exp_f32 v46, v46
  v_exp_f32 v47, v47
  v_exp_f32 v48, v48
  v_exp_f32 v49, v49
  v_exp_f32 v50, v50
  v_exp_f32 v51, v51
  v_exp_f32 v52, v52
  v_exp_f32 v53, v53
  v_exp_f32 v54, v54
  v_exp_f32 v55, v55
  v_exp_f32 v56, v56
  v_exp_f32 v57, v57
  v_exp_f32 v58, v58
  v_exp_f32 v59, v59
  v_exp_f32 v60, v60
  v_exp_f32 v61, v61
  v_exp_f32 v62, v62
  v_exp_f32 v63, v63
  s_nop 0
  v_add_f32 v154, v0, v1
  v_add_f32 v155, v2, v3
  v_add_f32 v154, v154, v4
  v_add_f32 v155, v155, v5
  v_add_f32 v154, v154, v6
  v_add_f32 v155, v155, v7
  v_add_f32 v154, v154, v8
  v_add_f32 v155, v155, v9
  v_add_f32 v154, v154, v10
  v_add_f32 v155, v155, v11
  v_add_f32 v154, v154, v12
  v_add_f32 v155, v155, v13
  v_add_f32 v154, v154, v14
  v_add_f32 v155, v155, v15
  v_add_f32 v154, v154, v16
  v_add_f32 v155, v155, v17
  v_add_f32 v154, v154, v18
  v_add_f32 v155, v155, v19
  v_add_f32 v154, v154, v20
  v_add_f32 v155, v155, v21
  v_add_f32 v154, v154, v22
  v_add_f32 v155, v155, v23
  v_add_f32 v154, v154, v24
  v_add_f32 v155, v155, v25
  v_add_f32 v154, v154, v26
  v_add_f32 v155, v155, v27
  v_add_f32 v154, v154, v28
  v_add_f32 v155, v155, v29
  v_add_f32 v154, v154, v30
  v_add_f32 v155, v155, v31
  v_add_f32 v154, v154, v32
  v_add_f32 v155, v155, v33
  v_add_f32 v154, v154, v34
  v_add_f32 v155, v155, v35
  v_add_f32 v154, v154, v36
  v_add_f32 v155, v155, v37
  v_add_f32 v154, v154, v38
  v_add_f32 v155, v155, v39
  v_add_f32 v154, v154, v40
  v_add_f32 v155, v155, v41
  v_add_f32 v154, v154, v42
  v_add_f32 v155, v155, v43
  v_add_f32 v154, v154, v44
  v_add_f32 v155, v155, v45
  v_add_f32 v154, v154, v46
  v_add_f32 v155, v155, v47
  v_add_f32 v154, v154, v48
  v_add_f32 v155, v155, v49
  v_add_f32 v154, v154, v50
  v_add_f32 v155, v155, v51
  v_add_f32 v154, v154, v52
  v_add_f32 v155, v155, v53
  v_add_f32 v154, v154, v54
  v_add_f32 v155, v155, v55
  v_add_f32 v154, v154, v56
  v_add_f32 v155, v155, v57
  v_add_f32 v154, v154, v58
  v_add_f32 v155, v155, v59
  v_add_f32 v154, v154, v60
  v_add_f32 v155, v155, v61
  v_add_f32 v154, v154, v62
  v_add_f32 v155, v155, v63
  v_add_f32 v154, v154, v155
  v_mov_b32 v155, v154
  s_nop 1
  v_permlane32_swap_b32 v154, v155
  s_nop 1
  v_add_f32 v154, v154, v155
  v_mov_b32 v151, v154
  s_lshl_b32 s53, s42, 7
  s_lshl_b32 s54, s40, 5
  s_add_u32 s53, s53, s54
  s_add_u32 s55, s53, s45
  v_add_u32 v204, s55, v202
  v_lshlrev_b32 v206, 6, v204
  s_lshl_b32 s54, s41, 3

  v_cvt_pk_bf16_f32 v84, v0, v1
  v_cvt_pk_bf16_f32 v85, v2, v3
  v_cvt_pk_bf16_f32 v86, v4, v5
  v_cvt_pk_bf16_f32 v87, v6, v7
  v_cvt_pk_bf16_f32 v88, v8, v9
  v_cvt_pk_bf16_f32 v89, v10, v11
  v_cvt_pk_bf16_f32 v90, v12, v13
  v_cvt_pk_bf16_f32 v91, v14, v15
  v_cvt_pk_bf16_f32 v92, v16, v17
  v_cvt_pk_bf16_f32 v93, v18, v19
  v_cvt_pk_bf16_f32 v94, v20, v21
  v_cvt_pk_bf16_f32 v95, v22, v23
  v_cvt_pk_bf16_f32 v96, v24, v25
  v_cvt_pk_bf16_f32 v97, v26, v27
  v_cvt_pk_bf16_f32 v98, v28, v29
  v_cvt_pk_bf16_f32 v99, v30, v31
  v_cvt_pk_bf16_f32 v100, v32, v33
  v_cvt_pk_bf16_f32 v101, v34, v35
  v_cvt_pk_bf16_f32 v102, v36, v37
  v_cvt_pk_bf16_f32 v103, v38, v39
  v_cvt_pk_bf16_f32 v104, v40, v41
  v_cvt_pk_bf16_f32 v105, v42, v43
  v_cvt_pk_bf16_f32 v106, v44, v45
  v_cvt_pk_bf16_f32 v107, v46, v47
  v_cvt_pk_bf16_f32 v108, v48, v49
  v_cvt_pk_bf16_f32 v109, v50, v51
  v_cvt_pk_bf16_f32 v110, v52, v53
  v_cvt_pk_bf16_f32 v111, v54, v55
  v_cvt_pk_bf16_f32 v112, v56, v57
  v_cvt_pk_bf16_f32 v113, v58, v59
  v_cvt_pk_bf16_f32 v114, v60, v61
  v_cvt_pk_bf16_f32 v115, v62, v63
  v_mul_u32_u24 v205, 2176, v204
  v_lshl_add_u32 v205, v203, 4, v205
  s_lshl_b32 s56, s41, 8

  buffer_store_dwordx4 v[84:87], v205, s[20:23], s56 offen offset:0
  buffer_store_dwordx4 v[88:91], v205, s[20:23], s56 offen offset:32
  buffer_store_dwordx4 v[92:95], v205, s[20:23], s56 offen offset:64
  buffer_store_dwordx4 v[96:99], v205, s[20:23], s56 offen offset:96
  buffer_store_dwordx4 v[100:103], v205, s[20:23], s56 offen offset:128
  buffer_store_dwordx4 v[104:107], v205, s[20:23], s56 offen offset:160
  buffer_store_dwordx4 v[108:111], v205, s[20:23], s56 offen offset:192
  buffer_store_dwordx4 v[112:115], v205, s[20:23], s56 offen offset:224
  v_cmp_gt_u32 vcc, 32, v200
  s_and_saveexec_b64 s[56:57], vcc
  buffer_store_dwordx2 v[150:151], v206, s[24:27], s54 offen
  s_mov_b64 exec, s[56:57]

  s_endpgm
K3_S5:
  v_lshrrev_b32 v202, 3, v200
  v_and_b32 v203, 7, v200
  v_lshrrev_b32 v204, 4, v200
  v_xor_b32 v205, v203, v204
  v_xor_b32 v206, 4, v205
  v_mul_u32_u24 v202, 4608, v202
  v_lshl_add_u32 v190, v205, 4, v202
  v_lshl_add_u32 v191, v206, 4, v202

  s_mul_i32 s45, s43, 1056
  s_lshl_b32 s46, s42, 7
  s_add_u32 s46, s46, s45
  s_mul_i32 s47, s41, 128
  s_add_u32 s47, s47, s45
  s_mul_i32 s48, s46, 4608
  s_mul_i32 s49, s47, 4608
  s_add_u32 s49, s49, 1536
  s_mul_i32 s50, s40, 147456
  s_add_u32 s48, s48, s50
  s_mul_i32 s50, s40, 184320
  s_add_u32 s49, s49, s50
  s_lshl_b32 s51, s40, 12
  s_mul_i32 s52, s40, 5120
  s_add_u32 s52, s52, 16384

  s_and_b32 s53, s40, 1
  s_cmp_eq_u32 s53, 1
  s_cselect_b64 s[54:55], -1, 0
  s_nop 1
  v_cndmask_b32 v192, v190, v191, s[54:55]
  v_cndmask_b32 v193, v191, v190, s[54:55]

  s_add_u32 m0, s51, 0
  s_add_u32 s56, s48, 0
  buffer_load_dwordx4 v190, s[16:19], s56 offen lds
  s_add_u32 m0, s51, 1024
  s_add_u32 s56, s48, 36864
  buffer_load_dwordx4 v191, s[16:19], s56 offen lds
  s_add_u32 m0, s51, 2048
  s_add_u32 s56, s48, 73728
  buffer_load_dwordx4 v190, s[16:19], s56 offen lds
  s_add_u32 m0, s51, 3072
  s_add_u32 s56, s48, 110592
  buffer_load_dwordx4 v191, s[16:19], s56 offen lds
  s_add_u32 m0, s52, 0
  s_add_u32 s56, s49, 0
  buffer_load_dwordx4 v192, s[16:19], s56 offen lds
  s_add_u32 m0, s52, 1024
  s_add_u32 s56, s49, 36864
  buffer_load_dwordx4 v193, s[16:19], s56 offen lds
  s_add_u32 m0, s52, 2048
  s_add_u32 s56, s49, 73728
  buffer_load_dwordx4 v192, s[16:19], s56 offen lds
  s_add_u32 m0, s52, 3072
  s_add_u32 s56, s49, 110592
  buffer_load_dwordx4 v193, s[16:19], s56 offen lds
  s_add_u32 m0, s52, 4096
  s_add_u32 s56, s49, 147456
  buffer_load_dwordx4 v192, s[16:19], s56 offen lds
  s_add_u32 m0, s51, 36864
  s_add_u32 s56, s48, 128
  buffer_load_dwordx4 v190, s[16:19], s56 offen lds
  s_add_u32 m0, s51, 37888
  s_add_u32 s56, s48, 36992
  buffer_load_dwordx4 v191, s[16:19], s56 offen lds
  s_add_u32 m0, s51, 38912
  s_add_u32 s56, s48, 73856
  buffer_load_dwordx4 v190, s[16:19], s56 offen lds
  s_add_u32 m0, s51, 39936
  s_add_u32 s56, s48, 110720
  buffer_load_dwordx4 v191, s[16:19], s56 offen lds
  s_add_u32 m0, s52, 36864
  s_add_u32 s56, s49, 128
  buffer_load_dwordx4 v192, s[16:19], s56 offen lds
  s_add_u32 m0, s52, 37888
  s_add_u32 s56, s49, 36992
  buffer_load_dwordx4 v193, s[16:19], s56 offen lds
  s_add_u32 m0, s52, 38912
  s_add_u32 s56, s49, 73856
  buffer_load_dwordx4 v192, s[16:19], s56 offen lds
  s_add_u32 m0, s52, 39936
  s_add_u32 s56, s49, 110720
  buffer_load_dwordx4 v193, s[16:19], s56 offen lds
  s_add_u32 m0, s52, 40960
  s_add_u32 s56, s49, 147584
  buffer_load_dwordx4 v192, s[16:19], s56 offen lds
  v_and_b32 v202, 31, v200
  v_lshrrev_b32 v203, 5, v200
  v_bfe_u32 v204, v202, 1, 3
  v_xor_b32 v204, v204, v203
  v_lshlrev_b32 v204, 4, v204
  v_lshl_add_u32 v204, v202, 7, v204
  s_lshl_b32 s53, s40, 12
  v_add_u32 v130, s53, v204

  v_and_b32 v204, 3, v202
  v_bfe_u32 v205, v202, 2, 1
  v_lshl_add_u32 v204, v205, 3, v204
  v_bfe_u32 v205, v202, 3, 1
  v_lshl_add_u32 v204, v205, 2, v204
  v_bfe_u32 v205, v202, 4, 1
  v_lshl_add_u32 v204, v205, 4, v204

  v_bfe_u32 v205, v204, 1, 3
  v_xor_b32 v205, v205, v203
  v_lshlrev_b32 v205, 4, v205
  v_lshl_add_u32 v205, v204, 7, v205
  v_add_u32 v134, 16384, v205

  v_xor_b32 v131, 32, v130
  v_xor_b32 v135, 32, v134
  v_xor_b32 v132, 64, v130
  v_xor_b32 v136, 64, v134
  v_xor_b32 v133, 96, v130
  v_xor_b32 v137, 96, v134
  s_add_u32 m0, s51, 73728
  s_add_u32 s56, s48, 256
  buffer_load_dwordx4 v190, s[16:19], s56 offen lds
  s_add_u32 m0, s51, 74752
  s_add_u32 s56, s48, 37120
  buffer_load_dwordx4 v191, s[16:19], s56 offen lds
  s_add_u32 m0, s51, 75776
  s_add_u32 s56, s48, 73984
  buffer_load_dwordx4 v190, s[16:19], s56 offen lds
  s_add_u32 m0, s51, 76800
  s_add_u32 s56, s48, 110848
  buffer_load_dwordx4 v191, s[16:19], s56 offen lds
  s_add_u32 m0, s52, 73728
  s_add_u32 s56, s49, 256
  buffer_load_dwordx4 v192, s[16:19], s56 offen lds
  s_add_u32 m0, s52, 74752
  s_add_u32 s56, s49, 37120
  buffer_load_dwordx4 v193, s[16:19], s56 offen lds
  s_add_u32 m0, s52, 75776
  s_add_u32 s56, s49, 73984
  buffer_load_dwordx4 v192, s[16:19], s56 offen lds
  s_add_u32 m0, s52, 76800
  s_add_u32 s56, s49, 110848
  buffer_load_dwordx4 v193, s[16:19], s56 offen lds
  s_add_u32 m0, s52, 77824
  s_add_u32 s56, s49, 147712
  buffer_load_dwordx4 v192, s[16:19], s56 offen lds
  s_add_u32 m0, s51, 110592
  s_add_u32 s56, s48, 384
  buffer_load_dwordx4 v190, s[16:19], s56 offen lds
  s_add_u32 m0, s51, 111616
  s_add_u32 s56, s48, 37248
  buffer_load_dwordx4 v191, s[16:19], s56 offen lds
  s_add_u32 m0, s51, 112640
  s_add_u32 s56, s48, 74112
  buffer_load_dwordx4 v190, s[16:19], s56 offen lds
  s_add_u32 m0, s51, 113664
  s_add_u32 s56, s48, 110976
  buffer_load_dwordx4 v191, s[16:19], s56 offen lds
  s_add_u32 m0, s52, 110592
  s_add_u32 s56, s49, 384
  buffer_load_dwordx4 v192, s[16:19], s56 offen lds
  s_add_u32 m0, s52, 111616
  s_add_u32 s56, s49, 37248
  buffer_load_dwordx4 v193, s[16:19], s56 offen lds
  s_add_u32 m0, s52, 112640
  s_add_u32 s56, s49, 74112
  buffer_load_dwordx4 v192, s[16:19], s56 offen lds
  s_add_u32 m0, s52, 113664
  s_add_u32 s56, s49, 110976
  buffer_load_dwordx4 v193, s[16:19], s56 offen lds
  s_add_u32 m0, s52, 114688
  s_add_u32 s56, s49, 147840
  buffer_load_dwordx4 v192, s[16:19], s56 offen lds
  s_waitcnt vmcnt(27)
  s_barrier
  v_add_u32 v138, 0, v130
  v_add_u32 v142, 0, v134
  ds_read_b128 v[80:83], v138
  ds_read_b128 v[84:87], v142 offset:0
  ds_read_b128 v[88:91], v142 offset:4096
  ds_read_b128 v[92:95], v142 offset:8192
  ds_read_b128 v[96:99], v142 offset:12288
  ds_read_b128 v[100:103], v142 offset:16384
  v_add_u32 v138, 0, v131
  v_add_u32 v142, 0, v135
  ds_read_b128 v[104:107], v138
  ds_read_b128 v[108:111], v142 offset:0
  ds_read_b128 v[112:115], v142 offset:4096
  ds_read_b128 v[116:119], v142 offset:8192
  ds_read_b128 v[120:123], v142 offset:12288
  ds_read_b128 v[124:127], v142 offset:16384
  s_waitcnt lgkmcnt(6)
  v_mfma_f32_32x32x16_bf16 v[0:15], v[84:87], v[80:83], 0
  v_mfma_f32_32x32x16_bf16 v[16:31], v[88:91], v[80:83], 0
  v_mfma_f32_32x32x16_bf16 v[32:47], v[92:95], v[80:83], 0
  v_mfma_f32_32x32x16_bf16 v[48:63], v[96:99], v[80:83], 0
  v_mfma_f32_32x32x16_bf16 v[64:79], v[100:103], v[80:83], 0
  v_add_u32 v138, 0, v132
  v_add_u32 v142, 0, v136
  ds_read_b128 v[80:83], v138
  ds_read_b128 v[84:87], v142 offset:0
  ds_read_b128 v[88:91], v142 offset:4096
  ds_read_b128 v[92:95], v142 offset:8192
  ds_read_b128 v[96:99], v142 offset:12288
  ds_read_b128 v[100:103], v142 offset:16384
  s_waitcnt lgkmcnt(6)
  v_mfma_f32_32x32x16_bf16 v[0:15], v[108:111], v[104:107], v[0:15]
  s_waitcnt vmcnt(18)
  s_barrier
  v_mfma_f32_32x32x16_bf16 v[16:31], v[112:115], v[104:107], v[16:31]
  v_mfma_f32_32x32x16_bf16 v[32:47], v[116:119], v[104:107], v[32:47]
  v_mfma_f32_32x32x16_bf16 v[48:63], v[120:123], v[104:107], v[48:63]
  v_mfma_f32_32x32x16_bf16 v[64:79], v[124:127], v[104:107], v[64:79]
  v_add_u32 v138, 0, v133
  v_add_u32 v142, 0, v137
  ds_read_b128 v[104:107], v138
  ds_read_b128 v[108:111], v142 offset:0
  ds_read_b128 v[112:115], v142 offset:4096
  ds_read_b128 v[116:119], v142 offset:8192
  ds_read_b128 v[120:123], v142 offset:12288
  ds_read_b128 v[124:127], v142 offset:16384
  s_waitcnt lgkmcnt(6)
  v_mfma_f32_32x32x16_bf16 v[0:15], v[84:87], v[80:83], v[0:15]
  v_mfma_f32_32x32x16_bf16 v[16:31], v[88:91], v[80:83], v[16:31]
  v_mfma_f32_32x32x16_bf16 v[32:47], v[92:95], v[80:83], v[32:47]
  v_mfma_f32_32x32x16_bf16 v[48:63], v[96:99], v[80:83], v[48:63]
  v_mfma_f32_32x32x16_bf16 v[64:79], v[100:103], v[80:83], v[64:79]
  v_add_u32 v138, 36864, v130
  v_add_u32 v142, 36864, v134
  ds_read_b128 v[80:83], v138
  ds_read_b128 v[84:87], v142 offset:0
  ds_read_b128 v[88:91], v142 offset:4096
  ds_read_b128 v[92:95], v142 offset:8192
  ds_read_b128 v[96:99], v142 offset:12288
  ds_read_b128 v[100:103], v142 offset:16384
  s_waitcnt lgkmcnt(6)
  v_mfma_f32_32x32x16_bf16 v[0:15], v[108:111], v[104:107], v[0:15]
  v_mfma_f32_32x32x16_bf16 v[16:31], v[112:115], v[104:107], v[16:31]
  v_mfma_f32_32x32x16_bf16 v[32:47], v[116:119], v[104:107], v[32:47]
  v_mfma_f32_32x32x16_bf16 v[48:63], v[120:123], v[104:107], v[48:63]
  v_mfma_f32_32x32x16_bf16 v[64:79], v[124:127], v[104:107], v[64:79]
  v_add_u32 v138, 36864, v131
  v_add_u32 v142, 36864, v135
  ds_read_b128 v[104:107], v138
  ds_read_b128 v[108:111], v142 offset:0
  ds_read_b128 v[112:115], v142 offset:4096
  ds_read_b128 v[116:119], v142 offset:8192
  ds_read_b128 v[120:123], v142 offset:12288
  ds_read_b128 v[124:127], v142 offset:16384
  s_waitcnt lgkmcnt(6)
  v_mfma_f32_32x32x16_bf16 v[0:15], v[84:87], v[80:83], v[0:15]
  v_mfma_f32_32x32x16_bf16 v[16:31], v[88:91], v[80:83], v[16:31]
  v_mfma_f32_32x32x16_bf16 v[32:47], v[92:95], v[80:83], v[32:47]
  v_mfma_f32_32x32x16_bf16 v[48:63], v[96:99], v[80:83], v[48:63]
  v_mfma_f32_32x32x16_bf16 v[64:79], v[100:103], v[80:83], v[64:79]
  v_add_u32 v138, 36864, v132
  v_add_u32 v142, 36864, v136
  ds_read_b128 v[80:83], v138
  ds_read_b128 v[84:87], v142 offset:0
  ds_read_b128 v[88:91], v142 offset:4096
  ds_read_b128 v[92:95], v142 offset:8192
  ds_read_b128 v[96:99], v142 offset:12288
  ds_read_b128 v[100:103], v142 offset:16384
  s_waitcnt lgkmcnt(6)
  v_mfma_f32_32x32x16_bf16 v[0:15], v[108:111], v[104:107], v[0:15]
  s_waitcnt vmcnt(9)
  s_barrier
  v_mfma_f32_32x32x16_bf16 v[16:31], v[112:115], v[104:107], v[16:31]
  s_add_u32 m0, s51, 0
  s_add_u32 s56, s48, 512
  buffer_load_dwordx4 v190, s[16:19], s56 offen lds
  s_add_u32 m0, s51, 1024
  v_mfma_f32_32x32x16_bf16 v[32:47], v[116:119], v[104:107], v[32:47]
  s_add_u32 s56, s48, 37376
  buffer_load_dwordx4 v191, s[16:19], s56 offen lds
  s_add_u32 m0, s51, 2048
  s_add_u32 s56, s48, 74240
  v_mfma_f32_32x32x16_bf16 v[48:63], v[120:123], v[104:107], v[48:63]
  buffer_load_dwordx4 v190, s[16:19], s56 offen lds
  s_add_u32 m0, s51, 3072
  s_add_u32 s56, s48, 111104
  buffer_load_dwordx4 v191, s[16:19], s56 offen lds
  v_mfma_f32_32x32x16_bf16 v[64:79], v[124:127], v[104:107], v[64:79]
  s_add_u32 m0, s52, 0
  s_add_u32 s56, s49, 512
  buffer_load_dwordx4 v192, s[16:19], s56 offen lds
  s_add_u32 m0, s52, 1024
  v_add_u32 v138, 36864, v133
  v_add_u32 v142, 36864, v137
  ds_read_b128 v[104:107], v138
  ds_read_b128 v[108:111], v142 offset:0
  ds_read_b128 v[112:115], v142 offset:4096
  ds_read_b128 v[116:119], v142 offset:8192
  ds_read_b128 v[120:123], v142 offset:12288
  ds_read_b128 v[124:127], v142 offset:16384
  s_waitcnt lgkmcnt(6)
  v_mfma_f32_32x32x16_bf16 v[0:15], v[84:87], v[80:83], v[0:15]
  s_add_u32 s56, s49, 37376
  buffer_load_dwordx4 v193, s[16:19], s56 offen lds
  s_add_u32 m0, s52, 2048
  s_add_u32 s56, s49, 74240
  v_mfma_f32_32x32x16_bf16 v[16:31], v[88:91], v[80:83], v[16:31]
  buffer_load_dwordx4 v192, s[16:19], s56 offen lds
  s_add_u32 m0, s52, 3072
  s_add_u32 s56, s49, 111104
  buffer_load_dwordx4 v193, s[16:19], s56 offen lds
  v_mfma_f32_32x32x16_bf16 v[32:47], v[92:95], v[80:83], v[32:47]
  s_add_u32 m0, s52, 4096
  s_add_u32 s56, s49, 147968
  buffer_load_dwordx4 v192, s[16:19], s56 offen lds
  v_mfma_f32_32x32x16_bf16 v[48:63], v[96:99], v[80:83], v[48:63]
  v_mfma_f32_32x32x16_bf16 v[64:79], v[100:103], v[80:83], v[64:79]
  v_add_u32 v138, 73728, v130
  v_add_u32 v142, 73728, v134
  ds_read_b128 v[80:83], v138
  ds_read_b128 v[84:87], v142 offset:0
  ds_read_b128 v[88:91], v142 offset:4096
  ds_read_b128 v[92:95], v142 offset:8192
  ds_read_b128 v[96:99], v142 offset:12288
  ds_read_b128 v[100:103], v142 offset:16384
  s_waitcnt lgkmcnt(6)
  v_mfma_f32_32x32x16_bf16 v[0:15], v[108:111], v[104:107], v[0:15]
  v_mfma_f32_32x32x16_bf16 v[16:31], v[112:115], v[104:107], v[16:31]
  v_mfma_f32_32x32x16_bf16 v[32:47], v[116:119], v[104:107], v[32:47]
  v_mfma_f32_32x32x16_bf16 v[48:63], v[120:123], v[104:107], v[48:63]
  v_mfma_f32_32x32x16_bf16 v[64:79], v[124:127], v[104:107], v[64:79]
  v_add_u32 v138, 73728, v131
  v_add_u32 v142, 73728, v135
  ds_read_b128 v[104:107], v138
  ds_read_b128 v[108:111], v142 offset:0
  ds_read_b128 v[112:115], v142 offset:4096
  ds_read_b128 v[116:119], v142 offset:8192
  ds_read_b128 v[120:123], v142 offset:12288
  ds_read_b128 v[124:127], v142 offset:16384
  s_waitcnt lgkmcnt(6)
  v_mfma_f32_32x32x16_bf16 v[0:15], v[84:87], v[80:83], v[0:15]
  v_mfma_f32_32x32x16_bf16 v[16:31], v[88:91], v[80:83], v[16:31]
  v_mfma_f32_32x32x16_bf16 v[32:47], v[92:95], v[80:83], v[32:47]
  v_mfma_f32_32x32x16_bf16 v[48:63], v[96:99], v[80:83], v[48:63]
  v_mfma_f32_32x32x16_bf16 v[64:79], v[100:103], v[80:83], v[64:79]
  v_add_u32 v138, 73728, v132
  v_add_u32 v142, 73728, v136
  ds_read_b128 v[80:83], v138
  ds_read_b128 v[84:87], v142 offset:0
  ds_read_b128 v[88:91], v142 offset:4096
  ds_read_b128 v[92:95], v142 offset:8192
  ds_read_b128 v[96:99], v142 offset:12288
  ds_read_b128 v[100:103], v142 offset:16384
  s_waitcnt lgkmcnt(6)
  v_mfma_f32_32x32x16_bf16 v[0:15], v[108:111], v[104:107], v[0:15]
  s_waitcnt vmcnt(9)
  s_barrier
  v_mfma_f32_32x32x16_bf16 v[16:31], v[112:115], v[104:107], v[16:31]
  s_add_u32 m0, s51, 36864
  s_add_u32 s56, s48, 640
  buffer_load_dwordx4 v190, s[16:19], s56 offen lds
  s_add_u32 m0, s51, 37888
  v_mfma_f32_32x32x16_bf16 v[32:47], v[116:119], v[104:107], v[32:47]
  s_add_u32 s56, s48, 37504
  buffer_load_dwordx4 v191, s[16:19], s56 offen lds
  s_add_u32 m0, s51, 38912
  s_add_u32 s56, s48, 74368
  v_mfma_f32_32x32x16_bf16 v[48:63], v[120:123], v[104:107], v[48:63]
  buffer_load_dwordx4 v190, s[16:19], s56 offen lds
  s_add_u32 m0, s51, 39936
  s_add_u32 s56, s48, 111232
  buffer_load_dwordx4 v191, s[16:19], s56 offen lds
  v_mfma_f32_32x32x16_bf16 v[64:79], v[124:127], v[104:107], v[64:79]
  s_add_u32 m0, s52, 36864
  s_add_u32 s56, s49, 640
  buffer_load_dwordx4 v192, s[16:19], s56 offen lds
  s_add_u32 m0, s52, 37888
  v_add_u32 v138, 73728, v133
  v_add_u32 v142, 73728, v137
  ds_read_b128 v[104:107], v138
  ds_read_b128 v[108:111], v142 offset:0
  ds_read_b128 v[112:115], v142 offset:4096
  ds_read_b128 v[116:119], v142 offset:8192
  ds_read_b128 v[120:123], v142 offset:12288
  ds_read_b128 v[124:127], v142 offset:16384
  s_waitcnt lgkmcnt(6)
  v_mfma_f32_32x32x16_bf16 v[0:15], v[84:87], v[80:83], v[0:15]
  s_add_u32 s56, s49, 37504
  buffer_load_dwordx4 v193, s[16:19], s56 offen lds
  s_add_u32 m0, s52, 38912
  s_add_u32 s56, s49, 74368
  v_mfma_f32_32x32x16_bf16 v[16:31], v[88:91], v[80:83], v[16:31]
  buffer_load_dwordx4 v192, s[16:19], s56 offen lds
  s_add_u32 m0, s52, 39936
  s_add_u32 s56, s49, 111232
  buffer_load_dwordx4 v193, s[16:19], s56 offen lds
  v_mfma_f32_32x32x16_bf16 v[32:47], v[92:95], v[80:83], v[32:47]
  s_add_u32 m0, s52, 40960
  s_add_u32 s56, s49, 148096
  buffer_load_dwordx4 v192, s[16:19], s56 offen lds
  v_mfma_f32_32x32x16_bf16 v[48:63], v[96:99], v[80:83], v[48:63]
  v_mfma_f32_32x32x16_bf16 v[64:79], v[100:103], v[80:83], v[64:79]
  v_add_u32 v138, 110592, v130
  v_add_u32 v142, 110592, v134
  ds_read_b128 v[80:83], v138
  ds_read_b128 v[84:87], v142 offset:0
  ds_read_b128 v[88:91], v142 offset:4096
  ds_read_b128 v[92:95], v142 offset:8192
  ds_read_b128 v[96:99], v142 offset:12288
  ds_read_b128 v[100:103], v142 offset:16384
  s_waitcnt lgkmcnt(6)
  v_mfma_f32_32x32x16_bf16 v[0:15], v[108:111], v[104:107], v[0:15]
  v_mfma_f32_32x32x16_bf16 v[16:31], v[112:115], v[104:107], v[16:31]
  v_mfma_f32_32x32x16_bf16 v[32:47], v[116:119], v[104:107], v[32:47]
  v_mfma_f32_32x32x16_bf16 v[48:63], v[120:123], v[104:107], v[48:63]
  v_mfma_f32_32x32x16_bf16 v[64:79], v[124:127], v[104:107], v[64:79]
  v_add_u32 v138, 110592, v131
  v_add_u32 v142, 110592, v135
  ds_read_b128 v[104:107], v138
  ds_read_b128 v[108:111], v142 offset:0
  ds_read_b128 v[112:115], v142 offset:4096
  ds_read_b128 v[116:119], v142 offset:8192
  ds_read_b128 v[120:123], v142 offset:12288
  ds_read_b128 v[124:127], v142 offset:16384
  s_waitcnt lgkmcnt(6)
  v_mfma_f32_32x32x16_bf16 v[0:15], v[84:87], v[80:83], v[0:15]
  v_mfma_f32_32x32x16_bf16 v[16:31], v[88:91], v[80:83], v[16:31]
  v_mfma_f32_32x32x16_bf16 v[32:47], v[92:95], v[80:83], v[32:47]
  v_mfma_f32_32x32x16_bf16 v[48:63], v[96:99], v[80:83], v[48:63]
  v_mfma_f32_32x32x16_bf16 v[64:79], v[100:103], v[80:83], v[64:79]
  v_add_u32 v138, 110592, v132
  v_add_u32 v142, 110592, v136
  ds_read_b128 v[80:83], v138
  ds_read_b128 v[84:87], v142 offset:0
  ds_read_b128 v[88:91], v142 offset:4096
  ds_read_b128 v[92:95], v142 offset:8192
  ds_read_b128 v[96:99], v142 offset:12288
  ds_read_b128 v[100:103], v142 offset:16384
  s_waitcnt lgkmcnt(6)
  v_mfma_f32_32x32x16_bf16 v[0:15], v[108:111], v[104:107], v[0:15]
  s_waitcnt vmcnt(9)
  s_barrier
  v_mfma_f32_32x32x16_bf16 v[16:31], v[112:115], v[104:107], v[16:31]
  s_add_u32 m0, s51, 73728
  s_add_u32 s56, s48, 768
  buffer_load_dwordx4 v190, s[16:19], s56 offen lds
  s_add_u32 m0, s51, 74752
  v_mfma_f32_32x32x16_bf16 v[32:47], v[116:119], v[104:107], v[32:47]
  s_add_u32 s56, s48, 37632
  buffer_load_dwordx4 v191, s[16:19], s56 offen lds
  s_add_u32 m0, s51, 75776
  s_add_u32 s56, s48, 74496
  v_mfma_f32_32x32x16_bf16 v[48:63], v[120:123], v[104:107], v[48:63]
  buffer_load_dwordx4 v190, s[16:19], s56 offen lds
  s_add_u32 m0, s51, 76800
  s_add_u32 s56, s48, 111360
  buffer_load_dwordx4 v191, s[16:19], s56 offen lds
  v_mfma_f32_32x32x16_bf16 v[64:79], v[124:127], v[104:107], v[64:79]
  s_add_u32 m0, s52, 73728
  s_add_u32 s56, s49, 768
  buffer_load_dwordx4 v192, s[16:19], s56 offen lds
  s_add_u32 m0, s52, 74752
  v_add_u32 v138, 110592, v133
  v_add_u32 v142, 110592, v137
  ds_read_b128 v[104:107], v138
  ds_read_b128 v[108:111], v142 offset:0
  ds_read_b128 v[112:115], v142 offset:4096
  ds_read_b128 v[116:119], v142 offset:8192
  ds_read_b128 v[120:123], v142 offset:12288
  ds_read_b128 v[124:127], v142 offset:16384
  s_waitcnt lgkmcnt(6)
  v_mfma_f32_32x32x16_bf16 v[0:15], v[84:87], v[80:83], v[0:15]
  s_add_u32 s56, s49, 37632
  buffer_load_dwordx4 v193, s[16:19], s56 offen lds
  s_add_u32 m0, s52, 75776
  s_add_u32 s56, s49, 74496
  v_mfma_f32_32x32x16_bf16 v[16:31], v[88:91], v[80:83], v[16:31]
  buffer_load_dwordx4 v192, s[16:19], s56 offen lds
  s_add_u32 m0, s52, 76800
  s_add_u32 s56, s49, 111360
  buffer_load_dwordx4 v193, s[16:19], s56 offen lds
  v_mfma_f32_32x32x16_bf16 v[32:47], v[92:95], v[80:83], v[32:47]
  s_add_u32 m0, s52, 77824
  s_add_u32 s56, s49, 148224
  buffer_load_dwordx4 v192, s[16:19], s56 offen lds
  v_mfma_f32_32x32x16_bf16 v[48:63], v[96:99], v[80:83], v[48:63]
  v_mfma_f32_32x32x16_bf16 v[64:79], v[100:103], v[80:83], v[64:79]
  v_add_u32 v138, 0, v130
  v_add_u32 v142, 0, v134
  ds_read_b128 v[80:83], v138
  ds_read_b128 v[84:87], v142 offset:0
  ds_read_b128 v[88:91], v142 offset:4096
  ds_read_b128 v[92:95], v142 offset:8192
  ds_read_b128 v[96:99], v142 offset:12288
  ds_read_b128 v[100:103], v142 offset:16384
  s_waitcnt lgkmcnt(6)
  v_mfma_f32_32x32x16_bf16 v[0:15], v[108:111], v[104:107], v[0:15]
  v_mfma_f32_32x32x16_bf16 v[16:31], v[112:115], v[104:107], v[16:31]
  v_mfma_f32_32x32x16_bf16 v[32:47], v[116:119], v[104:107], v[32:47]
  v_mfma_f32_32x32x16_bf16 v[48:63], v[120:123], v[104:107], v[48:63]
  v_mfma_f32_32x32x16_bf16 v[64:79], v[124:127], v[104:107], v[64:79]
  v_add_u32 v138, 0, v131
  v_add_u32 v142, 0, v135
  ds_read_b128 v[104:107], v138
  ds_read_b128 v[108:111], v142 offset:0
  ds_read_b128 v[112:115], v142 offset:4096
  ds_read_b128 v[116:119], v142 offset:8192
  ds_read_b128 v[120:123], v142 offset:12288
  ds_read_b128 v[124:127], v142 offset:16384
  s_waitcnt lgkmcnt(6)
  v_mfma_f32_32x32x16_bf16 v[0:15], v[84:87], v[80:83], v[0:15]
  v_mfma_f32_32x32x16_bf16 v[16:31], v[88:91], v[80:83], v[16:31]
  v_mfma_f32_32x32x16_bf16 v[32:47], v[92:95], v[80:83], v[32:47]
  v_mfma_f32_32x32x16_bf16 v[48:63], v[96:99], v[80:83], v[48:63]
  v_mfma_f32_32x32x16_bf16 v[64:79], v[100:103], v[80:83], v[64:79]
  v_add_u32 v138, 0, v132
  v_add_u32 v142, 0, v136
  ds_read_b128 v[80:83], v138
  ds_read_b128 v[84:87], v142 offset:0
  ds_read_b128 v[88:91], v142 offset:4096
  ds_read_b128 v[92:95], v142 offset:8192
  ds_read_b128 v[96:99], v142 offset:12288
  ds_read_b128 v[100:103], v142 offset:16384
  s_waitcnt lgkmcnt(6)
  v_mfma_f32_32x32x16_bf16 v[0:15], v[108:111], v[104:107], v[0:15]
  s_waitcnt vmcnt(9)
  s_barrier
  v_mfma_f32_32x32x16_bf16 v[16:31], v[112:115], v[104:107], v[16:31]
  s_add_u32 m0, s51, 110592
  s_add_u32 s56, s48, 896
  buffer_load_dwordx4 v190, s[16:19], s56 offen lds
  s_add_u32 m0, s51, 111616
  v_mfma_f32_32x32x16_bf16 v[32:47], v[116:119], v[104:107], v[32:47]
  s_add_u32 s56, s48, 37760
  buffer_load_dwordx4 v191, s[16:19], s56 offen lds
  s_add_u32 m0, s51, 112640
  s_add_u32 s56, s48, 74624
  v_mfma_f32_32x32x16_bf16 v[48:63], v[120:123], v[104:107], v[48:63]
  buffer_load_dwordx4 v190, s[16:19], s56 offen lds
  s_add_u32 m0, s51, 113664
  s_add_u32 s56, s48, 111488
  buffer_load_dwordx4 v191, s[16:19], s56 offen lds
  v_mfma_f32_32x32x16_bf16 v[64:79], v[124:127], v[104:107], v[64:79]
  s_add_u32 m0, s52, 110592
  s_add_u32 s56, s49, 896
  buffer_load_dwordx4 v192, s[16:19], s56 offen lds
  s_add_u32 m0, s52, 111616
  v_add_u32 v138, 0, v133
  v_add_u32 v142, 0, v137
  ds_read_b128 v[104:107], v138
  ds_read_b128 v[108:111], v142 offset:0
  ds_read_b128 v[112:115], v142 offset:4096
  ds_read_b128 v[116:119], v142 offset:8192
  ds_read_b128 v[120:123], v142 offset:12288
  ds_read_b128 v[124:127], v142 offset:16384
  s_waitcnt lgkmcnt(6)
  v_mfma_f32_32x32x16_bf16 v[0:15], v[84:87], v[80:83], v[0:15]
  s_add_u32 s56, s49, 37760
  buffer_load_dwordx4 v193, s[16:19], s56 offen lds
  s_add_u32 m0, s52, 112640
  s_add_u32 s56, s49, 74624
  v_mfma_f32_32x32x16_bf16 v[16:31], v[88:91], v[80:83], v[16:31]
  buffer_load_dwordx4 v192, s[16:19], s56 offen lds
  s_add_u32 m0, s52, 113664
  s_add_u32 s56, s49, 111488
  buffer_load_dwordx4 v193, s[16:19], s56 offen lds
  v_mfma_f32_32x32x16_bf16 v[32:47], v[92:95], v[80:83], v[32:47]
  s_add_u32 m0, s52, 114688
  s_add_u32 s56, s49, 148352
  buffer_load_dwordx4 v192, s[16:19], s56 offen lds
  v_mfma_f32_32x32x16_bf16 v[48:63], v[96:99], v[80:83], v[48:63]
  v_mfma_f32_32x32x16_bf16 v[64:79], v[100:103], v[80:83], v[64:79]
  v_add_u32 v138, 36864, v130
  v_add_u32 v142, 36864, v134
  ds_read_b128 v[80:83], v138
  ds_read_b128 v[84:87], v142 offset:0
  ds_read_b128 v[88:91], v142 offset:4096
  ds_read_b128 v[92:95], v142 offset:8192
  ds_read_b128 v[96:99], v142 offset:12288
  ds_read_b128 v[100:103], v142 offset:16384
  s_waitcnt lgkmcnt(6)
  v_mfma_f32_32x32x16_bf16 v[0:15], v[108:111], v[104:107], v[0:15]
  v_mfma_f32_32x32x16_bf16 v[16:31], v[112:115], v[104:107], v[16:31]
  v_mfma_f32_32x32x16_bf16 v[32:47], v[116:119], v[104:107], v[32:47]
  v_mfma_f32_32x32x16_bf16 v[48:63], v[120:123], v[104:107], v[48:63]
  v_mfma_f32_32x32x16_bf16 v[64:79], v[124:127], v[104:107], v[64:79]
  v_add_u32 v138, 36864, v131
  v_add_u32 v142, 36864, v135
  ds_read_b128 v[104:107], v138
  ds_read_b128 v[108:111], v142 offset:0
  ds_read_b128 v[112:115], v142 offset:4096
  ds_read_b128 v[116:119], v142 offset:8192
  ds_read_b128 v[120:123], v142 offset:12288
  ds_read_b128 v[124:127], v142 offset:16384
  s_waitcnt lgkmcnt(6)
  v_mfma_f32_32x32x16_bf16 v[0:15], v[84:87], v[80:83], v[0:15]
  v_mfma_f32_32x32x16_bf16 v[16:31], v[88:91], v[80:83], v[16:31]
  v_mfma_f32_32x32x16_bf16 v[32:47], v[92:95], v[80:83], v[32:47]
  v_mfma_f32_32x32x16_bf16 v[48:63], v[96:99], v[80:83], v[48:63]
  v_mfma_f32_32x32x16_bf16 v[64:79], v[100:103], v[80:83], v[64:79]
  v_add_u32 v138, 36864, v132
  v_add_u32 v142, 36864, v136
  ds_read_b128 v[80:83], v138
  ds_read_b128 v[84:87], v142 offset:0
  ds_read_b128 v[88:91], v142 offset:4096
  ds_read_b128 v[92:95], v142 offset:8192
  ds_read_b128 v[96:99], v142 offset:12288
  ds_read_b128 v[100:103], v142 offset:16384
  s_waitcnt lgkmcnt(6)
  v_mfma_f32_32x32x16_bf16 v[0:15], v[108:111], v[104:107], v[0:15]
  s_waitcnt vmcnt(9)
  s_barrier
  v_mfma_f32_32x32x16_bf16 v[16:31], v[112:115], v[104:107], v[16:31]
  s_add_u32 m0, s51, 0
  s_add_u32 s56, s48, 1024
  buffer_load_dwordx4 v190, s[16:19], s56 offen lds
  s_add_u32 m0, s51, 1024
  v_mfma_f32_32x32x16_bf16 v[32:47], v[116:119], v[104:107], v[32:47]
  s_add_u32 s56, s48, 37888
  buffer_load_dwordx4 v191, s[16:19], s56 offen lds
  s_add_u32 m0, s51, 2048
  s_add_u32 s56, s48, 74752
  v_mfma_f32_32x32x16_bf16 v[48:63], v[120:123], v[104:107], v[48:63]
  buffer_load_dwordx4 v190, s[16:19], s56 offen lds
  s_add_u32 m0, s51, 3072
  s_add_u32 s56, s48, 111616
  buffer_load_dwordx4 v191, s[16:19], s56 offen lds
  v_mfma_f32_32x32x16_bf16 v[64:79], v[124:127], v[104:107], v[64:79]
  s_add_u32 m0, s52, 0
  s_add_u32 s56, s49, 1024
  buffer_load_dwordx4 v192, s[16:19], s56 offen lds
  s_add_u32 m0, s52, 1024
  v_add_u32 v138, 36864, v133
  v_add_u32 v142, 36864, v137
  ds_read_b128 v[104:107], v138
  ds_read_b128 v[108:111], v142 offset:0
  ds_read_b128 v[112:115], v142 offset:4096
  ds_read_b128 v[116:119], v142 offset:8192
  ds_read_b128 v[120:123], v142 offset:12288
  ds_read_b128 v[124:127], v142 offset:16384
  s_waitcnt lgkmcnt(6)
  v_mfma_f32_32x32x16_bf16 v[0:15], v[84:87], v[80:83], v[0:15]
  s_add_u32 s56, s49, 37888
  buffer_load_dwordx4 v193, s[16:19], s56 offen lds
  s_add_u32 m0, s52, 2048
  s_add_u32 s56, s49, 74752
  v_mfma_f32_32x32x16_bf16 v[16:31], v[88:91], v[80:83], v[16:31]
  buffer_load_dwordx4 v192, s[16:19], s56 offen lds
  s_add_u32 m0, s52, 3072
  s_add_u32 s56, s49, 111616
  buffer_load_dwordx4 v193, s[16:19], s56 offen lds
  v_mfma_f32_32x32x16_bf16 v[32:47], v[92:95], v[80:83], v[32:47]
  s_add_u32 m0, s52, 4096
  s_add_u32 s56, s49, 148480
  buffer_load_dwordx4 v192, s[16:19], s56 offen lds
  v_mfma_f32_32x32x16_bf16 v[48:63], v[96:99], v[80:83], v[48:63]
  v_mfma_f32_32x32x16_bf16 v[64:79], v[100:103], v[80:83], v[64:79]
  v_add_u32 v138, 73728, v130
  v_add_u32 v142, 73728, v134
  ds_read_b128 v[80:83], v138
  ds_read_b128 v[84:87], v142 offset:0
  ds_read_b128 v[88:91], v142 offset:4096
  ds_read_b128 v[92:95], v142 offset:8192
  ds_read_b128 v[96:99], v142 offset:12288
  ds_read_b128 v[100:103], v142 offset:16384
  s_waitcnt lgkmcnt(6)
  v_mfma_f32_32x32x16_bf16 v[0:15], v[108:111], v[104:107], v[0:15]
  v_mfma_f32_32x32x16_bf16 v[16:31], v[112:115], v[104:107], v[16:31]
  v_mfma_f32_32x32x16_bf16 v[32:47], v[116:119], v[104:107], v[32:47]
  v_mfma_f32_32x32x16_bf16 v[48:63], v[120:123], v[104:107], v[48:63]
  v_mfma_f32_32x32x16_bf16 v[64:79], v[124:127], v[104:107], v[64:79]
  v_add_u32 v138, 73728, v131
  v_add_u32 v142, 73728, v135
  ds_read_b128 v[104:107], v138
  ds_read_b128 v[108:111], v142 offset:0
  ds_read_b128 v[112:115], v142 offset:4096
  ds_read_b128 v[116:119], v142 offset:8192
  ds_read_b128 v[120:123], v142 offset:12288
  ds_read_b128 v[124:127], v142 offset:16384
  s_waitcnt lgkmcnt(6)
  v_mfma_f32_32x32x16_bf16 v[0:15], v[84:87], v[80:83], v[0:15]
  v_mfma_f32_32x32x16_bf16 v[16:31], v[88:91], v[80:83], v[16:31]
  v_mfma_f32_32x32x16_bf16 v[32:47], v[92:95], v[80:83], v[32:47]
  v_mfma_f32_32x32x16_bf16 v[48:63], v[96:99], v[80:83], v[48:63]
  v_mfma_f32_32x32x16_bf16 v[64:79], v[100:103], v[80:83], v[64:79]
  v_add_u32 v138, 73728, v132
  v_add_u32 v142, 73728, v136
  ds_read_b128 v[80:83], v138
  ds_read_b128 v[84:87], v142 offset:0
  ds_read_b128 v[88:91], v142 offset:4096
  ds_read_b128 v[92:95], v142 offset:8192
  ds_read_b128 v[96:99], v142 offset:12288
  ds_read_b128 v[100:103], v142 offset:16384
  s_waitcnt lgkmcnt(6)
  v_mfma_f32_32x32x16_bf16 v[0:15], v[108:111], v[104:107], v[0:15]
  s_waitcnt vmcnt(9)
  s_barrier
  v_mfma_f32_32x32x16_bf16 v[16:31], v[112:115], v[104:107], v[16:31]
  s_add_u32 m0, s51, 36864
  s_add_u32 s56, s48, 1152
  buffer_load_dwordx4 v190, s[16:19], s56 offen lds
  s_add_u32 m0, s51, 37888
  v_mfma_f32_32x32x16_bf16 v[32:47], v[116:119], v[104:107], v[32:47]
  s_add_u32 s56, s48, 38016
  buffer_load_dwordx4 v191, s[16:19], s56 offen lds
  s_add_u32 m0, s51, 38912
  s_add_u32 s56, s48, 74880
  v_mfma_f32_32x32x16_bf16 v[48:63], v[120:123], v[104:107], v[48:63]
  buffer_load_dwordx4 v190, s[16:19], s56 offen lds
  s_add_u32 m0, s51, 39936
  s_add_u32 s56, s48, 111744
  buffer_load_dwordx4 v191, s[16:19], s56 offen lds
  v_mfma_f32_32x32x16_bf16 v[64:79], v[124:127], v[104:107], v[64:79]
  s_add_u32 m0, s52, 36864
  s_add_u32 s56, s49, 1152
  buffer_load_dwordx4 v192, s[16:19], s56 offen lds
  s_add_u32 m0, s52, 37888
  v_add_u32 v138, 73728, v133
  v_add_u32 v142, 73728, v137
  ds_read_b128 v[104:107], v138
  ds_read_b128 v[108:111], v142 offset:0
  ds_read_b128 v[112:115], v142 offset:4096
  ds_read_b128 v[116:119], v142 offset:8192
  ds_read_b128 v[120:123], v142 offset:12288
  ds_read_b128 v[124:127], v142 offset:16384
  s_waitcnt lgkmcnt(6)
  v_mfma_f32_32x32x16_bf16 v[0:15], v[84:87], v[80:83], v[0:15]
  s_add_u32 s56, s49, 38016
  buffer_load_dwordx4 v193, s[16:19], s56 offen lds
  s_add_u32 m0, s52, 38912
  s_add_u32 s56, s49, 74880
  v_mfma_f32_32x32x16_bf16 v[16:31], v[88:91], v[80:83], v[16:31]
  buffer_load_dwordx4 v192, s[16:19], s56 offen lds
  s_add_u32 m0, s52, 39936
  s_add_u32 s56, s49, 111744
  buffer_load_dwordx4 v193, s[16:19], s56 offen lds
  v_mfma_f32_32x32x16_bf16 v[32:47], v[92:95], v[80:83], v[32:47]
  s_add_u32 m0, s52, 40960
  s_add_u32 s56, s49, 148608
  buffer_load_dwordx4 v192, s[16:19], s56 offen lds
  v_mfma_f32_32x32x16_bf16 v[48:63], v[96:99], v[80:83], v[48:63]
  v_mfma_f32_32x32x16_bf16 v[64:79], v[100:103], v[80:83], v[64:79]
  v_add_u32 v138, 110592, v130
  v_add_u32 v142, 110592, v134
  ds_read_b128 v[80:83], v138
  ds_read_b128 v[84:87], v142 offset:0
  ds_read_b128 v[88:91], v142 offset:4096
  ds_read_b128 v[92:95], v142 offset:8192
  ds_read_b128 v[96:99], v142 offset:12288
  ds_read_b128 v[100:103], v142 offset:16384
  s_waitcnt lgkmcnt(6)
  v_mfma_f32_32x32x16_bf16 v[0:15], v[108:111], v[104:107], v[0:15]
  v_mfma_f32_32x32x16_bf16 v[16:31], v[112:115], v[104:107], v[16:31]
  v_mfma_f32_32x32x16_bf16 v[32:47], v[116:119], v[104:107], v[32:47]
  v_mfma_f32_32x32x16_bf16 v[48:63], v[120:123], v[104:107], v[48:63]
  v_mfma_f32_32x32x16_bf16 v[64:79], v[124:127], v[104:107], v[64:79]
  v_add_u32 v138, 110592, v131
  v_add_u32 v142, 110592, v135
  ds_read_b128 v[104:107], v138
  ds_read_b128 v[108:111], v142 offset:0
  ds_read_b128 v[112:115], v142 offset:4096
  ds_read_b128 v[116:119], v142 offset:8192
  ds_read_b128 v[120:123], v142 offset:12288
  ds_read_b128 v[124:127], v142 offset:16384
  s_waitcnt lgkmcnt(6)
  v_mfma_f32_32x32x16_bf16 v[0:15], v[84:87], v[80:83], v[0:15]
  v_mfma_f32_32x32x16_bf16 v[16:31], v[88:91], v[80:83], v[16:31]
  v_mfma_f32_32x32x16_bf16 v[32:47], v[92:95], v[80:83], v[32:47]
  v_mfma_f32_32x32x16_bf16 v[48:63], v[96:99], v[80:83], v[48:63]
  v_mfma_f32_32x32x16_bf16 v[64:79], v[100:103], v[80:83], v[64:79]
  v_add_u32 v138, 110592, v132
  v_add_u32 v142, 110592, v136
  ds_read_b128 v[80:83], v138
  ds_read_b128 v[84:87], v142 offset:0
  ds_read_b128 v[88:91], v142 offset:4096
  ds_read_b128 v[92:95], v142 offset:8192
  ds_read_b128 v[96:99], v142 offset:12288
  ds_read_b128 v[100:103], v142 offset:16384
  s_waitcnt lgkmcnt(6)
  v_mfma_f32_32x32x16_bf16 v[0:15], v[108:111], v[104:107], v[0:15]
  s_waitcnt vmcnt(9)
  s_barrier
  v_mfma_f32_32x32x16_bf16 v[16:31], v[112:115], v[104:107], v[16:31]
  s_add_u32 m0, s51, 73728
  s_add_u32 s56, s48, 1280
  buffer_load_dwordx4 v190, s[16:19], s56 offen lds
  s_add_u32 m0, s51, 74752
  v_mfma_f32_32x32x16_bf16 v[32:47], v[116:119], v[104:107], v[32:47]
  s_add_u32 s56, s48, 38144
  buffer_load_dwordx4 v191, s[16:19], s56 offen lds
  s_add_u32 m0, s51, 75776
  s_add_u32 s56, s48, 75008
  v_mfma_f32_32x32x16_bf16 v[48:63], v[120:123], v[104:107], v[48:63]
  buffer_load_dwordx4 v190, s[16:19], s56 offen lds
  s_add_u32 m0, s51, 76800
  s_add_u32 s56, s48, 111872
  buffer_load_dwordx4 v191, s[16:19], s56 offen lds
  v_mfma_f32_32x32x16_bf16 v[64:79], v[124:127], v[104:107], v[64:79]
  s_add_u32 m0, s52, 73728
  s_add_u32 s56, s49, 1280
  buffer_load_dwordx4 v192, s[16:19], s56 offen lds
  s_add_u32 m0, s52, 74752
  v_add_u32 v138, 110592, v133
  v_add_u32 v142, 110592, v137
  ds_read_b128 v[104:107], v138
  ds_read_b128 v[108:111], v142 offset:0
  ds_read_b128 v[112:115], v142 offset:4096
  ds_read_b128 v[116:119], v142 offset:8192
  ds_read_b128 v[120:123], v142 offset:12288
  ds_read_b128 v[124:127], v142 offset:16384
  s_waitcnt lgkmcnt(6)
  v_mfma_f32_32x32x16_bf16 v[0:15], v[84:87], v[80:83], v[0:15]
  s_add_u32 s56, s49, 38144
  buffer_load_dwordx4 v193, s[16:19], s56 offen lds
  s_add_u32 m0, s52, 75776
  s_add_u32 s56, s49, 75008
  v_mfma_f32_32x32x16_bf16 v[16:31], v[88:91], v[80:83], v[16:31]
  buffer_load_dwordx4 v192, s[16:19], s56 offen lds
  s_add_u32 m0, s52, 76800
  s_add_u32 s56, s49, 111872
  buffer_load_dwordx4 v193, s[16:19], s56 offen lds
  v_mfma_f32_32x32x16_bf16 v[32:47], v[92:95], v[80:83], v[32:47]
  s_add_u32 m0, s52, 77824
  s_add_u32 s56, s49, 148736
  buffer_load_dwordx4 v192, s[16:19], s56 offen lds
  v_mfma_f32_32x32x16_bf16 v[48:63], v[96:99], v[80:83], v[48:63]
  v_mfma_f32_32x32x16_bf16 v[64:79], v[100:103], v[80:83], v[64:79]
  v_add_u32 v138, 0, v130
  v_add_u32 v142, 0, v134
  ds_read_b128 v[80:83], v138
  ds_read_b128 v[84:87], v142 offset:0
  ds_read_b128 v[88:91], v142 offset:4096
  ds_read_b128 v[92:95], v142 offset:8192
  ds_read_b128 v[96:99], v142 offset:12288
  ds_read_b128 v[100:103], v142 offset:16384
  s_waitcnt lgkmcnt(6)
  v_mfma_f32_32x32x16_bf16 v[0:15], v[108:111], v[104:107], v[0:15]
  v_mfma_f32_32x32x16_bf16 v[16:31], v[112:115], v[104:107], v[16:31]
  v_mfma_f32_32x32x16_bf16 v[32:47], v[116:119], v[104:107], v[32:47]
  v_mfma_f32_32x32x16_bf16 v[48:63], v[120:123], v[104:107], v[48:63]
  v_mfma_f32_32x32x16_bf16 v[64:79], v[124:127], v[104:107], v[64:79]
  v_add_u32 v138, 0, v131
  v_add_u32 v142, 0, v135
  ds_read_b128 v[104:107], v138
  ds_read_b128 v[108:111], v142 offset:0
  ds_read_b128 v[112:115], v142 offset:4096
  ds_read_b128 v[116:119], v142 offset:8192
  ds_read_b128 v[120:123], v142 offset:12288
  ds_read_b128 v[124:127], v142 offset:16384
  s_waitcnt lgkmcnt(6)
  v_mfma_f32_32x32x16_bf16 v[0:15], v[84:87], v[80:83], v[0:15]
  v_mfma_f32_32x32x16_bf16 v[16:31], v[88:91], v[80:83], v[16:31]
  v_mfma_f32_32x32x16_bf16 v[32:47], v[92:95], v[80:83], v[32:47]
  v_mfma_f32_32x32x16_bf16 v[48:63], v[96:99], v[80:83], v[48:63]
  v_mfma_f32_32x32x16_bf16 v[64:79], v[100:103], v[80:83], v[64:79]
  v_add_u32 v138, 0, v132
  v_add_u32 v142, 0, v136
  ds_read_b128 v[80:83], v138
  ds_read_b128 v[84:87], v142 offset:0
  ds_read_b128 v[88:91], v142 offset:4096
  ds_read_b128 v[92:95], v142 offset:8192
  ds_read_b128 v[96:99], v142 offset:12288
  ds_read_b128 v[100:103], v142 offset:16384
  s_waitcnt lgkmcnt(6)
  v_mfma_f32_32x32x16_bf16 v[0:15], v[108:111], v[104:107], v[0:15]
  s_waitcnt vmcnt(9)
  s_barrier
  v_mfma_f32_32x32x16_bf16 v[16:31], v[112:115], v[104:107], v[16:31]
  s_add_u32 m0, s51, 110592
  s_add_u32 s56, s48, 1408
  buffer_load_dwordx4 v190, s[16:19], s56 offen lds
  s_add_u32 m0, s51, 111616
  v_mfma_f32_32x32x16_bf16 v[32:47], v[116:119], v[104:107], v[32:47]
  s_add_u32 s56, s48, 38272
  buffer_load_dwordx4 v191, s[16:19], s56 offen lds
  s_add_u32 m0, s51, 112640
  s_add_u32 s56, s48, 75136
  v_mfma_f32_32x32x16_bf16 v[48:63], v[120:123], v[104:107], v[48:63]
  buffer_load_dwordx4 v190, s[16:19], s56 offen lds
  s_add_u32 m0, s51, 113664
  s_add_u32 s56, s48, 112000
  buffer_load_dwordx4 v191, s[16:19], s56 offen lds
  v_mfma_f32_32x32x16_bf16 v[64:79], v[124:127], v[104:107], v[64:79]
  s_add_u32 m0, s52, 110592
  s_add_u32 s56, s49, 1408
  buffer_load_dwordx4 v192, s[16:19], s56 offen lds
  s_add_u32 m0, s52, 111616
  v_add_u32 v138, 0, v133
  v_add_u32 v142, 0, v137
  ds_read_b128 v[104:107], v138
  ds_read_b128 v[108:111], v142 offset:0
  ds_read_b128 v[112:115], v142 offset:4096
  ds_read_b128 v[116:119], v142 offset:8192
  ds_read_b128 v[120:123], v142 offset:12288
  ds_read_b128 v[124:127], v142 offset:16384
  s_waitcnt lgkmcnt(6)
  v_mfma_f32_32x32x16_bf16 v[0:15], v[84:87], v[80:83], v[0:15]
  s_add_u32 s56, s49, 38272
  buffer_load_dwordx4 v193, s[16:19], s56 offen lds
  s_add_u32 m0, s52, 112640
  s_add_u32 s56, s49, 75136
  v_mfma_f32_32x32x16_bf16 v[16:31], v[88:91], v[80:83], v[16:31]
  buffer_load_dwordx4 v192, s[16:19], s56 offen lds
  s_add_u32 m0, s52, 113664
  s_add_u32 s56, s49, 112000
  buffer_load_dwordx4 v193, s[16:19], s56 offen lds
  v_mfma_f32_32x32x16_bf16 v[32:47], v[92:95], v[80:83], v[32:47]
  s_add_u32 m0, s52, 114688
  s_add_u32 s56, s49, 148864
  buffer_load_dwordx4 v192, s[16:19], s56 offen lds
  v_mfma_f32_32x32x16_bf16 v[48:63], v[96:99], v[80:83], v[48:63]
  v_mfma_f32_32x32x16_bf16 v[64:79], v[100:103], v[80:83], v[64:79]
  v_add_u32 v138, 36864, v130
  v_add_u32 v142, 36864, v134
  ds_read_b128 v[80:83], v138
  ds_read_b128 v[84:87], v142 offset:0
  ds_read_b128 v[88:91], v142 offset:4096
  ds_read_b128 v[92:95], v142 offset:8192
  ds_read_b128 v[96:99], v142 offset:12288
  ds_read_b128 v[100:103], v142 offset:16384
  s_waitcnt lgkmcnt(6)
  v_mfma_f32_32x32x16_bf16 v[0:15], v[108:111], v[104:107], v[0:15]
  v_mfma_f32_32x32x16_bf16 v[16:31], v[112:115], v[104:107], v[16:31]
  v_mfma_f32_32x32x16_bf16 v[32:47], v[116:119], v[104:107], v[32:47]
  v_mfma_f32_32x32x16_bf16 v[48:63], v[120:123], v[104:107], v[48:63]
  v_mfma_f32_32x32x16_bf16 v[64:79], v[124:127], v[104:107], v[64:79]
  v_add_u32 v138, 36864, v131
  v_add_u32 v142, 36864, v135
  ds_read_b128 v[104:107], v138
  ds_read_b128 v[108:111], v142 offset:0
  ds_read_b128 v[112:115], v142 offset:4096
  ds_read_b128 v[116:119], v142 offset:8192
  ds_read_b128 v[120:123], v142 offset:12288
  ds_read_b128 v[124:127], v142 offset:16384
  s_waitcnt lgkmcnt(6)
  v_mfma_f32_32x32x16_bf16 v[0:15], v[84:87], v[80:83], v[0:15]
  v_mfma_f32_32x32x16_bf16 v[16:31], v[88:91], v[80:83], v[16:31]
  v_mfma_f32_32x32x16_bf16 v[32:47], v[92:95], v[80:83], v[32:47]
  v_mfma_f32_32x32x16_bf16 v[48:63], v[96:99], v[80:83], v[48:63]
  v_mfma_f32_32x32x16_bf16 v[64:79], v[100:103], v[80:83], v[64:79]
  v_add_u32 v138, 36864, v132
  v_add_u32 v142, 36864, v136
  ds_read_b128 v[80:83], v138
  ds_read_b128 v[84:87], v142 offset:0
  ds_read_b128 v[88:91], v142 offset:4096
  ds_read_b128 v[92:95], v142 offset:8192
  ds_read_b128 v[96:99], v142 offset:12288
  ds_read_b128 v[100:103], v142 offset:16384
  s_waitcnt lgkmcnt(6)
  v_mfma_f32_32x32x16_bf16 v[0:15], v[108:111], v[104:107], v[0:15]
  s_waitcnt vmcnt(9)
  s_barrier
  v_mfma_f32_32x32x16_bf16 v[16:31], v[112:115], v[104:107], v[16:31]
  v_mfma_f32_32x32x16_bf16 v[32:47], v[116:119], v[104:107], v[32:47]
  v_mfma_f32_32x32x16_bf16 v[48:63], v[120:123], v[104:107], v[48:63]
  v_mfma_f32_32x32x16_bf16 v[64:79], v[124:127], v[104:107], v[64:79]
  v_add_u32 v138, 36864, v133
  v_add_u32 v142, 36864, v137
  ds_read_b128 v[104:107], v138
  ds_read_b128 v[108:111], v142 offset:0
  ds_read_b128 v[112:115], v142 offset:4096
  ds_read_b128 v[116:119], v142 offset:8192
  ds_read_b128 v[120:123], v142 offset:12288
  ds_read_b128 v[124:127], v142 offset:16384
  s_waitcnt lgkmcnt(6)
  v_mfma_f32_32x32x16_bf16 v[0:15], v[84:87], v[80:83], v[0:15]
  v_mfma_f32_32x32x16_bf16 v[16:31], v[88:91], v[80:83], v[16:31]
  v_mfma_f32_32x32x16_bf16 v[32:47], v[92:95], v[80:83], v[32:47]
  v_mfma_f32_32x32x16_bf16 v[48:63], v[96:99], v[80:83], v[48:63]
  v_mfma_f32_32x32x16_bf16 v[64:79], v[100:103], v[80:83], v[64:79]
  v_add_u32 v138, 73728, v130
  v_add_u32 v142, 73728, v134
  ds_read_b128 v[80:83], v138
  ds_read_b128 v[84:87], v142 offset:0
  ds_read_b128 v[88:91], v142 offset:4096
  ds_read_b128 v[92:95], v142 offset:8192
  ds_read_b128 v[96:99], v142 offset:12288
  ds_read_b128 v[100:103], v142 offset:16384
  s_waitcnt lgkmcnt(6)
  v_mfma_f32_32x32x16_bf16 v[0:15], v[108:111], v[104:107], v[0:15]
  v_mfma_f32_32x32x16_bf16 v[16:31], v[112:115], v[104:107], v[16:31]
  v_mfma_f32_32x32x16_bf16 v[32:47], v[116:119], v[104:107], v[32:47]
  v_mfma_f32_32x32x16_bf16 v[48:63], v[120:123], v[104:107], v[48:63]
  v_mfma_f32_32x32x16_bf16 v[64:79], v[124:127], v[104:107], v[64:79]
  v_add_u32 v138, 73728, v131
  v_add_u32 v142, 73728, v135
  ds_read_b128 v[104:107], v138
  ds_read_b128 v[108:111], v142 offset:0
  ds_read_b128 v[112:115], v142 offset:4096
  ds_read_b128 v[116:119], v142 offset:8192
  ds_read_b128 v[120:123], v142 offset:12288
  ds_read_b128 v[124:127], v142 offset:16384
  s_waitcnt lgkmcnt(6)
  v_mfma_f32_32x32x16_bf16 v[0:15], v[84:87], v[80:83], v[0:15]
  v_mfma_f32_32x32x16_bf16 v[16:31], v[88:91], v[80:83], v[16:31]
  v_mfma_f32_32x32x16_bf16 v[32:47], v[92:95], v[80:83], v[32:47]
  v_mfma_f32_32x32x16_bf16 v[48:63], v[96:99], v[80:83], v[48:63]
  v_mfma_f32_32x32x16_bf16 v[64:79], v[100:103], v[80:83], v[64:79]
  v_add_u32 v138, 73728, v132
  v_add_u32 v142, 73728, v136
  ds_read_b128 v[80:83], v138
  ds_read_b128 v[84:87], v142 offset:0
  ds_read_b128 v[88:91], v142 offset:4096
  ds_read_b128 v[92:95], v142 offset:8192
  ds_read_b128 v[96:99], v142 offset:12288
  ds_read_b128 v[100:103], v142 offset:16384
  s_waitcnt lgkmcnt(6)
  v_mfma_f32_32x32x16_bf16 v[0:15], v[108:111], v[104:107], v[0:15]
  s_waitcnt vmcnt(0)
  s_barrier
  v_mfma_f32_32x32x16_bf16 v[16:31], v[112:115], v[104:107], v[16:31]
  v_mfma_f32_32x32x16_bf16 v[32:47], v[116:119], v[104:107], v[32:47]
  v_mfma_f32_32x32x16_bf16 v[48:63], v[120:123], v[104:107], v[48:63]
  v_mfma_f32_32x32x16_bf16 v[64:79], v[124:127], v[104:107], v[64:79]
  v_add_u32 v138, 73728, v133
  v_add_u32 v142, 73728, v137
  ds_read_b128 v[104:107], v138
  ds_read_b128 v[108:111], v142 offset:0
  ds_read_b128 v[112:115], v142 offset:4096
  ds_read_b128 v[116:119], v142 offset:8192
  ds_read_b128 v[120:123], v142 offset:12288
  ds_read_b128 v[124:127], v142 offset:16384
  s_waitcnt lgkmcnt(6)
  v_mfma_f32_32x32x16_bf16 v[0:15], v[84:87], v[80:83], v[0:15]
  v_mfma_f32_32x32x16_bf16 v[16:31], v[88:91], v[80:83], v[16:31]
  v_mfma_f32_32x32x16_bf16 v[32:47], v[92:95], v[80:83], v[32:47]
  v_mfma_f32_32x32x16_bf16 v[48:63], v[96:99], v[80:83], v[48:63]
  v_mfma_f32_32x32x16_bf16 v[64:79], v[100:103], v[80:83], v[64:79]
  v_add_u32 v138, 110592, v130
  v_add_u32 v142, 110592, v134
  ds_read_b128 v[80:83], v138
  ds_read_b128 v[84:87], v142 offset:0
  ds_read_b128 v[88:91], v142 offset:4096
  ds_read_b128 v[92:95], v142 offset:8192
  ds_read_b128 v[96:99], v142 offset:12288
  ds_read_b128 v[100:103], v142 offset:16384
  s_waitcnt lgkmcnt(6)
  v_mfma_f32_32x32x16_bf16 v[0:15], v[108:111], v[104:107], v[0:15]
  v_mfma_f32_32x32x16_bf16 v[16:31], v[112:115], v[104:107], v[16:31]
  v_mfma_f32_32x32x16_bf16 v[32:47], v[116:119], v[104:107], v[32:47]
  v_mfma_f32_32x32x16_bf16 v[48:63], v[120:123], v[104:107], v[48:63]
  v_mfma_f32_32x32x16_bf16 v[64:79], v[124:127], v[104:107], v[64:79]
  v_add_u32 v138, 110592, v131
  v_add_u32 v142, 110592, v135
  ds_read_b128 v[104:107], v138
  ds_read_b128 v[108:111], v142 offset:0
  ds_read_b128 v[112:115], v142 offset:4096
  ds_read_b128 v[116:119], v142 offset:8192
  ds_read_b128 v[120:123], v142 offset:12288
  ds_read_b128 v[124:127], v142 offset:16384
  s_waitcnt lgkmcnt(6)
  v_mfma_f32_32x32x16_bf16 v[0:15], v[84:87], v[80:83], v[0:15]
  v_mfma_f32_32x32x16_bf16 v[16:31], v[88:91], v[80:83], v[16:31]
  v_mfma_f32_32x32x16_bf16 v[32:47], v[92:95], v[80:83], v[32:47]
  v_mfma_f32_32x32x16_bf16 v[48:63], v[96:99], v[80:83], v[48:63]
  v_mfma_f32_32x32x16_bf16 v[64:79], v[100:103], v[80:83], v[64:79]
  v_add_u32 v138, 110592, v132
  v_add_u32 v142, 110592, v136
  ds_read_b128 v[80:83], v138
  ds_read_b128 v[84:87], v142 offset:0
  ds_read_b128 v[88:91], v142 offset:4096
  ds_read_b128 v[92:95], v142 offset:8192
  ds_read_b128 v[96:99], v142 offset:12288
  ds_read_b128 v[100:103], v142 offset:16384
  s_waitcnt lgkmcnt(6)
  v_mfma_f32_32x32x16_bf16 v[0:15], v[108:111], v[104:107], v[0:15]
  v_mfma_f32_32x32x16_bf16 v[16:31], v[112:115], v[104:107], v[16:31]
  v_mfma_f32_32x32x16_bf16 v[32:47], v[116:119], v[104:107], v[32:47]
  v_mfma_f32_32x32x16_bf16 v[48:63], v[120:123], v[104:107], v[48:63]
  v_mfma_f32_32x32x16_bf16 v[64:79], v[124:127], v[104:107], v[64:79]
  v_add_u32 v138, 110592, v133
  v_add_u32 v142, 110592, v137
  ds_read_b128 v[104:107], v138
  ds_read_b128 v[108:111], v142 offset:0
  ds_read_b128 v[112:115], v142 offset:4096
  ds_read_b128 v[116:119], v142 offset:8192
  ds_read_b128 v[120:123], v142 offset:12288
  ds_read_b128 v[124:127], v142 offset:16384
  s_waitcnt lgkmcnt(6)
  v_mfma_f32_32x32x16_bf16 v[0:15], v[84:87], v[80:83], v[0:15]
  v_mfma_f32_32x32x16_bf16 v[16:31], v[88:91], v[80:83], v[16:31]
  v_mfma_f32_32x32x16_bf16 v[32:47], v[92:95], v[80:83], v[32:47]
  v_mfma_f32_32x32x16_bf16 v[48:63], v[96:99], v[80:83], v[48:63]
  v_mfma_f32_32x32x16_bf16 v[64:79], v[100:103], v[80:83], v[64:79]
  s_waitcnt lgkmcnt(0)
  v_mfma_f32_32x32x16_bf16 v[0:15], v[108:111], v[104:107], v[0:15]
  v_mfma_f32_32x32x16_bf16 v[16:31], v[112:115], v[104:107], v[16:31]
  v_mfma_f32_32x32x16_bf16 v[32:47], v[116:119], v[104:107], v[32:47]
  v_mfma_f32_32x32x16_bf16 v[48:63], v[120:123], v[104:107], v[48:63]
  v_mfma_f32_32x32x16_bf16 v[64:79], v[124:127], v[104:107], v[64:79]
  v_lshlrev_b32 v208, 6, v201
  v_add_u32 v208, v208, v200
  s_lshr_b32 s100, s2, 3
  s_cmp_ge_u32 s100, 18
  s_cbranch_scc1 PFW_k3S5
  s_lshl_b32 s100, s100, 8
  v_add_u32 v209, s100, v208
  v_mul_u32_u24 v210, 10923, v209
  v_lshrrev_b32 v210, 16, v210
  v_mul_u32_u24 v211, 6, v210
  v_sub_u32 v211, v209, v211
  v_mul_u32_u24 v210, 1536, v210
  v_lshl_add_u32 v210, v211, 7, v210
  s_and_b32 s100, s2, 1
  s_mul_i32 s100, s100, 768
  v_add_u32 v210, s100, v210
  s_waitcnt lgkmcnt(0)
  global_load_dword v211, v210, s[10:11]
PFW_k3S5:

  s_nop 15
  s_nop 7
  v_max3_f32 v150, v0, v1, v2
  v_max3_f32 v151, v3, v4, v5
  v_max3_f32 v150, v150, v6, v7
  v_max3_f32 v151, v151, v8, v9
  v_max3_f32 v150, v150, v10, v11
  v_max3_f32 v151, v151, v12, v13
  v_max3_f32 v150, v150, v14, v15
  v_max3_f32 v151, v151, v16, v17
  v_max3_f32 v150, v150, v18, v19
  v_max3_f32 v151, v151, v20, v21
  v_max3_f32 v150, v150, v22, v23
  v_max3_f32 v151, v151, v24, v25
  v_max3_f32 v150, v150, v26, v27
  v_max3_f32 v151, v151, v28, v29
  v_max3_f32 v150, v150, v30, v31
  v_max3_f32 v151, v151, v32, v33
  v_max3_f32 v150, v150, v34, v35
  v_max3_f32 v151, v151, v36, v37
  v_max3_f32 v150, v150, v38, v39
  v_max3_f32 v151, v151, v40, v41
  v_max3_f32 v150, v150, v42, v43
  v_max3_f32 v151, v151, v44, v45
  v_max3_f32 v150, v150, v46, v47
  v_max3_f32 v151, v151, v48, v49
  v_max3_f32 v150, v150, v50, v51
  v_max3_f32 v151, v151, v52, v53
  v_max3_f32 v150, v150, v54, v55
  v_max3_f32 v151, v151, v56, v57
  v_max3_f32 v150, v150, v58, v59
  v_max3_f32 v151, v151, v60, v61
  v_max3_f32 v150, v150, v62, v63
  v_max3_f32 v151, v151, v64, v65
  v_max3_f32 v150, v150, v66, v67
  v_max3_f32 v151, v151, v68, v69
  v_max3_f32 v150, v150, v70, v71
  v_max3_f32 v151, v151, v72, v73
  v_max3_f32 v150, v150, v74, v75
  v_max3_f32 v151, v151, v76, v77
  v_max3_f32 v150, v150, v78, v79
  v_max_f32 v150, v150, v151
  v_mov_b32 v151, v150
  s_nop 1
  v_permlane32_swap_b32 v150, v151
  s_nop 1
  v_max_f32 v150, v150, v151
  s_mov_b32 s53, 0x3d553b95
  v_mul_f32 v150, s53, v150
  v_sub_f32 v152, 0, v150
  v_mov_b32 v153, s53

  v_fma_f32 v0, v0, v153, v152
  v_fma_f32 v1, v1, v153, v152
  v_fma_f32 v2, v2, v153, v152
  v_fma_f32 v3, v3, v153, v152
  v_fma_f32 v4, v4, v153, v152
  v_fma_f32 v5, v5, v153, v152
  v_fma_f32 v6, v6, v153, v152
  v_fma_f32 v7, v7, v153, v152
  v_fma_f32 v8, v8, v153, v152
  v_fma_f32 v9, v9, v153, v152
  v_fma_f32 v10, v10, v153, v152
  v_fma_f32 v11, v11, v153, v152
  v_fma_f32 v12, v12, v153, v152
  v_fma_f32 v13, v13, v153, v152
  v_fma_f32 v14, v14, v153, v152
  v_fma_f32 v15, v15, v153, v152
  v_fma_f32 v16, v16, v153, v152
  v_fma_f32 v17, v17, v153, v152
  v_fma_f32 v18, v18, v153, v152
  v_fma_f32 v19, v19, v153, v152
  v_fma_f32 v20, v20, v153, v152
  v_fma_f32 v21, v21, v153, v152
  v_fma_f32 v22, v22, v153, v152
  v_fma_f32 v23, v23, v153, v152
  v_fma_f32 v24, v24, v153, v152
  v_fma_f32 v25, v25, v153, v152
  v_fma_f32 v26, v26, v153, v152
  v_fma_f32 v27, v27, v153, v152
  v_fma_f32 v28, v28, v153, v152
  v_fma_f32 v29, v29, v153, v152
  v_fma_f32 v30, v30, v153, v152
  v_fma_f32 v31, v31, v153, v152
  v_fma_f32 v32, v32, v153, v152
  v_fma_f32 v33, v33, v153, v152
  v_fma_f32 v34, v34, v153, v152
  v_fma_f32 v35, v35, v153, v152
  v_fma_f32 v36, v36, v153, v152
  v_fma_f32 v37, v37, v153, v152
  v_fma_f32 v38, v38, v153, v152
  v_fma_f32 v39, v39, v153, v152
  v_fma_f32 v40, v40, v153, v152
  v_fma_f32 v41, v41, v153, v152
  v_fma_f32 v42, v42, v153, v152
  v_fma_f32 v43, v43, v153, v152
  v_fma_f32 v44, v44, v153, v152
  v_fma_f32 v45, v45, v153, v152
  v_fma_f32 v46, v46, v153, v152
  v_fma_f32 v47, v47, v153, v152
  v_fma_f32 v48, v48, v153, v152
  v_fma_f32 v49, v49, v153, v152
  v_fma_f32 v50, v50, v153, v152
  v_fma_f32 v51, v51, v153, v152
  v_fma_f32 v52, v52, v153, v152
  v_fma_f32 v53, v53, v153, v152
  v_fma_f32 v54, v54, v153, v152
  v_fma_f32 v55, v55, v153, v152
  v_fma_f32 v56, v56, v153, v152
  v_fma_f32 v57, v57, v153, v152
  v_fma_f32 v58, v58, v153, v152
  v_fma_f32 v59, v59, v153, v152
  v_fma_f32 v60, v60, v153, v152
  v_fma_f32 v61, v61, v153, v152
  v_fma_f32 v62, v62, v153, v152
  v_fma_f32 v63, v63, v153, v152
  v_fma_f32 v64, v64, v153, v152
  v_fma_f32 v65, v65, v153, v152
  v_fma_f32 v66, v66, v153, v152
  v_fma_f32 v67, v67, v153, v152
  v_fma_f32 v68, v68, v153, v152
  v_fma_f32 v69, v69, v153, v152
  v_fma_f32 v70, v70, v153, v152
  v_fma_f32 v71, v71, v153, v152
  v_fma_f32 v72, v72, v153, v152
  v_fma_f32 v73, v73, v153, v152
  v_fma_f32 v74, v74, v153, v152
  v_fma_f32 v75, v75, v153, v152
  v_fma_f32 v76, v76, v153, v152
  v_fma_f32 v77, v77, v153, v152
  v_fma_f32 v78, v78, v153, v152
  v_fma_f32 v79, v79, v153, v152
  v_exp_f32 v0, v0
  v_exp_f32 v1, v1
  v_exp_f32 v2, v2
  v_exp_f32 v3, v3
  v_exp_f32 v4, v4
  v_exp_f32 v5, v5
  v_exp_f32 v6, v6
  v_exp_f32 v7, v7
  v_exp_f32 v8, v8
  v_exp_f32 v9, v9
  v_exp_f32 v10, v10
  v_exp_f32 v11, v11
  v_exp_f32 v12, v12
  v_exp_f32 v13, v13
  v_exp_f32 v14, v14
  v_exp_f32 v15, v15
  v_exp_f32 v16, v16
  v_exp_f32 v17, v17
  v_exp_f32 v18, v18
  v_exp_f32 v19, v19
  v_exp_f32 v20, v20
  v_exp_f32 v21, v21
  v_exp_f32 v22, v22
  v_exp_f32 v23, v23
  v_exp_f32 v24, v24
  v_exp_f32 v25, v25
  v_exp_f32 v26, v26
  v_exp_f32 v27, v27
  v_exp_f32 v28, v28
  v_exp_f32 v29, v29
  v_exp_f32 v30, v30
  v_exp_f32 v31, v31
  v_exp_f32 v32, v32
  v_exp_f32 v33, v33
  v_exp_f32 v34, v34
  v_exp_f32 v35, v35
  v_exp_f32 v36, v36
  v_exp_f32 v37, v37
  v_exp_f32 v38, v38
  v_exp_f32 v39, v39
  v_exp_f32 v40, v40
  v_exp_f32 v41, v41
  v_exp_f32 v42, v42
  v_exp_f32 v43, v43
  v_exp_f32 v44, v44
  v_exp_f32 v45, v45
  v_exp_f32 v46, v46
  v_exp_f32 v47, v47
  v_exp_f32 v48, v48
  v_exp_f32 v49, v49
  v_exp_f32 v50, v50
  v_exp_f32 v51, v51
  v_exp_f32 v52, v52
  v_exp_f32 v53, v53
  v_exp_f32 v54, v54
  v_exp_f32 v55, v55
  v_exp_f32 v56, v56
  v_exp_f32 v57, v57
  v_exp_f32 v58, v58
  v_exp_f32 v59, v59
  v_exp_f32 v60, v60
  v_exp_f32 v61, v61
  v_exp_f32 v62, v62
  v_exp_f32 v63, v63
  v_exp_f32 v64, v64
  v_exp_f32 v65, v65
  v_exp_f32 v66, v66
  v_exp_f32 v67, v67
  v_exp_f32 v68, v68
  v_exp_f32 v69, v69
  v_exp_f32 v70, v70
  v_exp_f32 v71, v71
  v_exp_f32 v72, v72
  v_exp_f32 v73, v73
  v_exp_f32 v74, v74
  v_exp_f32 v75, v75
  v_exp_f32 v76, v76
  v_exp_f32 v77, v77
  v_exp_f32 v78, v78
  v_exp_f32 v79, v79
  s_nop 0
  v_add_f32 v154, v0, v1
  v_add_f32 v155, v2, v3
  v_add_f32 v154, v154, v4
  v_add_f32 v155, v155, v5
  v_add_f32 v154, v154, v6
  v_add_f32 v155, v155, v7
  v_add_f32 v154, v154, v8
  v_add_f32 v155, v155, v9
  v_add_f32 v154, v154, v10
  v_add_f32 v155, v155, v11
  v_add_f32 v154, v154, v12
  v_add_f32 v155, v155, v13
  v_add_f32 v154, v154, v14
  v_add_f32 v155, v155, v15
  v_add_f32 v154, v154, v16
  v_add_f32 v155, v155, v17
  v_add_f32 v154, v154, v18
  v_add_f32 v155, v155, v19
  v_add_f32 v154, v154, v20
  v_add_f32 v155, v155, v21
  v_add_f32 v154, v154, v22
  v_add_f32 v155, v155, v23
  v_add_f32 v154, v154, v24
  v_add_f32 v155, v155, v25
  v_add_f32 v154, v154, v26
  v_add_f32 v155, v155, v27
  v_add_f32 v154, v154, v28
  v_add_f32 v155, v155, v29
  v_add_f32 v154, v154, v30
  v_add_f32 v155, v155, v31
  v_add_f32 v154, v154, v32
  v_add_f32 v155, v155, v33
  v_add_f32 v154, v154, v34
  v_add_f32 v155, v155, v35
  v_add_f32 v154, v154, v36
  v_add_f32 v155, v155, v37
  v_add_f32 v154, v154, v38
  v_add_f32 v155, v155, v39
  v_add_f32 v154, v154, v40
  v_add_f32 v155, v155, v41
  v_add_f32 v154, v154, v42
  v_add_f32 v155, v155, v43
  v_add_f32 v154, v154, v44
  v_add_f32 v155, v155, v45
  v_add_f32 v154, v154, v46
  v_add_f32 v155, v155, v47
  v_add_f32 v154, v154, v48
  v_add_f32 v155, v155, v49
  v_add_f32 v154, v154, v50
  v_add_f32 v155, v155, v51
  v_add_f32 v154, v154, v52
  v_add_f32 v155, v155, v53
  v_add_f32 v154, v154, v54
  v_add_f32 v155, v155, v55
  v_add_f32 v154, v154, v56
  v_add_f32 v155, v155, v57
  v_add_f32 v154, v154, v58
  v_add_f32 v155, v155, v59
  v_add_f32 v154, v154, v60
  v_add_f32 v155, v155, v61
  v_add_f32 v154, v154, v62
  v_add_f32 v155, v155, v63
  v_add_f32 v154, v154, v64
  v_add_f32 v155, v155, v65
  v_add_f32 v154, v154, v66
  v_add_f32 v155, v155, v67
  v_add_f32 v154, v154, v68
  v_add_f32 v155, v155, v69
  v_add_f32 v154, v154, v70
  v_add_f32 v155, v155, v71
  v_add_f32 v154, v154, v72
  v_add_f32 v155, v155, v73
  v_add_f32 v154, v154, v74
  v_add_f32 v155, v155, v75
  v_add_f32 v154, v154, v76
  v_add_f32 v155, v155, v77
  v_add_f32 v154, v154, v78
  v_add_f32 v155, v155, v79
  v_add_f32 v154, v154, v155
  v_mov_b32 v155, v154
  s_nop 1
  v_permlane32_swap_b32 v154, v155
  s_nop 1
  v_add_f32 v154, v154, v155
  v_mov_b32 v151, v154
  s_lshl_b32 s53, s42, 7
  s_lshl_b32 s54, s40, 5
  s_add_u32 s53, s53, s54
  s_add_u32 s55, s53, s45
  v_add_u32 v204, s55, v202
  v_lshlrev_b32 v206, 6, v204
  s_lshl_b32 s54, s41, 3

  v_cvt_pk_bf16_f32 v84, v0, v1
  v_cvt_pk_bf16_f32 v85, v2, v3
  v_cvt_pk_bf16_f32 v86, v4, v5
  v_cvt_pk_bf16_f32 v87, v6, v7
  v_cvt_pk_bf16_f32 v88, v8, v9
  v_cvt_pk_bf16_f32 v89, v10, v11
  v_cvt_pk_bf16_f32 v90, v12, v13
  v_cvt_pk_bf16_f32 v91, v14, v15
  v_cvt_pk_bf16_f32 v92, v16, v17
  v_cvt_pk_bf16_f32 v93, v18, v19
  v_cvt_pk_bf16_f32 v94, v20, v21
  v_cvt_pk_bf16_f32 v95, v22, v23
  v_cvt_pk_bf16_f32 v96, v24, v25
  v_cvt_pk_bf16_f32 v97, v26, v27
  v_cvt_pk_bf16_f32 v98, v28, v29
  v_cvt_pk_bf16_f32 v99, v30, v31
  v_cvt_pk_bf16_f32 v100, v32, v33
  v_cvt_pk_bf16_f32 v101, v34, v35
  v_cvt_pk_bf16_f32 v102, v36, v37
  v_cvt_pk_bf16_f32 v103, v38, v39
  v_cvt_pk_bf16_f32 v104, v40, v41
  v_cvt_pk_bf16_f32 v105, v42, v43
  v_cvt_pk_bf16_f32 v106, v44, v45
  v_cvt_pk_bf16_f32 v107, v46, v47
  v_cvt_pk_bf16_f32 v108, v48, v49
  v_cvt_pk_bf16_f32 v109, v50, v51
  v_cvt_pk_bf16_f32 v110, v52, v53
  v_cvt_pk_bf16_f32 v111, v54, v55
  v_cvt_pk_bf16_f32 v112, v56, v57
  v_cvt_pk_bf16_f32 v113, v58, v59
  v_cvt_pk_bf16_f32 v114, v60, v61
  v_cvt_pk_bf16_f32 v115, v62, v63
  v_cvt_pk_bf16_f32 v116, v64, v65
  v_cvt_pk_bf16_f32 v117, v66, v67
  v_cvt_pk_bf16_f32 v118, v68, v69
  v_cvt_pk_bf16_f32 v119, v70, v71
  v_cvt_pk_bf16_f32 v120, v72, v73
  v_cvt_pk_bf16_f32 v121, v74, v75
  v_cvt_pk_bf16_f32 v122, v76, v77
  v_cvt_pk_bf16_f32 v123, v78, v79
  v_mul_u32_u24 v205, 2176, v204
  v_lshl_add_u32 v205, v203, 4, v205
  s_lshl_b32 s56, s41, 8

  buffer_store_dwordx4 v[84:87], v205, s[20:23], s56 offen offset:0
  buffer_store_dwordx4 v[88:91], v205, s[20:23], s56 offen offset:32
  buffer_store_dwordx4 v[92:95], v205, s[20:23], s56 offen offset:64
  buffer_store_dwordx4 v[96:99], v205, s[20:23], s56 offen offset:96
  buffer_store_dwordx4 v[100:103], v205, s[20:23], s56 offen offset:128
  buffer_store_dwordx4 v[104:107], v205, s[20:23], s56 offen offset:160
  buffer_store_dwordx4 v[108:111], v205, s[20:23], s56 offen offset:192
  buffer_store_dwordx4 v[112:115], v205, s[20:23], s56 offen offset:224
  buffer_store_dwordx4 v[116:119], v205, s[20:23], s56 offen offset:256
  buffer_store_dwordx4 v[120:123], v205, s[20:23], s56 offen offset:288
  v_cmp_gt_u32 vcc, 32, v200
  s_and_saveexec_b64 s[56:57], vcc
  buffer_store_dwordx2 v[150:151], v206, s[24:27], s54 offen
  s_mov_b64 exec, s[56:57]

  s_endpgm
K3_S3:
  v_lshrrev_b32 v202, 3, v200
  v_and_b32 v203, 7, v200
  v_lshrrev_b32 v204, 4, v200
  v_xor_b32 v205, v203, v204
  v_xor_b32 v206, 4, v205
  v_mul_u32_u24 v202, 4608, v202
  v_lshl_add_u32 v190, v205, 4, v202
  v_lshl_add_u32 v191, v206, 4, v202

  s_mul_i32 s45, s43, 1056
  s_lshl_b32 s46, s42, 7
  s_add_u32 s46, s46, s45
  s_mul_i32 s47, s41, 96
  s_add_u32 s47, s47, s45
  s_mul_i32 s48, s46, 4608
  s_mul_i32 s49, s47, 4608
  s_add_u32 s49, s49, 1536
  s_mul_i32 s50, s40, 536870912
  s_add_u32 s48, s48, s50
  s_mul_i32 s50, s40, 110592
  s_add_u32 s49, s49, s50
  s_lshl_b32 s51, s40, 12
  s_mul_i32 s52, s40, 3072
  s_add_u32 s52, s52, 16384

  s_and_b32 s53, s40, 1
  s_cmp_eq_u32 s53, 1
  s_cselect_b64 s[54:55], -1, 0
  s_nop 1
  v_cndmask_b32 v192, v190, v191, s[54:55]
  v_cndmask_b32 v193, v191, v190, s[54:55]

  s_add_u32 m0, s51, 0
  s_add_u32 s56, s48, 0
  buffer_load_dwordx4 v190, s[16:19], s56 offen lds
  s_add_u32 m0, s51, 1024
  s_add_u32 s56, s48, 36864
  buffer_load_dwordx4 v191, s[16:19], s56 offen lds
  s_add_u32 m0, s51, 2048
  s_add_u32 s56, s48, 73728
  buffer_load_dwordx4 v190, s[16:19], s56 offen lds
  s_add_u32 m0, s51, 3072
  s_add_u32 s56, s48, 110592
  buffer_load_dwordx4 v191, s[16:19], s56 offen lds
  s_add_u32 m0, s52, 0
  s_add_u32 s56, s49, 0
  buffer_load_dwordx4 v192, s[16:19], s56 offen lds
  s_add_u32 m0, s52, 1024
  s_add_u32 s56, s49, 36864
  buffer_load_dwordx4 v193, s[16:19], s56 offen lds
  s_add_u32 m0, s52, 2048
  s_add_u32 s56, s49, 73728
  buffer_load_dwordx4 v192, s[16:19], s56 offen lds
  s_add_u32 m0, s51, 36864
  s_add_u32 s56, s48, 128
  buffer_load_dwordx4 v190, s[16:19], s56 offen lds
  s_add_u32 m0, s51, 37888
  s_add_u32 s56, s48, 36992
  buffer_load_dwordx4 v191, s[16:19], s56 offen lds
  s_add_u32 m0, s51, 38912
  s_add_u32 s56, s48, 73856
  buffer_load_dwordx4 v190, s[16:19], s56 offen lds
  s_add_u32 m0, s51, 39936
  s_add_u32 s56, s48, 110720
  buffer_load_dwordx4 v191, s[16:19], s56 offen lds
  s_add_u32 m0, s52, 36864
  s_add_u32 s56, s49, 128
  buffer_load_dwordx4 v192, s[16:19], s56 offen lds
  s_add_u32 m0, s52, 37888
  s_add_u32 s56, s49, 36992
  buffer_load_dwordx4 v193, s[16:19], s56 offen lds
  s_add_u32 m0, s52, 38912
  s_add_u32 s56, s49, 73856
  buffer_load_dwordx4 v192, s[16:19], s56 offen lds
  v_and_b32 v202, 31, v200
  v_lshrrev_b32 v203, 5, v200
  v_bfe_u32 v204, v202, 1, 3
  v_xor_b32 v204, v204, v203
  v_lshlrev_b32 v204, 4, v204
  v_lshl_add_u32 v204, v202, 7, v204
  s_lshl_b32 s53, s40, 12
  v_add_u32 v130, 0, v204

  v_and_b32 v204, 3, v202
  v_bfe_u32 v205, v202, 2, 1
  v_lshl_add_u32 v204, v205, 3, v204
  v_bfe_u32 v205, v202, 3, 1
  v_lshl_add_u32 v204, v205, 2, v204
  v_bfe_u32 v205, v202, 4, 1
  v_lshl_add_u32 v204, v205, 4, v204

  v_bfe_u32 v205, v204, 1, 3
  v_xor_b32 v205, v205, v203
  v_lshlrev_b32 v205, 4, v205
  v_lshl_add_u32 v205, v204, 7, v205
  v_add_u32 v134, 16384, v205

  v_xor_b32 v131, 32, v130
  v_xor_b32 v135, 32, v134
  v_xor_b32 v132, 64, v130
  v_xor_b32 v136, 64, v134
  v_xor_b32 v133, 96, v130
  v_xor_b32 v137, 96, v134
  s_add_u32 m0, s51, 73728
  s_add_u32 s56, s48, 256
  buffer_load_dwordx4 v190, s[16:19], s56 offen lds
  s_add_u32 m0, s51, 74752
  s_add_u32 s56, s48, 37120
  buffer_load_dwordx4 v191, s[16:19], s56 offen lds
  s_add_u32 m0, s51, 75776
  s_add_u32 s56, s48, 73984
  buffer_load_dwordx4 v190, s[16:19], s56 offen lds
  s_add_u32 m0, s51, 76800
  s_add_u32 s56, s48, 110848
  buffer_load_dwordx4 v191, s[16:19], s56 offen lds
  s_add_u32 m0, s52, 73728
  s_add_u32 s56, s49, 256
  buffer_load_dwordx4 v192, s[16:19], s56 offen lds
  s_add_u32 m0, s52, 74752
  s_add_u32 s56, s49, 37120
  buffer_load_dwordx4 v193, s[16:19], s56 offen lds
  s_add_u32 m0, s52, 75776
  s_add_u32 s56, s49, 73984
  buffer_load_dwordx4 v192, s[16:19], s56 offen lds
  s_add_u32 m0, s51, 110592
  s_add_u32 s56, s48, 384
  buffer_load_dwordx4 v190, s[16:19], s56 offen lds
  s_add_u32 m0, s51, 111616
  s_add_u32 s56, s48, 37248
  buffer_load_dwordx4 v191, s[16:19], s56 offen lds
  s_add_u32 m0, s51, 112640
  s_add_u32 s56, s48, 74112
  buffer_load_dwordx4 v190, s[16:19], s56 offen lds
  s_add_u32 m0, s51, 113664
  s_add_u32 s56, s48, 110976
  buffer_load_dwordx4 v191, s[16:19], s56 offen lds
  s_add_u32 m0, s52, 110592
  s_add_u32 s56, s49, 384
  buffer_load_dwordx4 v192, s[16:19], s56 offen lds
  s_add_u32 m0, s52, 111616
  s_add_u32 s56, s49, 37248
  buffer_load_dwordx4 v193, s[16:19], s56 offen lds
  s_add_u32 m0, s52, 112640
  s_add_u32 s56, s49, 74112
  buffer_load_dwordx4 v192, s[16:19], s56 offen lds
  s_waitcnt vmcnt(21)
  s_barrier
  v_add_u32 v138, 0, v130
  v_add_u32 v142, 0, v134
  ds_read_b128 v[80:83], v138
  ds_read_b128 v[84:87], v142 offset:0
  ds_read_b128 v[88:91], v142 offset:4096
  ds_read_b128 v[92:95], v142 offset:8192
  v_add_u32 v138, 0, v131
  v_add_u32 v142, 0, v135
  ds_read_b128 v[104:107], v138
  ds_read_b128 v[108:111], v142 offset:0
  ds_read_b128 v[112:115], v142 offset:4096
  ds_read_b128 v[116:119], v142 offset:8192
  s_waitcnt lgkmcnt(4)
  v_mfma_f32_32x32x16_bf16 v[0:15], v[84:87], v[80:83], 0
  v_mfma_f32_32x32x16_bf16 v[16:31], v[88:91], v[80:83], 0
  v_mfma_f32_32x32x16_bf16 v[32:47], v[92:95], v[80:83], 0
  v_add_u32 v138, 0, v132
  v_add_u32 v142, 0, v136
  ds_read_b128 v[80:83], v138
  ds_read_b128 v[84:87], v142 offset:0
  ds_read_b128 v[88:91], v142 offset:4096
  ds_read_b128 v[92:95], v142 offset:8192
  s_waitcnt lgkmcnt(4)
  v_mfma_f32_32x32x16_bf16 v[0:15], v[108:111], v[104:107], v[0:15]
  s_waitcnt vmcnt(14)
  s_barrier
  v_mfma_f32_32x32x16_bf16 v[16:31], v[112:115], v[104:107], v[16:31]
  v_mfma_f32_32x32x16_bf16 v[32:47], v[116:119], v[104:107], v[32:47]
  v_add_u32 v138, 0, v133
  v_add_u32 v142, 0, v137
  ds_read_b128 v[104:107], v138
  ds_read_b128 v[108:111], v142 offset:0
  ds_read_b128 v[112:115], v142 offset:4096
  ds_read_b128 v[116:119], v142 offset:8192
  s_waitcnt lgkmcnt(4)
  v_mfma_f32_32x32x16_bf16 v[0:15], v[84:87], v[80:83], v[0:15]
  v_mfma_f32_32x32x16_bf16 v[16:31], v[88:91], v[80:83], v[16:31]
  v_mfma_f32_32x32x16_bf16 v[32:47], v[92:95], v[80:83], v[32:47]
  v_add_u32 v138, 36864, v130
  v_add_u32 v142, 36864, v134
  ds_read_b128 v[80:83], v138
  ds_read_b128 v[84:87], v142 offset:0
  ds_read_b128 v[88:91], v142 offset:4096
  ds_read_b128 v[92:95], v142 offset:8192
  s_waitcnt lgkmcnt(4)
  v_mfma_f32_32x32x16_bf16 v[0:15], v[108:111], v[104:107], v[0:15]
  v_mfma_f32_32x32x16_bf16 v[16:31], v[112:115], v[104:107], v[16:31]
  v_mfma_f32_32x32x16_bf16 v[32:47], v[116:119], v[104:107], v[32:47]
  v_add_u32 v138, 36864, v131
  v_add_u32 v142, 36864, v135
  ds_read_b128 v[104:107], v138
  ds_read_b128 v[108:111], v142 offset:0
  ds_read_b128 v[112:115], v142 offset:4096
  ds_read_b128 v[116:119], v142 offset:8192
  s_waitcnt lgkmcnt(4)
  v_mfma_f32_32x32x16_bf16 v[0:15], v[84:87], v[80:83], v[0:15]
  v_mfma_f32_32x32x16_bf16 v[16:31], v[88:91], v[80:83], v[16:31]
  v_mfma_f32_32x32x16_bf16 v[32:47], v[92:95], v[80:83], v[32:47]
  v_add_u32 v138, 36864, v132
  v_add_u32 v142, 36864, v136
  ds_read_b128 v[80:83], v138
  ds_read_b128 v[84:87], v142 offset:0
  ds_read_b128 v[88:91], v142 offset:4096
  ds_read_b128 v[92:95], v142 offset:8192
  s_waitcnt lgkmcnt(4)
  v_mfma_f32_32x32x16_bf16 v[0:15], v[108:111], v[104:107], v[0:15]
  s_waitcnt vmcnt(7)
  s_barrier
  v_mfma_f32_32x32x16_bf16 v[16:31], v[112:115], v[104:107], v[16:31]
  s_add_u32 m0, s51, 0
  s_add_u32 s56, s48, 512
  buffer_load_dwordx4 v190, s[16:19], s56 offen lds
  s_add_u32 m0, s51, 1024
  v_mfma_f32_32x32x16_bf16 v[32:47], v[116:119], v[104:107], v[32:47]
  s_add_u32 s56, s48, 37376
  buffer_load_dwordx4 v191, s[16:19], s56 offen lds
  s_add_u32 m0, s51, 2048
  s_add_u32 s56, s48, 74240
  v_add_u32 v138, 36864, v133
  v_add_u32 v142, 36864, v137
  ds_read_b128 v[104:107], v138
  ds_read_b128 v[108:111], v142 offset:0
  ds_read_b128 v[112:115], v142 offset:4096
  ds_read_b128 v[116:119], v142 offset:8192
  s_waitcnt lgkmcnt(4)
  v_mfma_f32_32x32x16_bf16 v[0:15], v[84:87], v[80:83], v[0:15]
  buffer_load_dwordx4 v190, s[16:19], s56 offen lds
  s_add_u32 m0, s51, 3072
  s_add_u32 s56, s48, 111104
  buffer_load_dwordx4 v191, s[16:19], s56 offen lds
  v_mfma_f32_32x32x16_bf16 v[16:31], v[88:91], v[80:83], v[16:31]
  s_add_u32 m0, s52, 0
  s_add_u32 s56, s49, 512
  buffer_load_dwordx4 v192, s[16:19], s56 offen lds
  s_add_u32 m0, s52, 1024
  v_mfma_f32_32x32x16_bf16 v[32:47], v[92:95], v[80:83], v[32:47]
  s_add_u32 s56, s49, 37376
  buffer_load_dwordx4 v193, s[16:19], s56 offen lds
  s_add_u32 m0, s52, 2048
  s_add_u32 s56, s49, 74240
  v_add_u32 v138, 73728, v130
  v_add_u32 v142, 73728, v134
  ds_read_b128 v[80:83], v138
  ds_read_b128 v[84:87], v142 offset:0
  ds_read_b128 v[88:91], v142 offset:4096
  ds_read_b128 v[92:95], v142 offset:8192
  s_waitcnt lgkmcnt(4)
  v_mfma_f32_32x32x16_bf16 v[0:15], v[108:111], v[104:107], v[0:15]
  buffer_load_dwordx4 v192, s[16:19], s56 offen lds
  v_mfma_f32_32x32x16_bf16 v[16:31], v[112:115], v[104:107], v[16:31]
  v_mfma_f32_32x32x16_bf16 v[32:47], v[116:119], v[104:107], v[32:47]
  v_add_u32 v138, 73728, v131
  v_add_u32 v142, 73728, v135
  ds_read_b128 v[104:107], v138
  ds_read_b128 v[108:111], v142 offset:0
  ds_read_b128 v[112:115], v142 offset:4096
  ds_read_b128 v[116:119], v142 offset:8192
  s_waitcnt lgkmcnt(4)
  v_mfma_f32_32x32x16_bf16 v[0:15], v[84:87], v[80:83], v[0:15]
  v_mfma_f32_32x32x16_bf16 v[16:31], v[88:91], v[80:83], v[16:31]
  v_mfma_f32_32x32x16_bf16 v[32:47], v[92:95], v[80:83], v[32:47]
  v_add_u32 v138, 73728, v132
  v_add_u32 v142, 73728, v136
  ds_read_b128 v[80:83], v138
  ds_read_b128 v[84:87], v142 offset:0
  ds_read_b128 v[88:91], v142 offset:4096
  ds_read_b128 v[92:95], v142 offset:8192
  s_waitcnt lgkmcnt(4)
  v_mfma_f32_32x32x16_bf16 v[0:15], v[108:111], v[104:107], v[0:15]
  s_waitcnt vmcnt(7)
  s_barrier
  v_mfma_f32_32x32x16_bf16 v[16:31], v[112:115], v[104:107], v[16:31]
  s_add_u32 m0, s51, 36864
  s_add_u32 s56, s48, 640
  buffer_load_dwordx4 v190, s[16:19], s56 offen lds
  s_add_u32 m0, s51, 37888
  v_mfma_f32_32x32x16_bf16 v[32:47], v[116:119], v[104:107], v[32:47]
  s_add_u32 s56, s48, 37504
  buffer_load_dwordx4 v191, s[16:19], s56 offen lds
  s_add_u32 m0, s51, 38912
  s_add_u32 s56, s48, 74368
  v_add_u32 v138, 73728, v133
  v_add_u32 v142, 73728, v137
  ds_read_b128 v[104:107], v138
  ds_read_b128 v[108:111], v142 offset:0
  ds_read_b128 v[112:115], v142 offset:4096
  ds_read_b128 v[116:119], v142 offset:8192
  s_waitcnt lgkmcnt(4)
  v_mfma_f32_32x32x16_bf16 v[0:15], v[84:87], v[80:83], v[0:15]
  buffer_load_dwordx4 v190, s[16:19], s56 offen lds
  s_add_u32 m0, s51, 39936
  s_add_u32 s56, s48, 111232
  buffer_load_dwordx4 v191, s[16:19], s56 offen lds
  v_mfma_f32_32x32x16_bf16 v[16:31], v[88:91], v[80:83], v[16:31]
  s_add_u32 m0, s52, 36864
  s_add_u32 s56, s49, 640
  buffer_load_dwordx4 v192, s[16:19], s56 offen lds
  s_add_u32 m0, s52, 37888
  v_mfma_f32_32x32x16_bf16 v[32:47], v[92:95], v[80:83], v[32:47]
  s_add_u32 s56, s49, 37504
  buffer_load_dwordx4 v193, s[16:19], s56 offen lds
  s_add_u32 m0, s52, 38912
  s_add_u32 s56, s49, 74368
  v_add_u32 v138, 110592, v130
  v_add_u32 v142, 110592, v134
  ds_read_b128 v[80:83], v138
  ds_read_b128 v[84:87], v142 offset:0
  ds_read_b128 v[88:91], v142 offset:4096
  ds_read_b128 v[92:95], v142 offset:8192
  s_waitcnt lgkmcnt(4)
  v_mfma_f32_32x32x16_bf16 v[0:15], v[108:111], v[104:107], v[0:15]
  buffer_load_dwordx4 v192, s[16:19], s56 offen lds
  v_mfma_f32_32x32x16_bf16 v[16:31], v[112:115], v[104:107], v[16:31]
  v_mfma_f32_32x32x16_bf16 v[32:47], v[116:119], v[104:107], v[32:47]
  v_add_u32 v138, 110592, v131
  v_add_u32 v142, 110592, v135
  ds_read_b128 v[104:107], v138
  ds_read_b128 v[108:111], v142 offset:0
  ds_read_b128 v[112:115], v142 offset:4096
  ds_read_b128 v[116:119], v142 offset:8192
  s_waitcnt lgkmcnt(4)
  v_mfma_f32_32x32x16_bf16 v[0:15], v[84:87], v[80:83], v[0:15]
  v_mfma_f32_32x32x16_bf16 v[16:31], v[88:91], v[80:83], v[16:31]
  v_mfma_f32_32x32x16_bf16 v[32:47], v[92:95], v[80:83], v[32:47]
  v_add_u32 v138, 110592, v132
  v_add_u32 v142, 110592, v136
  ds_read_b128 v[80:83], v138
  ds_read_b128 v[84:87], v142 offset:0
  ds_read_b128 v[88:91], v142 offset:4096
  ds_read_b128 v[92:95], v142 offset:8192
  s_waitcnt lgkmcnt(4)
  v_mfma_f32_32x32x16_bf16 v[0:15], v[108:111], v[104:107], v[0:15]
  s_waitcnt vmcnt(7)
  s_barrier
  v_mfma_f32_32x32x16_bf16 v[16:31], v[112:115], v[104:107], v[16:31]
  s_add_u32 m0, s51, 73728
  s_add_u32 s56, s48, 768
  buffer_load_dwordx4 v190, s[16:19], s56 offen lds
  s_add_u32 m0, s51, 74752
  v_mfma_f32_32x32x16_bf16 v[32:47], v[116:119], v[104:107], v[32:47]
  s_add_u32 s56, s48, 37632
  buffer_load_dwordx4 v191, s[16:19], s56 offen lds
  s_add_u32 m0, s51, 75776
  s_add_u32 s56, s48, 74496
  v_add_u32 v138, 110592, v133
  v_add_u32 v142, 110592, v137
  ds_read_b128 v[104:107], v138
  ds_read_b128 v[108:111], v142 offset:0
  ds_read_b128 v[112:115], v142 offset:4096
  ds_read_b128 v[116:119], v142 offset:8192
  s_waitcnt lgkmcnt(4)
  v_mfma_f32_32x32x16_bf16 v[0:15], v[84:87], v[80:83], v[0:15]
  buffer_load_dwordx4 v190, s[16:19], s56 offen lds
  s_add_u32 m0, s51, 76800
  s_add_u32 s56, s48, 111360
  buffer_load_dwordx4 v191, s[16:19], s56 offen lds
  v_mfma_f32_32x32x16_bf16 v[16:31], v[88:91], v[80:83], v[16:31]
  s_add_u32 m0, s52, 73728
  s_add_u32 s56, s49, 768
  buffer_load_dwordx4 v192, s[16:19], s56 offen lds
  s_add_u32 m0, s52, 74752
  v_mfma_f32_32x32x16_bf16 v[32:47], v[92:95], v[80:83], v[32:47]
  s_add_u32 s56, s49, 37632
  buffer_load_dwordx4 v193, s[16:19], s56 offen lds
  s_add_u32 m0, s52, 75776
  s_add_u32 s56, s49, 74496
  v_add_u32 v138, 0, v130
  v_add_u32 v142, 0, v134
  ds_read_b128 v[80:83], v138
  ds_read_b128 v[84:87], v142 offset:0
  ds_read_b128 v[88:91], v142 offset:4096
  ds_read_b128 v[92:95], v142 offset:8192
  s_waitcnt lgkmcnt(4)
  v_mfma_f32_32x32x16_bf16 v[0:15], v[108:111], v[104:107], v[0:15]
  buffer_load_dwordx4 v192, s[16:19], s56 offen lds
  v_mfma_f32_32x32x16_bf16 v[16:31], v[112:115], v[104:107], v[16:31]
  v_mfma_f32_32x32x16_bf16 v[32:47], v[116:119], v[104:107], v[32:47]
  v_add_u32 v138, 0, v131
  v_add_u32 v142, 0, v135
  ds_read_b128 v[104:107], v138
  ds_read_b128 v[108:111], v142 offset:0
  ds_read_b128 v[112:115], v142 offset:4096
  ds_read_b128 v[116:119], v142 offset:8192
  s_waitcnt lgkmcnt(4)
  v_mfma_f32_32x32x16_bf16 v[0:15], v[84:87], v[80:83], v[0:15]
  v_mfma_f32_32x32x16_bf16 v[16:31], v[88:91], v[80:83], v[16:31]
  v_mfma_f32_32x32x16_bf16 v[32:47], v[92:95], v[80:83], v[32:47]
  v_add_u32 v138, 0, v132
  v_add_u32 v142, 0, v136
  ds_read_b128 v[80:83], v138
  ds_read_b128 v[84:87], v142 offset:0
  ds_read_b128 v[88:91], v142 offset:4096
  ds_read_b128 v[92:95], v142 offset:8192
  s_waitcnt lgkmcnt(4)
  v_mfma_f32_32x32x16_bf16 v[0:15], v[108:111], v[104:107], v[0:15]
  s_waitcnt vmcnt(7)
  s_barrier
  v_mfma_f32_32x32x16_bf16 v[16:31], v[112:115], v[104:107], v[16:31]
  s_add_u32 m0, s51, 110592
  s_add_u32 s56, s48, 896
  buffer_load_dwordx4 v190, s[16:19], s56 offen lds
  s_add_u32 m0, s51, 111616
  v_mfma_f32_32x32x16_bf16 v[32:47], v[116:119], v[104:107], v[32:47]
  s_add_u32 s56, s48, 37760
  buffer_load_dwordx4 v191, s[16:19], s56 offen lds
  s_add_u32 m0, s51, 112640
  s_add_u32 s56, s48, 74624
  v_add_u32 v138, 0, v133
  v_add_u32 v142, 0, v137
  ds_read_b128 v[104:107], v138
  ds_read_b128 v[108:111], v142 offset:0
  ds_read_b128 v[112:115], v142 offset:4096
  ds_read_b128 v[116:119], v142 offset:8192
  s_waitcnt lgkmcnt(4)
  v_mfma_f32_32x32x16_bf16 v[0:15], v[84:87], v[80:83], v[0:15]
  buffer_load_dwordx4 v190, s[16:19], s56 offen lds
  s_add_u32 m0, s51, 113664
  s_add_u32 s56, s48, 111488
  buffer_load_dwordx4 v191, s[16:19], s56 offen lds
  v_mfma_f32_32x32x16_bf16 v[16:31], v[88:91], v[80:83], v[16:31]
  s_add_u32 m0, s52, 110592
  s_add_u32 s56, s49, 896
  buffer_load_dwordx4 v192, s[16:19], s56 offen lds
  s_add_u32 m0, s52, 111616
  v_mfma_f32_32x32x16_bf16 v[32:47], v[92:95], v[80:83], v[32:47]
  s_add_u32 s56, s49, 37760
  buffer_load_dwordx4 v193, s[16:19], s56 offen lds
  s_add_u32 m0, s52, 112640
  s_add_u32 s56, s49, 74624
  v_add_u32 v138, 36864, v130
  v_add_u32 v142, 36864, v134
  ds_read_b128 v[80:83], v138
  ds_read_b128 v[84:87], v142 offset:0
  ds_read_b128 v[88:91], v142 offset:4096
  ds_read_b128 v[92:95], v142 offset:8192
  s_waitcnt lgkmcnt(4)
  v_mfma_f32_32x32x16_bf16 v[0:15], v[108:111], v[104:107], v[0:15]
  buffer_load_dwordx4 v192, s[16:19], s56 offen lds
  v_mfma_f32_32x32x16_bf16 v[16:31], v[112:115], v[104:107], v[16:31]
  v_mfma_f32_32x32x16_bf16 v[32:47], v[116:119], v[104:107], v[32:47]
  v_add_u32 v138, 36864, v131
  v_add_u32 v142, 36864, v135
  ds_read_b128 v[104:107], v138
  ds_read_b128 v[108:111], v142 offset:0
  ds_read_b128 v[112:115], v142 offset:4096
  ds_read_b128 v[116:119], v142 offset:8192
  s_waitcnt lgkmcnt(4)
  v_mfma_f32_32x32x16_bf16 v[0:15], v[84:87], v[80:83], v[0:15]
  v_mfma_f32_32x32x16_bf16 v[16:31], v[88:91], v[80:83], v[16:31]
  v_mfma_f32_32x32x16_bf16 v[32:47], v[92:95], v[80:83], v[32:47]
  v_add_u32 v138, 36864, v132
  v_add_u32 v142, 36864, v136
  ds_read_b128 v[80:83], v138
  ds_read_b128 v[84:87], v142 offset:0
  ds_read_b128 v[88:91], v142 offset:4096
  ds_read_b128 v[92:95], v142 offset:8192
  s_waitcnt lgkmcnt(4)
  v_mfma_f32_32x32x16_bf16 v[0:15], v[108:111], v[104:107], v[0:15]
  s_waitcnt vmcnt(7)
  s_barrier
  v_mfma_f32_32x32x16_bf16 v[16:31], v[112:115], v[104:107], v[16:31]
  s_add_u32 m0, s51, 0
  s_add_u32 s56, s48, 1024
  buffer_load_dwordx4 v190, s[16:19], s56 offen lds
  s_add_u32 m0, s51, 1024
  v_mfma_f32_32x32x16_bf16 v[32:47], v[116:119], v[104:107], v[32:47]
  s_add_u32 s56, s48, 37888
  buffer_load_dwordx4 v191, s[16:19], s56 offen lds
  s_add_u32 m0, s51, 2048
  s_add_u32 s56, s48, 74752
  v_add_u32 v138, 36864, v133
  v_add_u32 v142, 36864, v137
  ds_read_b128 v[104:107], v138
  ds_read_b128 v[108:111], v142 offset:0
  ds_read_b128 v[112:115], v142 offset:4096
  ds_read_b128 v[116:119], v142 offset:8192
  s_waitcnt lgkmcnt(4)
  v_mfma_f32_32x32x16_bf16 v[0:15], v[84:87], v[80:83], v[0:15]
  buffer_load_dwordx4 v190, s[16:19], s56 offen lds
  s_add_u32 m0, s51, 3072
  s_add_u32 s56, s48, 111616
  buffer_load_dwordx4 v191, s[16:19], s56 offen lds
  v_mfma_f32_32x32x16_bf16 v[16:31], v[88:91], v[80:83], v[16:31]
  s_add_u32 m0, s52, 0
  s_add_u32 s56, s49, 1024
  buffer_load_dwordx4 v192, s[16:19], s56 offen lds
  s_add_u32 m0, s52, 1024
  v_mfma_f32_32x32x16_bf16 v[32:47], v[92:95], v[80:83], v[32:47]
  s_add_u32 s56, s49, 37888
  buffer_load_dwordx4 v193, s[16:19], s56 offen lds
  s_add_u32 m0, s52, 2048
  s_add_u32 s56, s49, 74752
  v_add_u32 v138, 73728, v130
  v_add_u32 v142, 73728, v134
  ds_read_b128 v[80:83], v138
  ds_read_b128 v[84:87], v142 offset:0
  ds_read_b128 v[88:91], v142 offset:4096
  ds_read_b128 v[92:95], v142 offset:8192
  s_waitcnt lgkmcnt(4)
  v_mfma_f32_32x32x16_bf16 v[0:15], v[108:111], v[104:107], v[0:15]
  buffer_load_dwordx4 v192, s[16:19], s56 offen lds
  v_mfma_f32_32x32x16_bf16 v[16:31], v[112:115], v[104:107], v[16:31]
  v_mfma_f32_32x32x16_bf16 v[32:47], v[116:119], v[104:107], v[32:47]
  v_add_u32 v138, 73728, v131
  v_add_u32 v142, 73728, v135
  ds_read_b128 v[104:107], v138
  ds_read_b128 v[108:111], v142 offset:0
  ds_read_b128 v[112:115], v142 offset:4096
  ds_read_b128 v[116:119], v142 offset:8192
  s_waitcnt lgkmcnt(4)
  v_mfma_f32_32x32x16_bf16 v[0:15], v[84:87], v[80:83], v[0:15]
  v_mfma_f32_32x32x16_bf16 v[16:31], v[88:91], v[80:83], v[16:31]
  v_mfma_f32_32x32x16_bf16 v[32:47], v[92:95], v[80:83], v[32:47]
  v_add_u32 v138, 73728, v132
  v_add_u32 v142, 73728, v136
  ds_read_b128 v[80:83], v138
  ds_read_b128 v[84:87], v142 offset:0
  ds_read_b128 v[88:91], v142 offset:4096
  ds_read_b128 v[92:95], v142 offset:8192
  s_waitcnt lgkmcnt(4)
  v_mfma_f32_32x32x16_bf16 v[0:15], v[108:111], v[104:107], v[0:15]
  s_waitcnt vmcnt(7)
  s_barrier
  v_mfma_f32_32x32x16_bf16 v[16:31], v[112:115], v[104:107], v[16:31]
  s_add_u32 m0, s51, 36864
  s_add_u32 s56, s48, 1152
  buffer_load_dwordx4 v190, s[16:19], s56 offen lds
  s_add_u32 m0, s51, 37888
  v_mfma_f32_32x32x16_bf16 v[32:47], v[116:119], v[104:107], v[32:47]
  s_add_u32 s56, s48, 38016
  buffer_load_dwordx4 v191, s[16:19], s56 offen lds
  s_add_u32 m0, s51, 38912
  s_add_u32 s56, s48, 74880
  v_add_u32 v138, 73728, v133
  v_add_u32 v142, 73728, v137
  ds_read_b128 v[104:107], v138
  ds_read_b128 v[108:111], v142 offset:0
  ds_read_b128 v[112:115], v142 offset:4096
  ds_read_b128 v[116:119], v142 offset:8192
  s_waitcnt lgkmcnt(4)
  v_mfma_f32_32x32x16_bf16 v[0:15], v[84:87], v[80:83], v[0:15]
  buffer_load_dwordx4 v190, s[16:19], s56 offen lds
  s_add_u32 m0, s51, 39936
  s_add_u32 s56, s48, 111744
  buffer_load_dwordx4 v191, s[16:19], s56 offen lds
  v_mfma_f32_32x32x16_bf16 v[16:31], v[88:91], v[80:83], v[16:31]
  s_add_u32 m0, s52, 36864
  s_add_u32 s56, s49, 1152
  buffer_load_dwordx4 v192, s[16:19], s56 offen lds
  s_add_u32 m0, s52, 37888
  v_mfma_f32_32x32x16_bf16 v[32:47], v[92:95], v[80:83], v[32:47]
  s_add_u32 s56, s49, 38016
  buffer_load_dwordx4 v193, s[16:19], s56 offen lds
  s_add_u32 m0, s52, 38912
  s_add_u32 s56, s49, 74880
  v_add_u32 v138, 110592, v130
  v_add_u32 v142, 110592, v134
  ds_read_b128 v[80:83], v138
  ds_read_b128 v[84:87], v142 offset:0
  ds_read_b128 v[88:91], v142 offset:4096
  ds_read_b128 v[92:95], v142 offset:8192
  s_waitcnt lgkmcnt(4)
  v_mfma_f32_32x32x16_bf16 v[0:15], v[108:111], v[104:107], v[0:15]
  buffer_load_dwordx4 v192, s[16:19], s56 offen lds
  v_mfma_f32_32x32x16_bf16 v[16:31], v[112:115], v[104:107], v[16:31]
  v_mfma_f32_32x32x16_bf16 v[32:47], v[116:119], v[104:107], v[32:47]
  v_add_u32 v138, 110592, v131
  v_add_u32 v142, 110592, v135
  ds_read_b128 v[104:107], v138
  ds_read_b128 v[108:111], v142 offset:0
  ds_read_b128 v[112:115], v142 offset:4096
  ds_read_b128 v[116:119], v142 offset:8192
  s_waitcnt lgkmcnt(4)
  v_mfma_f32_32x32x16_bf16 v[0:15], v[84:87], v[80:83], v[0:15]
  v_mfma_f32_32x32x16_bf16 v[16:31], v[88:91], v[80:83], v[16:31]
  v_mfma_f32_32x32x16_bf16 v[32:47], v[92:95], v[80:83], v[32:47]
  v_add_u32 v138, 110592, v132
  v_add_u32 v142, 110592, v136
  ds_read_b128 v[80:83], v138
  ds_read_b128 v[84:87], v142 offset:0
  ds_read_b128 v[88:91], v142 offset:4096
  ds_read_b128 v[92:95], v142 offset:8192
  s_waitcnt lgkmcnt(4)
  v_mfma_f32_32x32x16_bf16 v[0:15], v[108:111], v[104:107], v[0:15]
  s_waitcnt vmcnt(7)
  s_barrier
  v_mfma_f32_32x32x16_bf16 v[16:31], v[112:115], v[104:107], v[16:31]
  s_add_u32 m0, s51, 73728
  s_add_u32 s56, s48, 1280
  buffer_load_dwordx4 v190, s[16:19], s56 offen lds
  s_add_u32 m0, s51, 74752
  v_mfma_f32_32x32x16_bf16 v[32:47], v[116:119], v[104:107], v[32:47]
  s_add_u32 s56, s48, 38144
  buffer_load_dwordx4 v191, s[16:19], s56 offen lds
  s_add_u32 m0, s51, 75776
  s_add_u32 s56, s48, 75008
  v_add_u32 v138, 110592, v133
  v_add_u32 v142, 110592, v137
  ds_read_b128 v[104:107], v138
  ds_read_b128 v[108:111], v142 offset:0
  ds_read_b128 v[112:115], v142 offset:4096
  ds_read_b128 v[116:119], v142 offset:8192
  s_waitcnt lgkmcnt(4)
  v_mfma_f32_32x32x16_bf16 v[0:15], v[84:87], v[80:83], v[0:15]
  buffer_load_dwordx4 v190, s[16:19], s56 offen lds
  s_add_u32 m0, s51, 76800
  s_add_u32 s56, s48, 111872
  buffer_load_dwordx4 v191, s[16:19], s56 offen lds
  v_mfma_f32_32x32x16_bf16 v[16:31], v[88:91], v[80:83], v[16:31]
  s_add_u32 m0, s52, 73728
  s_add_u32 s56, s49, 1280
  buffer_load_dwordx4 v192, s[16:19], s56 offen lds
  s_add_u32 m0, s52, 74752
  v_mfma_f32_32x32x16_bf16 v[32:47], v[92:95], v[80:83], v[32:47]
  s_add_u32 s56, s49, 38144
  buffer_load_dwordx4 v193, s[16:19], s56 offen lds
  s_add_u32 m0, s52, 75776
  s_add_u32 s56, s49, 75008
  v_add_u32 v138, 0, v130
  v_add_u32 v142, 0, v134
  ds_read_b128 v[80:83], v138
  ds_read_b128 v[84:87], v142 offset:0
  ds_read_b128 v[88:91], v142 offset:4096
  ds_read_b128 v[92:95], v142 offset:8192
  s_waitcnt lgkmcnt(4)
  v_mfma_f32_32x32x16_bf16 v[0:15], v[108:111], v[104:107], v[0:15]
  buffer_load_dwordx4 v192, s[16:19], s56 offen lds
  v_mfma_f32_32x32x16_bf16 v[16:31], v[112:115], v[104:107], v[16:31]
  v_mfma_f32_32x32x16_bf16 v[32:47], v[116:119], v[104:107], v[32:47]
  v_add_u32 v138, 0, v131
  v_add_u32 v142, 0, v135
  ds_read_b128 v[104:107], v138
  ds_read_b128 v[108:111], v142 offset:0
  ds_read_b128 v[112:115], v142 offset:4096
  ds_read_b128 v[116:119], v142 offset:8192
  s_waitcnt lgkmcnt(4)
  v_mfma_f32_32x32x16_bf16 v[0:15], v[84:87], v[80:83], v[0:15]
  v_mfma_f32_32x32x16_bf16 v[16:31], v[88:91], v[80:83], v[16:31]
  v_mfma_f32_32x32x16_bf16 v[32:47], v[92:95], v[80:83], v[32:47]
  v_add_u32 v138, 0, v132
  v_add_u32 v142, 0, v136
  ds_read_b128 v[80:83], v138
  ds_read_b128 v[84:87], v142 offset:0
  ds_read_b128 v[88:91], v142 offset:4096
  ds_read_b128 v[92:95], v142 offset:8192
  s_waitcnt lgkmcnt(4)
  v_mfma_f32_32x32x16_bf16 v[0:15], v[108:111], v[104:107], v[0:15]
  s_waitcnt vmcnt(7)
  s_barrier
  v_mfma_f32_32x32x16_bf16 v[16:31], v[112:115], v[104:107], v[16:31]
  s_add_u32 m0, s51, 110592
  s_add_u32 s56, s48, 1408
  buffer_load_dwordx4 v190, s[16:19], s56 offen lds
  s_add_u32 m0, s51, 111616
  v_mfma_f32_32x32x16_bf16 v[32:47], v[116:119], v[104:107], v[32:47]
  s_add_u32 s56, s48, 38272
  buffer_load_dwordx4 v191, s[16:19], s56 offen lds
  s_add_u32 m0, s51, 112640
  s_add_u32 s56, s48, 75136
  v_add_u32 v138, 0, v133
  v_add_u32 v142, 0, v137
  ds_read_b128 v[104:107], v138
  ds_read_b128 v[108:111], v142 offset:0
  ds_read_b128 v[112:115], v142 offset:4096
  ds_read_b128 v[116:119], v142 offset:8192
  s_waitcnt lgkmcnt(4)
  v_mfma_f32_32x32x16_bf16 v[0:15], v[84:87], v[80:83], v[0:15]
  buffer_load_dwordx4 v190, s[16:19], s56 offen lds
  s_add_u32 m0, s51, 113664
  s_add_u32 s56, s48, 112000
  buffer_load_dwordx4 v191, s[16:19], s56 offen lds
  v_mfma_f32_32x32x16_bf16 v[16:31], v[88:91], v[80:83], v[16:31]
  s_add_u32 m0, s52, 110592
  s_add_u32 s56, s49, 1408
  buffer_load_dwordx4 v192, s[16:19], s56 offen lds
  s_add_u32 m0, s52, 111616
  v_mfma_f32_32x32x16_bf16 v[32:47], v[92:95], v[80:83], v[32:47]
  s_add_u32 s56, s49, 38272
  buffer_load_dwordx4 v193, s[16:19], s56 offen lds
  s_add_u32 m0, s52, 112640
  s_add_u32 s56, s49, 75136
  v_add_u32 v138, 36864, v130
  v_add_u32 v142, 36864, v134
  ds_read_b128 v[80:83], v138
  ds_read_b128 v[84:87], v142 offset:0
  ds_read_b128 v[88:91], v142 offset:4096
  ds_read_b128 v[92:95], v142 offset:8192
  s_waitcnt lgkmcnt(4)
  v_mfma_f32_32x32x16_bf16 v[0:15], v[108:111], v[104:107], v[0:15]
  buffer_load_dwordx4 v192, s[16:19], s56 offen lds
  v_mfma_f32_32x32x16_bf16 v[16:31], v[112:115], v[104:107], v[16:31]
  v_mfma_f32_32x32x16_bf16 v[32:47], v[116:119], v[104:107], v[32:47]
  v_add_u32 v138, 36864, v131
  v_add_u32 v142, 36864, v135
  ds_read_b128 v[104:107], v138
  ds_read_b128 v[108:111], v142 offset:0
  ds_read_b128 v[112:115], v142 offset:4096
  ds_read_b128 v[116:119], v142 offset:8192
  s_waitcnt lgkmcnt(4)
  v_mfma_f32_32x32x16_bf16 v[0:15], v[84:87], v[80:83], v[0:15]
  v_mfma_f32_32x32x16_bf16 v[16:31], v[88:91], v[80:83], v[16:31]
  v_mfma_f32_32x32x16_bf16 v[32:47], v[92:95], v[80:83], v[32:47]
  v_add_u32 v138, 36864, v132
  v_add_u32 v142, 36864, v136
  ds_read_b128 v[80:83], v138
  ds_read_b128 v[84:87], v142 offset:0
  ds_read_b128 v[88:91], v142 offset:4096
  ds_read_b128 v[92:95], v142 offset:8192
  s_waitcnt lgkmcnt(4)
  v_mfma_f32_32x32x16_bf16 v[0:15], v[108:111], v[104:107], v[0:15]
  s_waitcnt vmcnt(7)
  s_barrier
  v_mfma_f32_32x32x16_bf16 v[16:31], v[112:115], v[104:107], v[16:31]
  v_mfma_f32_32x32x16_bf16 v[32:47], v[116:119], v[104:107], v[32:47]
  v_add_u32 v138, 36864, v133
  v_add_u32 v142, 36864, v137
  ds_read_b128 v[104:107], v138
  ds_read_b128 v[108:111], v142 offset:0
  ds_read_b128 v[112:115], v142 offset:4096
  ds_read_b128 v[116:119], v142 offset:8192
  s_waitcnt lgkmcnt(4)
  v_mfma_f32_32x32x16_bf16 v[0:15], v[84:87], v[80:83], v[0:15]
  v_mfma_f32_32x32x16_bf16 v[16:31], v[88:91], v[80:83], v[16:31]
  v_mfma_f32_32x32x16_bf16 v[32:47], v[92:95], v[80:83], v[32:47]
  v_add_u32 v138, 73728, v130
  v_add_u32 v142, 73728, v134
  ds_read_b128 v[80:83], v138
  ds_read_b128 v[84:87], v142 offset:0
  ds_read_b128 v[88:91], v142 offset:4096
  ds_read_b128 v[92:95], v142 offset:8192
  s_waitcnt lgkmcnt(4)
  v_mfma_f32_32x32x16_bf16 v[0:15], v[108:111], v[104:107], v[0:15]
  v_mfma_f32_32x32x16_bf16 v[16:31], v[112:115], v[104:107], v[16:31]
  v_mfma_f32_32x32x16_bf16 v[32:47], v[116:119], v[104:107], v[32:47]
  v_add_u32 v138, 73728, v131
  v_add_u32 v142, 73728, v135
  ds_read_b128 v[104:107], v138
  ds_read_b128 v[108:111], v142 offset:0
  ds_read_b128 v[112:115], v142 offset:4096
  ds_read_b128 v[116:119], v142 offset:8192
  s_waitcnt lgkmcnt(4)
  v_mfma_f32_32x32x16_bf16 v[0:15], v[84:87], v[80:83], v[0:15]
  v_mfma_f32_32x32x16_bf16 v[16:31], v[88:91], v[80:83], v[16:31]
  v_mfma_f32_32x32x16_bf16 v[32:47], v[92:95], v[80:83], v[32:47]
  v_add_u32 v138, 73728, v132
  v_add_u32 v142, 73728, v136
  ds_read_b128 v[80:83], v138
  ds_read_b128 v[84:87], v142 offset:0
  ds_read_b128 v[88:91], v142 offset:4096
  ds_read_b128 v[92:95], v142 offset:8192
  s_waitcnt lgkmcnt(4)
  v_mfma_f32_32x32x16_bf16 v[0:15], v[108:111], v[104:107], v[0:15]
  s_waitcnt vmcnt(0)
  s_barrier
  v_mfma_f32_32x32x16_bf16 v[16:31], v[112:115], v[104:107], v[16:31]
  v_mfma_f32_32x32x16_bf16 v[32:47], v[116:119], v[104:107], v[32:47]
  v_add_u32 v138, 73728, v133
  v_add_u32 v142, 73728, v137
  ds_read_b128 v[104:107], v138
  ds_read_b128 v[108:111], v142 offset:0
  ds_read_b128 v[112:115], v142 offset:4096
  ds_read_b128 v[116:119], v142 offset:8192
  s_waitcnt lgkmcnt(4)
  v_mfma_f32_32x32x16_bf16 v[0:15], v[84:87], v[80:83], v[0:15]
  v_mfma_f32_32x32x16_bf16 v[16:31], v[88:91], v[80:83], v[16:31]
  v_mfma_f32_32x32x16_bf16 v[32:47], v[92:95], v[80:83], v[32:47]
  v_add_u32 v138, 110592, v130
  v_add_u32 v142, 110592, v134
  ds_read_b128 v[80:83], v138
  ds_read_b128 v[84:87], v142 offset:0
  ds_read_b128 v[88:91], v142 offset:4096
  ds_read_b128 v[92:95], v142 offset:8192
  s_waitcnt lgkmcnt(4)
  v_mfma_f32_32x32x16_bf16 v[0:15], v[108:111], v[104:107], v[0:15]
  v_mfma_f32_32x32x16_bf16 v[16:31], v[112:115], v[104:107], v[16:31]
  v_mfma_f32_32x32x16_bf16 v[32:47], v[116:119], v[104:107], v[32:47]
  v_add_u32 v138, 110592, v131
  v_add_u32 v142, 110592, v135
  ds_read_b128 v[104:107], v138
  ds_read_b128 v[108:111], v142 offset:0
  ds_read_b128 v[112:115], v142 offset:4096
  ds_read_b128 v[116:119], v142 offset:8192
  s_waitcnt lgkmcnt(4)
  v_mfma_f32_32x32x16_bf16 v[0:15], v[84:87], v[80:83], v[0:15]
  v_mfma_f32_32x32x16_bf16 v[16:31], v[88:91], v[80:83], v[16:31]
  v_mfma_f32_32x32x16_bf16 v[32:47], v[92:95], v[80:83], v[32:47]
  v_add_u32 v138, 110592, v132
  v_add_u32 v142, 110592, v136
  ds_read_b128 v[80:83], v138
  ds_read_b128 v[84:87], v142 offset:0
  ds_read_b128 v[88:91], v142 offset:4096
  ds_read_b128 v[92:95], v142 offset:8192
  s_waitcnt lgkmcnt(4)
  v_mfma_f32_32x32x16_bf16 v[0:15], v[108:111], v[104:107], v[0:15]
  v_mfma_f32_32x32x16_bf16 v[16:31], v[112:115], v[104:107], v[16:31]
  v_mfma_f32_32x32x16_bf16 v[32:47], v[116:119], v[104:107], v[32:47]
  v_add_u32 v138, 110592, v133
  v_add_u32 v142, 110592, v137
  ds_read_b128 v[104:107], v138
  ds_read_b128 v[108:111], v142 offset:0
  ds_read_b128 v[112:115], v142 offset:4096
  ds_read_b128 v[116:119], v142 offset:8192
  s_waitcnt lgkmcnt(4)
  v_mfma_f32_32x32x16_bf16 v[0:15], v[84:87], v[80:83], v[0:15]
  v_mfma_f32_32x32x16_bf16 v[16:31], v[88:91], v[80:83], v[16:31]
  v_mfma_f32_32x32x16_bf16 v[32:47], v[92:95], v[80:83], v[32:47]
  s_waitcnt lgkmcnt(0)
  v_mfma_f32_32x32x16_bf16 v[0:15], v[108:111], v[104:107], v[0:15]
  v_mfma_f32_32x32x16_bf16 v[16:31], v[112:115], v[104:107], v[16:31]
  v_mfma_f32_32x32x16_bf16 v[32:47], v[116:119], v[104:107], v[32:47]
  s_barrier
  v_lshrrev_b32 v204, 4, v200
  v_and_b32 v205, 15, v200
  v_lshlrev_b32 v206, 2, v204
  v_xor_b32 v205, v205, v206
  v_mul_u32_u24 v204, 4608, v204
  v_lshl_add_u32 v190, v205, 4, v204
  s_mul_i32 s48, s47, 4608
  s_add_u32 s48, s48, 3072
  s_mul_i32 s50, s40, 110592
  s_add_u32 s48, s48, s50
  s_mul_i32 s51, s40, 6144

  s_add_u32 m0, s51, 0
  s_add_u32 s56, s48, 0
  buffer_load_dwordx4 v190, s[16:19], s56 offen lds
  s_add_u32 m0, s51, 1024
  s_add_u32 s56, s48, 18432
  buffer_load_dwordx4 v190, s[16:19], s56 offen lds
  s_add_u32 m0, s51, 2048
  s_add_u32 s56, s48, 36864
  buffer_load_dwordx4 v190, s[16:19], s56 offen lds
  s_add_u32 m0, s51, 3072
  s_add_u32 s56, s48, 55296
  buffer_load_dwordx4 v190, s[16:19], s56 offen lds
  s_add_u32 m0, s51, 4096
  s_add_u32 s56, s48, 73728
  buffer_load_dwordx4 v190, s[16:19], s56 offen lds
  s_add_u32 m0, s51, 5120
  s_add_u32 s56, s48, 92160
  buffer_load_dwordx4 v190, s[16:19], s56 offen lds
  s_add_u32 m0, s51, 24576
  s_add_u32 s56, s48, 256
  buffer_load_dwordx4 v190, s[16:19], s56 offen lds
  s_add_u32 m0, s51, 25600
  s_add_u32 s56, s48, 18688
  buffer_load_dwordx4 v190, s[16:19], s56 offen lds
  s_add_u32 m0, s51, 26624
  s_add_u32 s56, s48, 37120
  buffer_load_dwordx4 v190, s[16:19], s56 offen lds
  s_add_u32 m0, s51, 27648
  s_add_u32 s56, s48, 55552
  buffer_load_dwordx4 v190, s[16:19], s56 offen lds
  s_add_u32 m0, s51, 28672
  s_add_u32 s56, s48, 73984
  buffer_load_dwordx4 v190, s[16:19], s56 offen lds
  s_add_u32 m0, s51, 29696
  s_add_u32 s56, s48, 92416
  buffer_load_dwordx4 v190, s[16:19], s56 offen lds
  s_add_u32 m0, s51, 49152
  s_add_u32 s56, s48, 512
  buffer_load_dwordx4 v190, s[16:19], s56 offen lds
  s_add_u32 m0, s51, 50176
  s_add_u32 s56, s48, 18944
  buffer_load_dwordx4 v190, s[16:19], s56 offen lds
  s_add_u32 m0, s51, 51200
  s_add_u32 s56, s48, 37376
  buffer_load_dwordx4 v190, s[16:19], s56 offen lds
  s_add_u32 m0, s51, 52224
  s_add_u32 s56, s48, 55808
  buffer_load_dwordx4 v190, s[16:19], s56 offen lds
  s_add_u32 m0, s51, 53248
  s_add_u32 s56, s48, 74240
  buffer_load_dwordx4 v190, s[16:19], s56 offen lds
  s_add_u32 m0, s51, 54272
  s_add_u32 s56, s48, 92672
  buffer_load_dwordx4 v190, s[16:19], s56 offen lds
K3_UsmS3:
  s_nop 15
  s_nop 7
  v_max3_f32 v150, v0, v1, v2
  v_max3_f32 v151, v3, v4, v5
  v_max3_f32 v150, v150, v6, v7
  v_max3_f32 v151, v151, v8, v9
  v_max3_f32 v150, v150, v10, v11
  v_max3_f32 v151, v151, v12, v13
  v_max3_f32 v150, v150, v14, v15
  v_max3_f32 v151, v151, v16, v17
  v_max3_f32 v150, v150, v18, v19
  v_max3_f32 v151, v151, v20, v21
  v_max3_f32 v150, v150, v22, v23
  v_max3_f32 v151, v151, v24, v25
  v_max3_f32 v150, v150, v26, v27
  v_max3_f32 v151, v151, v28, v29
  v_max3_f32 v150, v150, v30, v31
  v_max3_f32 v151, v151, v32, v33
  v_max3_f32 v150, v150, v34, v35
  v_max3_f32 v151, v151, v36, v37
  v_max3_f32 v150, v150, v38, v39
  v_max3_f32 v151, v151, v40, v41
  v_max3_f32 v150, v150, v42, v43
  v_max3_f32 v151, v151, v44, v45
  v_max3_f32 v150, v150, v46, v47
  v_max_f32 v150, v150, v151
  v_mov_b32 v151, v150
  s_nop 1
  v_permlane32_swap_b32 v150, v151
  s_nop 1
  v_max_f32 v150, v150, v151
  s_mov_b32 s53, 0x3d553b95
  v_mul_f32 v150, s53, v150
  v_sub_f32 v152, 0, v150
  v_mov_b32 v153, s53
  v_lshlrev_b32 v204, 4, v200
  v_add_u32 v204, 98304, v204
  v_mov_b32 v154, 0

  s_cmp_eq_u32 s40, 0
  s_cbranch_scc0 K3_Uw1S3
  v_fma_f32 v0, v0, v153, v152
  v_fma_f32 v1, v1, v153, v152
  v_fma_f32 v2, v2, v153, v152
  v_fma_f32 v3, v3, v153, v152
  v_fma_f32 v4, v4, v153, v152
  v_fma_f32 v5, v5, v153, v152
  v_fma_f32 v6, v6, v153, v152
  v_fma_f32 v7, v7, v153, v152
  v_fma_f32 v8, v8, v153, v152
  v_fma_f32 v9, v9, v153, v152
  v_fma_f32 v10, v10, v153, v152
  v_fma_f32 v11, v11, v153, v152
  v_fma_f32 v12, v12, v153, v152
  v_fma_f32 v13, v13, v153, v152
  v_fma_f32 v14, v14, v153, v152
  v_fma_f32 v15, v15, v153, v152
  v_exp_f32 v0, v0
  v_exp_f32 v1, v1
  v_exp_f32 v2, v2
  v_exp_f32 v3, v3
  v_exp_f32 v4, v4
  v_exp_f32 v5, v5
  v_exp_f32 v6, v6
  v_exp_f32 v7, v7
  v_exp_f32 v8, v8
  v_exp_f32 v9, v9
  v_exp_f32 v10, v10
  v_exp_f32 v11, v11
  v_exp_f32 v12, v12
  v_exp_f32 v13, v13
  v_exp_f32 v14, v14
  v_exp_f32 v15, v15
  s_nop 0
  v_add_f32 v154, v154, v0
  v_add_f32 v154, v154, v1
  v_add_f32 v154, v154, v2
  v_add_f32 v154, v154, v3
  v_add_f32 v154, v154, v4
  v_add_f32 v154, v154, v5
  v_add_f32 v154, v154, v6
  v_add_f32 v154, v154, v7
  v_add_f32 v154, v154, v8
  v_add_f32 v154, v154, v9
  v_add_f32 v154, v154, v10
  v_add_f32 v154, v154, v11
  v_add_f32 v154, v154, v12
  v_add_f32 v154, v154, v13
  v_add_f32 v154, v154, v14
  v_add_f32 v154, v154, v15
  v_cvt_pk_bf16_f32 v84, v0, v1
  v_cvt_pk_bf16_f32 v85, v2, v3
  v_cvt_pk_bf16_f32 v86, v4, v5
  v_cvt_pk_bf16_f32 v87, v6, v7
  ds_write_b128 v204, v[84:87] offset:0
  s_nop 1
  v_cvt_pk_bf16_f32 v84, v8, v9
  v_cvt_pk_bf16_f32 v85, v10, v11
  v_cvt_pk_bf16_f32 v86, v12, v13
  v_cvt_pk_bf16_f32 v87, v14, v15
  ds_write_b128 v204, v[84:87] offset:1024
  s_nop 1
  s_branch K3_UlS3
K3_Uw1S3:
  s_cmp_eq_u32 s40, 1
  s_cbranch_scc0 K3_Uw2S3
  v_fma_f32 v16, v16, v153, v152
  v_fma_f32 v17, v17, v153, v152
  v_fma_f32 v18, v18, v153, v152
  v_fma_f32 v19, v19, v153, v152
  v_fma_f32 v20, v20, v153, v152
  v_fma_f32 v21, v21, v153, v152
  v_fma_f32 v22, v22, v153, v152
  v_fma_f32 v23, v23, v153, v152
  v_fma_f32 v24, v24, v153, v152
  v_fma_f32 v25, v25, v153, v152
  v_fma_f32 v26, v26, v153, v152
  v_fma_f32 v27, v27, v153, v152
  v_fma_f32 v28, v28, v153, v152
  v_fma_f32 v29, v29, v153, v152
  v_fma_f32 v30, v30, v153, v152
  v_fma_f32 v31, v31, v153, v152
  v_exp_f32 v16, v16
  v_exp_f32 v17, v17
  v_exp_f32 v18, v18
  v_exp_f32 v19, v19
  v_exp_f32 v20, v20
  v_exp_f32 v21, v21
  v_exp_f32 v22, v22
  v_exp_f32 v23, v23
  v_exp_f32 v24, v24
  v_exp_f32 v25, v25
  v_exp_f32 v26, v26
  v_exp_f32 v27, v27
  v_exp_f32 v28, v28
  v_exp_f32 v29, v29
  v_exp_f32 v30, v30
  v_exp_f32 v31, v31
  s_nop 0
  v_add_f32 v154, v154, v16
  v_add_f32 v154, v154, v17
  v_add_f32 v154, v154, v18
  v_add_f32 v154, v154, v19
  v_add_f32 v154, v154, v20
  v_add_f32 v154, v154, v21
  v_add_f32 v154, v154, v22
  v_add_f32 v154, v154, v23
  v_add_f32 v154, v154, v24
  v_add_f32 v154, v154, v25
  v_add_f32 v154, v154, v26
  v_add_f32 v154, v154, v27
  v_add_f32 v154, v154, v28
  v_add_f32 v154, v154, v29
  v_add_f32 v154, v154, v30
  v_add_f32 v154, v154, v31
  v_cvt_pk_bf16_f32 v84, v16, v17
  v_cvt_pk_bf16_f32 v85, v18, v19
  v_cvt_pk_bf16_f32 v86, v20, v21
  v_cvt_pk_bf16_f32 v87, v22, v23
  ds_write_b128 v204, v[84:87] offset:2048
  s_nop 1
  v_cvt_pk_bf16_f32 v84, v24, v25
  v_cvt_pk_bf16_f32 v85, v26, v27
  v_cvt_pk_bf16_f32 v86, v28, v29
  v_cvt_pk_bf16_f32 v87, v30, v31
  ds_write_b128 v204, v[84:87] offset:3072
  s_nop 1
  s_branch K3_UlS3
K3_Uw2S3:
  s_cmp_eq_u32 s40, 2
  s_cbranch_scc0 K3_Uw3S3
  v_fma_f32 v32, v32, v153, v152
  v_fma_f32 v33, v33, v153, v152
  v_fma_f32 v34, v34, v153, v152
  v_fma_f32 v35, v35, v153, v152
  v_fma_f32 v36, v36, v153, v152
  v_fma_f32 v37, v37, v153, v152
  v_fma_f32 v38, v38, v153, v152
  v_fma_f32 v39, v39, v153, v152
  v_fma_f32 v40, v40, v153, v152
  v_fma_f32 v41, v41, v153, v152
  v_fma_f32 v42, v42, v153, v152
  v_fma_f32 v43, v43, v153, v152
  v_fma_f32 v44, v44, v153, v152
  v_fma_f32 v45, v45, v153, v152
  v_fma_f32 v46, v46, v153, v152
  v_fma_f32 v47, v47, v153, v152
  v_exp_f32 v32, v32
  v_exp_f32 v33, v33
  v_exp_f32 v34, v34
  v_exp_f32 v35, v35
  v_exp_f32 v36, v36
  v_exp_f32 v37, v37
  v_exp_f32 v38, v38
  v_exp_f32 v39, v39
  v_exp_f32 v40, v40
  v_exp_f32 v41, v41
  v_exp_f32 v42, v42
  v_exp_f32 v43, v43
  v_exp_f32 v44, v44
  v_exp_f32 v45, v45
  v_exp_f32 v46, v46
  v_exp_f32 v47, v47
  s_nop 0
  v_add_f32 v154, v154, v32
  v_add_f32 v154, v154, v33
  v_add_f32 v154, v154, v34
  v_add_f32 v154, v154, v35
  v_add_f32 v154, v154, v36
  v_add_f32 v154, v154, v37
  v_add_f32 v154, v154, v38
  v_add_f32 v154, v154, v39
  v_add_f32 v154, v154, v40
  v_add_f32 v154, v154, v41
  v_add_f32 v154, v154, v42
  v_add_f32 v154, v154, v43
  v_add_f32 v154, v154, v44
  v_add_f32 v154, v154, v45
  v_add_f32 v154, v154, v46
  v_add_f32 v154, v154, v47
  v_cvt_pk_bf16_f32 v84, v32, v33
  v_cvt_pk_bf16_f32 v85, v34, v35
  v_cvt_pk_bf16_f32 v86, v36, v37
  v_cvt_pk_bf16_f32 v87, v38, v39
  ds_write_b128 v204, v[84:87] offset:4096
  s_nop 1
  v_cvt_pk_bf16_f32 v84, v40, v41
  v_cvt_pk_bf16_f32 v85, v42, v43
  v_cvt_pk_bf16_f32 v86, v44, v45
  v_cvt_pk_bf16_f32 v87, v46, v47
  ds_write_b128 v204, v[84:87] offset:5120
  s_nop 1
  s_branch K3_UlS3
K3_Uw3S3:
  s_cmp_eq_u32 s40, 3
  s_cbranch_scc0 K3_Uw4S3
  s_branch K3_UlS3
K3_Uw4S3:
K3_UlS3:
  v_lshlrev_b32 v205, 2, v200
  s_lshl_b32 s53, s40, 8
  s_add_u32 s53, s53, 108544
  v_add_u32 v206, s53, v205
  ds_write_b32 v206, v154

  v_bfe_u32 v204, v200, 2, 2
  v_lshl_add_u32 v205, v203, 3, v204
  v_lshlrev_b32 v205, 8, v205
  v_xor_b32 v204, s40, v204
  v_lshl_add_u32 v205, v204, 6, v205
  v_bfe_u32 v206, v200, 4, 1
  v_lshl_add_u32 v205, v206, 5, v205
  v_and_b32 v206, 1, v200
  v_lshl_add_u32 v205, v206, 4, v205
  v_bfe_u32 v206, v200, 1, 1
  v_lshl_add_u32 v191, v206, 3, v205
  v_add_u32 v192, 24576, v191
  v_add_u32 v193, 49152, v191
  v_add_u32 v195, 73728, v191
  s_mul_i32 s53, s43, 11
  s_add_u32 s53, s53, s41
  s_lshl_b32 s53, s53, 5
  v_add_u32 v204, s53, v202
  v_mul_u32_u24 v204, 1536, v204
  v_lshl_add_u32 v204, v203, 4, v204
  s_lshl_b32 s53, s40, 6
  v_add_u32 v194, s53, v204

  s_add_u32 s28, s12, 34603008
  s_addc_u32 s29, s13, 0
  s_mov_b32 s30, 1081344
  s_mov_b32 s31, 0x00020000
  s_add_u32 s24, s12, 33554432
  s_addc_u32 s25, s13, 0
  s_mov_b32 s26, 8192
  s_mov_b32 s27, 0x00020000
  s_waitcnt lgkmcnt(0)
  s_barrier
  v_lshlrev_b32 v204, 4, v200
  v_add_u32 v204, 98304, v204
  s_cmp_lg_u32 s40, 0
  s_cbranch_scc1 K3_UnsS3
  v_lshlrev_b32 v205, 2, v200
  v_add_u32 v206, 108544, v205
  ds_read_b32 v0, v206
  ds_read_b32 v1, v206 offset:256
  ds_read_b32 v2, v206 offset:512
  ds_read_b32 v3, v206 offset:768
  s_waitcnt lgkmcnt(0)
  v_add_f32 v0, v0, v1
  v_add_f32 v2, v2, v3
  v_add_f32 v0, v0, v2
  v_mov_b32 v1, v0
  s_nop 1
  v_permlane32_swap_b32 v0, v1
  s_nop 1
  v_add_f32 v151, v0, v1
  s_lshl_b32 s55, s43, 5
  v_add_u32 v206, s55, v202
  v_lshlrev_b32 v206, 7, v206
  s_lshl_b32 s54, s41, 3
  v_cmp_gt_u32 vcc, 32, v200
  s_and_saveexec_b64 s[56:57], vcc
  buffer_store_dwordx2 v[150:151], v206, s[24:27], s54 offen
  s_mov_b64 exec, s[56:57]
K3_UnsS3:

  ds_read_b128 v[84:87], v204 offset:0
  ds_read_b128 v[88:91], v204 offset:1024
  ds_read_b128 v[92:95], v204 offset:2048
  ds_read_b128 v[96:99], v204 offset:3072
  ds_read_b128 v[100:103], v204 offset:4096
  ds_read_b128 v[104:107], v204 offset:5120
  s_waitcnt vmcnt(12)
  s_barrier
  ds_read_b64_tr_b16 v[0:1], v191 offset:0
  ds_read_b64_tr_b16 v[2:3], v191 offset:1024
  ds_read_b64_tr_b16 v[4:5], v191 offset:4096
  ds_read_b64_tr_b16 v[6:7], v191 offset:5120
  ds_read_b64_tr_b16 v[8:9], v191 offset:8192
  ds_read_b64_tr_b16 v[10:11], v191 offset:9216
  ds_read_b64_tr_b16 v[12:13], v191 offset:12288
  ds_read_b64_tr_b16 v[14:15], v191 offset:13312
  ds_read_b64_tr_b16 v[16:17], v191 offset:16384
  ds_read_b64_tr_b16 v[18:19], v191 offset:17408
  ds_read_b64_tr_b16 v[20:21], v191 offset:20480
  ds_read_b64_tr_b16 v[22:23], v191 offset:21504
  s_add_u32 m0, s51, 73728
  s_add_u32 s56, s48, 768
  buffer_load_dwordx4 v190, s[16:19], s56 offen lds
  s_add_u32 m0, s51, 74752
  s_add_u32 s56, s48, 19200
  buffer_load_dwordx4 v190, s[16:19], s56 offen lds
  s_add_u32 m0, s51, 75776
  s_add_u32 s56, s48, 37632
  buffer_load_dwordx4 v190, s[16:19], s56 offen lds
  s_add_u32 m0, s51, 76800
  s_add_u32 s56, s48, 56064
  buffer_load_dwordx4 v190, s[16:19], s56 offen lds
  s_add_u32 m0, s51, 77824
  s_add_u32 s56, s48, 74496
  buffer_load_dwordx4 v190, s[16:19], s56 offen lds
  s_add_u32 m0, s51, 78848
  s_add_u32 s56, s48, 92928
  buffer_load_dwordx4 v190, s[16:19], s56 offen lds
  s_waitcnt lgkmcnt(10)
  v_mfma_f32_32x32x16_bf16 v[40:55], v[0:3], v[84:87], 0
  s_waitcnt lgkmcnt(8)
  v_mfma_f32_32x32x16_bf16 v[40:55], v[4:7], v[88:91], v[40:55]
  s_waitcnt lgkmcnt(6)
  v_mfma_f32_32x32x16_bf16 v[40:55], v[8:11], v[92:95], v[40:55]
  s_waitcnt lgkmcnt(4)
  v_mfma_f32_32x32x16_bf16 v[40:55], v[12:15], v[96:99], v[40:55]
  s_waitcnt lgkmcnt(2)
  v_mfma_f32_32x32x16_bf16 v[40:55], v[16:19], v[100:103], v[40:55]
  s_waitcnt lgkmcnt(0)
  v_mfma_f32_32x32x16_bf16 v[40:55], v[20:23], v[104:107], v[40:55]
  s_waitcnt vmcnt(12)
  s_barrier
  ds_read_b64_tr_b16 v[0:1], v192 offset:0
  ds_read_b64_tr_b16 v[2:3], v192 offset:1024
  ds_read_b64_tr_b16 v[4:5], v192 offset:4096
  ds_read_b64_tr_b16 v[6:7], v192 offset:5120
  ds_read_b64_tr_b16 v[8:9], v192 offset:8192
  ds_read_b64_tr_b16 v[10:11], v192 offset:9216
  ds_read_b64_tr_b16 v[12:13], v192 offset:12288
  ds_read_b64_tr_b16 v[14:15], v192 offset:13312
  ds_read_b64_tr_b16 v[16:17], v192 offset:16384
  ds_read_b64_tr_b16 v[18:19], v192 offset:17408
  ds_read_b64_tr_b16 v[20:21], v192 offset:20480
  ds_read_b64_tr_b16 v[22:23], v192 offset:21504
  s_add_u32 m0, s51, 0
  s_add_u32 s56, s48, 1024
  buffer_load_dwordx4 v190, s[16:19], s56 offen lds
  s_add_u32 m0, s51, 1024
  s_add_u32 s56, s48, 19456
  buffer_load_dwordx4 v190, s[16:19], s56 offen lds
  s_add_u32 m0, s51, 2048
  s_add_u32 s56, s48, 37888
  buffer_load_dwordx4 v190, s[16:19], s56 offen lds
  s_add_u32 m0, s51, 3072
  s_add_u32 s56, s48, 56320
  buffer_load_dwordx4 v190, s[16:19], s56 offen lds
  s_add_u32 m0, s51, 4096
  s_add_u32 s56, s48, 74752
  buffer_load_dwordx4 v190, s[16:19], s56 offen lds
  s_add_u32 m0, s51, 5120
  s_add_u32 s56, s48, 93184
  buffer_load_dwordx4 v190, s[16:19], s56 offen lds
  s_waitcnt lgkmcnt(10)
  v_mfma_f32_32x32x16_bf16 v[56:71], v[0:3], v[84:87], 0
  s_waitcnt lgkmcnt(8)
  v_mfma_f32_32x32x16_bf16 v[56:71], v[4:7], v[88:91], v[56:71]
  s_waitcnt lgkmcnt(6)
  v_mfma_f32_32x32x16_bf16 v[56:71], v[8:11], v[92:95], v[56:71]
  v_cvt_pk_bf16_f32 v72, v40, v41
  v_cvt_pk_bf16_f32 v73, v42, v43
  v_cvt_pk_bf16_f32 v74, v44, v45
  s_waitcnt lgkmcnt(4)
  v_mfma_f32_32x32x16_bf16 v[56:71], v[12:15], v[96:99], v[56:71]
  v_cvt_pk_bf16_f32 v75, v46, v47
  buffer_store_dwordx4 v[72:75], v194, s[28:31], 0 offen offset:0
  v_cvt_pk_bf16_f32 v76, v48, v49
  s_waitcnt lgkmcnt(2)
  v_mfma_f32_32x32x16_bf16 v[56:71], v[16:19], v[100:103], v[56:71]
  v_cvt_pk_bf16_f32 v77, v50, v51
  v_cvt_pk_bf16_f32 v78, v52, v53
  v_cvt_pk_bf16_f32 v79, v54, v55
  s_waitcnt lgkmcnt(0)
  v_mfma_f32_32x32x16_bf16 v[56:71], v[20:23], v[104:107], v[56:71]
  buffer_store_dwordx4 v[76:79], v194, s[28:31], 0 offen offset:32
  s_waitcnt vmcnt(14)
  s_barrier
  ds_read_b64_tr_b16 v[0:1], v193 offset:0
  ds_read_b64_tr_b16 v[2:3], v193 offset:1024
  ds_read_b64_tr_b16 v[4:5], v193 offset:4096
  ds_read_b64_tr_b16 v[6:7], v193 offset:5120
  ds_read_b64_tr_b16 v[8:9], v193 offset:8192
  ds_read_b64_tr_b16 v[10:11], v193 offset:9216
  ds_read_b64_tr_b16 v[12:13], v193 offset:12288
  ds_read_b64_tr_b16 v[14:15], v193 offset:13312
  ds_read_b64_tr_b16 v[16:17], v193 offset:16384
  ds_read_b64_tr_b16 v[18:19], v193 offset:17408
  ds_read_b64_tr_b16 v[20:21], v193 offset:20480
  ds_read_b64_tr_b16 v[22:23], v193 offset:21504
  s_add_u32 m0, s51, 24576
  s_add_u32 s56, s48, 1280
  buffer_load_dwordx4 v190, s[16:19], s56 offen lds
  s_add_u32 m0, s51, 25600
  s_add_u32 s56, s48, 19712
  buffer_load_dwordx4 v190, s[16:19], s56 offen lds
  s_add_u32 m0, s51, 26624
  s_add_u32 s56, s48, 38144
  buffer_load_dwordx4 v190, s[16:19], s56 offen lds
  s_add_u32 m0, s51, 27648
  s_add_u32 s56, s48, 56576
  buffer_load_dwordx4 v190, s[16:19], s56 offen lds
  s_add_u32 m0, s51, 28672
  s_add_u32 s56, s48, 75008
  buffer_load_dwordx4 v190, s[16:19], s56 offen lds
  s_add_u32 m0, s51, 29696
  s_add_u32 s56, s48, 93440
  buffer_load_dwordx4 v190, s[16:19], s56 offen lds
  s_waitcnt lgkmcnt(10)
  v_mfma_f32_32x32x16_bf16 v[40:55], v[0:3], v[84:87], 0
  s_waitcnt lgkmcnt(8)
  v_mfma_f32_32x32x16_bf16 v[40:55], v[4:7], v[88:91], v[40:55]
  s_waitcnt lgkmcnt(6)
  v_mfma_f32_32x32x16_bf16 v[40:55], v[8:11], v[92:95], v[40:55]
  v_cvt_pk_bf16_f32 v72, v56, v57
  v_cvt_pk_bf16_f32 v73, v58, v59
  v_cvt_pk_bf16_f32 v74, v60, v61
  s_waitcnt lgkmcnt(4)
  v_mfma_f32_32x32x16_bf16 v[40:55], v[12:15], v[96:99], v[40:55]
  v_cvt_pk_bf16_f32 v75, v62, v63
  buffer_store_dwordx4 v[72:75], v194, s[28:31], 0 offen offset:256
  v_cvt_pk_bf16_f32 v76, v64, v65
  s_waitcnt lgkmcnt(2)
  v_mfma_f32_32x32x16_bf16 v[40:55], v[16:19], v[100:103], v[40:55]
  v_cvt_pk_bf16_f32 v77, v66, v67
  v_cvt_pk_bf16_f32 v78, v68, v69
  v_cvt_pk_bf16_f32 v79, v70, v71
  s_waitcnt lgkmcnt(0)
  v_mfma_f32_32x32x16_bf16 v[40:55], v[20:23], v[104:107], v[40:55]
  buffer_store_dwordx4 v[76:79], v194, s[28:31], 0 offen offset:288
  s_waitcnt vmcnt(16)
  s_barrier
  ds_read_b64_tr_b16 v[0:1], v195 offset:0
  ds_read_b64_tr_b16 v[2:3], v195 offset:1024
  ds_read_b64_tr_b16 v[4:5], v195 offset:4096
  ds_read_b64_tr_b16 v[6:7], v195 offset:5120
  ds_read_b64_tr_b16 v[8:9], v195 offset:8192
  ds_read_b64_tr_b16 v[10:11], v195 offset:9216
  ds_read_b64_tr_b16 v[12:13], v195 offset:12288
  ds_read_b64_tr_b16 v[14:15], v195 offset:13312
  ds_read_b64_tr_b16 v[16:17], v195 offset:16384
  ds_read_b64_tr_b16 v[18:19], v195 offset:17408
  ds_read_b64_tr_b16 v[20:21], v195 offset:20480
  ds_read_b64_tr_b16 v[22:23], v195 offset:21504
  s_waitcnt lgkmcnt(10)
  v_mfma_f32_32x32x16_bf16 v[56:71], v[0:3], v[84:87], 0
  s_waitcnt lgkmcnt(8)
  v_mfma_f32_32x32x16_bf16 v[56:71], v[4:7], v[88:91], v[56:71]
  s_waitcnt lgkmcnt(6)
  v_mfma_f32_32x32x16_bf16 v[56:71], v[8:11], v[92:95], v[56:71]
  v_cvt_pk_bf16_f32 v72, v40, v41
  v_cvt_pk_bf16_f32 v73, v42, v43
  v_cvt_pk_bf16_f32 v74, v44, v45
  s_waitcnt lgkmcnt(4)
  v_mfma_f32_32x32x16_bf16 v[56:71], v[12:15], v[96:99], v[56:71]
  v_cvt_pk_bf16_f32 v75, v46, v47
  buffer_store_dwordx4 v[72:75], v194, s[28:31], 0 offen offset:512
  v_cvt_pk_bf16_f32 v76, v48, v49
  s_waitcnt lgkmcnt(2)
  v_mfma_f32_32x32x16_bf16 v[56:71], v[16:19], v[100:103], v[56:71]
  v_cvt_pk_bf16_f32 v77, v50, v51
  v_cvt_pk_bf16_f32 v78, v52, v53
  v_cvt_pk_bf16_f32 v79, v54, v55
  s_waitcnt lgkmcnt(0)
  v_mfma_f32_32x32x16_bf16 v[56:71], v[20:23], v[104:107], v[56:71]
  buffer_store_dwordx4 v[76:79], v194, s[28:31], 0 offen offset:544
  s_waitcnt vmcnt(12)
  s_barrier
  ds_read_b64_tr_b16 v[0:1], v191 offset:0
  ds_read_b64_tr_b16 v[2:3], v191 offset:1024
  ds_read_b64_tr_b16 v[4:5], v191 offset:4096
  ds_read_b64_tr_b16 v[6:7], v191 offset:5120
  ds_read_b64_tr_b16 v[8:9], v191 offset:8192
  ds_read_b64_tr_b16 v[10:11], v191 offset:9216
  ds_read_b64_tr_b16 v[12:13], v191 offset:12288
  ds_read_b64_tr_b16 v[14:15], v191 offset:13312
  ds_read_b64_tr_b16 v[16:17], v191 offset:16384
  ds_read_b64_tr_b16 v[18:19], v191 offset:17408
  ds_read_b64_tr_b16 v[20:21], v191 offset:20480
  ds_read_b64_tr_b16 v[22:23], v191 offset:21504
  s_waitcnt lgkmcnt(10)
  v_mfma_f32_32x32x16_bf16 v[40:55], v[0:3], v[84:87], 0
  s_waitcnt lgkmcnt(8)
  v_mfma_f32_32x32x16_bf16 v[40:55], v[4:7], v[88:91], v[40:55]
  s_waitcnt lgkmcnt(6)
  v_mfma_f32_32x32x16_bf16 v[40:55], v[8:11], v[92:95], v[40:55]
  v_cvt_pk_bf16_f32 v72, v56, v57
  v_cvt_pk_bf16_f32 v73, v58, v59
  v_cvt_pk_bf16_f32 v74, v60, v61
  s_waitcnt lgkmcnt(4)
  v_mfma_f32_32x32x16_bf16 v[40:55], v[12:15], v[96:99], v[40:55]
  v_cvt_pk_bf16_f32 v75, v62, v63
  buffer_store_dwordx4 v[72:75], v194, s[28:31], 0 offen offset:768
  v_cvt_pk_bf16_f32 v76, v64, v65
  s_waitcnt lgkmcnt(2)
  v_mfma_f32_32x32x16_bf16 v[40:55], v[16:19], v[100:103], v[40:55]
  v_cvt_pk_bf16_f32 v77, v66, v67
  v_cvt_pk_bf16_f32 v78, v68, v69
  v_cvt_pk_bf16_f32 v79, v70, v71
  s_waitcnt lgkmcnt(0)
  v_mfma_f32_32x32x16_bf16 v[40:55], v[20:23], v[104:107], v[40:55]
  buffer_store_dwordx4 v[76:79], v194, s[28:31], 0 offen offset:800
  s_waitcnt vmcnt(6)
  s_barrier
  ds_read_b64_tr_b16 v[0:1], v192 offset:0
  ds_read_b64_tr_b16 v[2:3], v192 offset:1024
  ds_read_b64_tr_b16 v[4:5], v192 offset:4096
  ds_read_b64_tr_b16 v[6:7], v192 offset:5120
  ds_read_b64_tr_b16 v[8:9], v192 offset:8192
  ds_read_b64_tr_b16 v[10:11], v192 offset:9216
  ds_read_b64_tr_b16 v[12:13], v192 offset:12288
  ds_read_b64_tr_b16 v[14:15], v192 offset:13312
  ds_read_b64_tr_b16 v[16:17], v192 offset:16384
  ds_read_b64_tr_b16 v[18:19], v192 offset:17408
  ds_read_b64_tr_b16 v[20:21], v192 offset:20480
  ds_read_b64_tr_b16 v[22:23], v192 offset:21504
  s_waitcnt lgkmcnt(10)
  v_mfma_f32_32x32x16_bf16 v[56:71], v[0:3], v[84:87], 0
  s_waitcnt lgkmcnt(8)
  v_mfma_f32_32x32x16_bf16 v[56:71], v[4:7], v[88:91], v[56:71]
  s_waitcnt lgkmcnt(6)
  v_mfma_f32_32x32x16_bf16 v[56:71], v[8:11], v[92:95], v[56:71]
  v_cvt_pk_bf16_f32 v72, v40, v41
  v_cvt_pk_bf16_f32 v73, v42, v43
  v_cvt_pk_bf16_f32 v74, v44, v45
  s_waitcnt lgkmcnt(4)
  v_mfma_f32_32x32x16_bf16 v[56:71], v[12:15], v[96:99], v[56:71]
  v_cvt_pk_bf16_f32 v75, v46, v47
  buffer_store_dwordx4 v[72:75], v194, s[28:31], 0 offen offset:1024
  v_cvt_pk_bf16_f32 v76, v48, v49
  s_waitcnt lgkmcnt(2)
  v_mfma_f32_32x32x16_bf16 v[56:71], v[16:19], v[100:103], v[56:71]
  v_cvt_pk_bf16_f32 v77, v50, v51
  v_cvt_pk_bf16_f32 v78, v52, v53
  v_cvt_pk_bf16_f32 v79, v54, v55
  s_waitcnt lgkmcnt(0)
  v_mfma_f32_32x32x16_bf16 v[56:71], v[20:23], v[104:107], v[56:71]
  buffer_store_dwordx4 v[76:79], v194, s[28:31], 0 offen offset:1056
  s_nop 15
  s_nop 7
  v_cvt_pk_bf16_f32 v72, v56, v57
  v_cvt_pk_bf16_f32 v73, v58, v59
  v_cvt_pk_bf16_f32 v74, v60, v61
  v_cvt_pk_bf16_f32 v75, v62, v63
  buffer_store_dwordx4 v[72:75], v194, s[28:31], 0 offen offset:1280
  v_cvt_pk_bf16_f32 v76, v64, v65
  v_cvt_pk_bf16_f32 v77, v66, v67
  v_cvt_pk_bf16_f32 v78, v68, v69
  v_cvt_pk_bf16_f32 v79, v70, v71
  buffer_store_dwordx4 v[76:79], v194, s[28:31], 0 offen offset:1312
  s_endpgm
K3_V:
  s_waitcnt lgkmcnt(0)
  s_add_u32 s16, s12, 1048576
  s_addc_u32 s17, s13, 0
  s_mov_b32 s18, 9732096
  s_mov_b32 s19, 0x00020000
  s_mov_b32 s20, s8
  s_mov_b32 s21, s9
  s_mov_b32 s22, 1179648
  s_mov_b32 s23, 0x00020000

  s_add_u32 s24, s12, 26214400
  s_addc_u32 s25, s13, 0
  s_mov_b32 s26, 3342336
  s_mov_b32 s27, 0x00020000
  v_lshrrev_b32 v202, 3, v200
  v_and_b32 v203, 7, v200
  v_lshrrev_b32 v204, 4, v200
  v_xor_b32 v205, v203, v204
  v_xor_b32 v206, 4, v205
  v_mul_u32_u24 v202, 4608, v202
  v_lshl_add_u32 v190, v205, 4, v202
  v_lshl_add_u32 v191, v206, 4, v202

  s_mul_i32 s46, s43, 1056
  s_add_u32 s47, s44, s46
  s_mul_i32 s48, s47, 4608
  s_add_u32 s48, s48, 3072
  s_lshl_b32 s51, s40, 12
  v_lshrrev_b32 v202, 4, v200
  v_and_b32 v203, 15, v200
  v_lshlrev_b32 v204, 2, v202
  v_xor_b32 v203, v203, v204
  v_mul_u32_u24 v202, 1536, v202
  v_lshl_add_u32 v192, v203, 4, v202
  s_lshl_b32 s49, s45, 8
  s_mul_i32 s50, s40, 24576
  s_add_u32 s49, s49, s50
  s_lshl_b32 s52, s40, 12
  s_add_u32 s52, s52, 16384

  s_add_u32 m0, s51, 0
  s_add_u32 s56, s48, 0
  buffer_load_dwordx4 v190, s[16:19], s56 offen lds
  s_add_u32 m0, s51, 1024
  s_add_u32 s56, s48, 36864
  buffer_load_dwordx4 v191, s[16:19], s56 offen lds
  s_add_u32 m0, s51, 2048
  s_add_u32 s56, s48, 73728
  buffer_load_dwordx4 v190, s[16:19], s56 offen lds
  s_add_u32 m0, s51, 3072
  s_add_u32 s56, s48, 110592
  buffer_load_dwordx4 v191, s[16:19], s56 offen lds
  s_add_u32 m0, s52, 0
  s_add_u32 s56, s49, 0
  buffer_load_dwordx4 v192, s[20:23], s56 offen lds
  s_add_u32 m0, s52, 1024
  s_add_u32 s56, s49, 6144
  buffer_load_dwordx4 v192, s[20:23], s56 offen lds
  s_add_u32 m0, s52, 2048
  s_add_u32 s56, s49, 12288
  buffer_load_dwordx4 v192, s[20:23], s56 offen lds
  s_add_u32 m0, s52, 3072
  s_add_u32 s56, s49, 18432
  buffer_load_dwordx4 v192, s[20:23], s56 offen lds
  s_add_u32 m0, s51, 36864
  s_add_u32 s56, s48, 128
  buffer_load_dwordx4 v190, s[16:19], s56 offen lds
  s_add_u32 m0, s51, 37888
  s_add_u32 s56, s48, 36992
  buffer_load_dwordx4 v191, s[16:19], s56 offen lds
  s_add_u32 m0, s51, 38912
  s_add_u32 s56, s48, 73856
  buffer_load_dwordx4 v190, s[16:19], s56 offen lds
  s_add_u32 m0, s51, 39936
  s_add_u32 s56, s48, 110720
  buffer_load_dwordx4 v191, s[16:19], s56 offen lds
  s_add_u32 m0, s52, 36864
  s_add_u32 s56, s49, 98304
  buffer_load_dwordx4 v192, s[20:23], s56 offen lds
  s_add_u32 m0, s52, 37888
  s_add_u32 s56, s49, 104448
  buffer_load_dwordx4 v192, s[20:23], s56 offen lds
  s_add_u32 m0, s52, 38912
  s_add_u32 s56, s49, 110592
  buffer_load_dwordx4 v192, s[20:23], s56 offen lds
  s_add_u32 m0, s52, 39936
  s_add_u32 s56, s49, 116736
  buffer_load_dwordx4 v192, s[20:23], s56 offen lds
  v_and_b32 v202, 31, v200
  v_lshrrev_b32 v203, 5, v200

  v_and_b32 v204, 3, v202
  v_bfe_u32 v205, v202, 2, 1
  v_lshl_add_u32 v204, v205, 3, v204
  v_bfe_u32 v205, v202, 3, 1
  v_lshl_add_u32 v204, v205, 2, v204
  v_bfe_u32 v205, v202, 4, 1
  v_lshl_add_u32 v204, v205, 4, v204

  v_bfe_u32 v205, v204, 1, 3
  v_xor_b32 v205, v205, v203
  v_lshlrev_b32 v205, 4, v205
  v_lshl_add_u32 v205, v204, 7, v205
  s_lshl_b32 s53, s40, 12
  v_add_u32 v130, s53, v205
  v_bfe_u32 v204, v200, 2, 2
  v_lshl_add_u32 v205, v203, 3, v204
  v_lshlrev_b32 v205, 8, v205
  v_lshl_add_u32 v205, v204, 6, v205
  v_bfe_u32 v206, v200, 4, 1
  v_lshl_add_u32 v205, v206, 5, v205
  v_and_b32 v206, 3, v200
  v_lshl_add_u32 v205, v206, 3, v205
  v_add_u32 v134, 16384, v205

  v_xor_b32 v131, 32, v130
  v_xor_b32 v135, 64, v134
  v_xor_b32 v132, 64, v130
  v_xor_b32 v136, 128, v134
  v_xor_b32 v133, 96, v130
  v_xor_b32 v137, 192, v134
  s_add_u32 m0, s51, 73728
  s_add_u32 s56, s48, 256
  buffer_load_dwordx4 v190, s[16:19], s56 offen lds
  s_add_u32 m0, s51, 74752
  s_add_u32 s56, s48, 37120
  buffer_load_dwordx4 v191, s[16:19], s56 offen lds
  s_add_u32 m0, s51, 75776
  s_add_u32 s56, s48, 73984
  buffer_load_dwordx4 v190, s[16:19], s56 offen lds
  s_add_u32 m0, s51, 76800
  s_add_u32 s56, s48, 110848
  buffer_load_dwordx4 v191, s[16:19], s56 offen lds
  s_add_u32 m0, s52, 73728
  s_add_u32 s56, s49, 196608
  buffer_load_dwordx4 v192, s[20:23], s56 offen lds
  s_add_u32 m0, s52, 74752
  s_add_u32 s56, s49, 202752
  buffer_load_dwordx4 v192, s[20:23], s56 offen lds
  s_add_u32 m0, s52, 75776
  s_add_u32 s56, s49, 208896
  buffer_load_dwordx4 v192, s[20:23], s56 offen lds
  s_add_u32 m0, s52, 76800
  s_add_u32 s56, s49, 215040
  buffer_load_dwordx4 v192, s[20:23], s56 offen lds
  s_add_u32 m0, s51, 110592
  s_add_u32 s56, s48, 384
  buffer_load_dwordx4 v190, s[16:19], s56 offen lds
  s_add_u32 m0, s51, 111616
  s_add_u32 s56, s48, 37248
  buffer_load_dwordx4 v191, s[16:19], s56 offen lds
  s_add_u32 m0, s51, 112640
  s_add_u32 s56, s48, 74112
  buffer_load_dwordx4 v190, s[16:19], s56 offen lds
  s_add_u32 m0, s51, 113664
  s_add_u32 s56, s48, 110976
  buffer_load_dwordx4 v191, s[16:19], s56 offen lds
  s_add_u32 m0, s52, 110592
  s_add_u32 s56, s49, 294912
  buffer_load_dwordx4 v192, s[20:23], s56 offen lds
  s_add_u32 m0, s52, 111616
  s_add_u32 s56, s49, 301056
  buffer_load_dwordx4 v192, s[20:23], s56 offen lds
  s_add_u32 m0, s52, 112640
  s_add_u32 s56, s49, 307200
  buffer_load_dwordx4 v192, s[20:23], s56 offen lds
  s_add_u32 m0, s52, 113664
  s_add_u32 s56, s49, 313344
  buffer_load_dwordx4 v192, s[20:23], s56 offen lds
  s_waitcnt vmcnt(24)
  s_barrier
  v_add_u32 v138, 0, v130
  v_add_u32 v142, 0, v134
  v_add_u32 v143, 0, v135
  v_add_u32 v144, 0, v136
  v_add_u32 v145, 0, v137
  ds_read_b128 v[80:83], v138
  ds_read_b64_tr_b16 v[84:85], v142 offset:0
  ds_read_b64_tr_b16 v[86:87], v142 offset:1024
  ds_read_b64_tr_b16 v[88:89], v143 offset:0
  ds_read_b64_tr_b16 v[90:91], v143 offset:1024
  ds_read_b64_tr_b16 v[92:93], v144 offset:0
  ds_read_b64_tr_b16 v[94:95], v144 offset:1024
  ds_read_b64_tr_b16 v[96:97], v145 offset:0
  ds_read_b64_tr_b16 v[98:99], v145 offset:1024
  v_add_u32 v138, 0, v131
  ds_read_b128 v[104:107], v138
  ds_read_b64_tr_b16 v[108:109], v142 offset:4096
  ds_read_b64_tr_b16 v[110:111], v142 offset:5120
  ds_read_b64_tr_b16 v[112:113], v143 offset:4096
  ds_read_b64_tr_b16 v[114:115], v143 offset:5120
  ds_read_b64_tr_b16 v[116:117], v144 offset:4096
  ds_read_b64_tr_b16 v[118:119], v144 offset:5120
  ds_read_b64_tr_b16 v[120:121], v145 offset:4096
  ds_read_b64_tr_b16 v[122:123], v145 offset:5120
  s_waitcnt lgkmcnt(9)
  v_mfma_f32_32x32x16_bf16 v[0:15], v[80:83], v[84:87], 0
  v_mfma_f32_32x32x16_bf16 v[16:31], v[80:83], v[88:91], 0
  v_mfma_f32_32x32x16_bf16 v[32:47], v[80:83], v[92:95], 0
  v_mfma_f32_32x32x16_bf16 v[48:63], v[80:83], v[96:99], 0
  v_add_u32 v138, 0, v132
  ds_read_b128 v[80:83], v138
  ds_read_b64_tr_b16 v[84:85], v142 offset:8192
  ds_read_b64_tr_b16 v[86:87], v142 offset:9216
  ds_read_b64_tr_b16 v[88:89], v143 offset:8192
  ds_read_b64_tr_b16 v[90:91], v143 offset:9216
  ds_read_b64_tr_b16 v[92:93], v144 offset:8192
  ds_read_b64_tr_b16 v[94:95], v144 offset:9216
  ds_read_b64_tr_b16 v[96:97], v145 offset:8192
  ds_read_b64_tr_b16 v[98:99], v145 offset:9216
  s_waitcnt lgkmcnt(9)
  v_mfma_f32_32x32x16_bf16 v[0:15], v[104:107], v[108:111], v[0:15]
  s_waitcnt vmcnt(16)
  s_barrier
  v_mfma_f32_32x32x16_bf16 v[16:31], v[104:107], v[112:115], v[16:31]
  v_mfma_f32_32x32x16_bf16 v[32:47], v[104:107], v[116:119], v[32:47]
  v_mfma_f32_32x32x16_bf16 v[48:63], v[104:107], v[120:123], v[48:63]
  v_add_u32 v138, 0, v133
  ds_read_b128 v[104:107], v138
  ds_read_b64_tr_b16 v[108:109], v142 offset:12288
  ds_read_b64_tr_b16 v[110:111], v142 offset:13312
  ds_read_b64_tr_b16 v[112:113], v143 offset:12288
  ds_read_b64_tr_b16 v[114:115], v143 offset:13312
  ds_read_b64_tr_b16 v[116:117], v144 offset:12288
  ds_read_b64_tr_b16 v[118:119], v144 offset:13312
  ds_read_b64_tr_b16 v[120:121], v145 offset:12288
  ds_read_b64_tr_b16 v[122:123], v145 offset:13312
  s_waitcnt lgkmcnt(9)
  v_mfma_f32_32x32x16_bf16 v[0:15], v[80:83], v[84:87], v[0:15]
  v_mfma_f32_32x32x16_bf16 v[16:31], v[80:83], v[88:91], v[16:31]
  v_mfma_f32_32x32x16_bf16 v[32:47], v[80:83], v[92:95], v[32:47]
  v_mfma_f32_32x32x16_bf16 v[48:63], v[80:83], v[96:99], v[48:63]
  v_add_u32 v138, 36864, v130
  v_add_u32 v142, 36864, v134
  v_add_u32 v143, 36864, v135
  v_add_u32 v144, 36864, v136
  v_add_u32 v145, 36864, v137
  ds_read_b128 v[80:83], v138
  ds_read_b64_tr_b16 v[84:85], v142 offset:0
  ds_read_b64_tr_b16 v[86:87], v142 offset:1024
  ds_read_b64_tr_b16 v[88:89], v143 offset:0
  ds_read_b64_tr_b16 v[90:91], v143 offset:1024
  ds_read_b64_tr_b16 v[92:93], v144 offset:0
  ds_read_b64_tr_b16 v[94:95], v144 offset:1024
  ds_read_b64_tr_b16 v[96:97], v145 offset:0
  ds_read_b64_tr_b16 v[98:99], v145 offset:1024
  s_waitcnt lgkmcnt(9)
  v_mfma_f32_32x32x16_bf16 v[0:15], v[104:107], v[108:111], v[0:15]
  v_mfma_f32_32x32x16_bf16 v[16:31], v[104:107], v[112:115], v[16:31]
  v_mfma_f32_32x32x16_bf16 v[32:47], v[104:107], v[116:119], v[32:47]
  v_mfma_f32_32x32x16_bf16 v[48:63], v[104:107], v[120:123], v[48:63]
  v_add_u32 v138, 36864, v131
  ds_read_b128 v[104:107], v138
  ds_read_b64_tr_b16 v[108:109], v142 offset:4096
  ds_read_b64_tr_b16 v[110:111], v142 offset:5120
  ds_read_b64_tr_b16 v[112:113], v143 offset:4096
  ds_read_b64_tr_b16 v[114:115], v143 offset:5120
  ds_read_b64_tr_b16 v[116:117], v144 offset:4096
  ds_read_b64_tr_b16 v[118:119], v144 offset:5120
  ds_read_b64_tr_b16 v[120:121], v145 offset:4096
  ds_read_b64_tr_b16 v[122:123], v145 offset:5120
  s_waitcnt lgkmcnt(9)
  v_mfma_f32_32x32x16_bf16 v[0:15], v[80:83], v[84:87], v[0:15]
  v_mfma_f32_32x32x16_bf16 v[16:31], v[80:83], v[88:91], v[16:31]
  v_mfma_f32_32x32x16_bf16 v[32:47], v[80:83], v[92:95], v[32:47]
  v_mfma_f32_32x32x16_bf16 v[48:63], v[80:83], v[96:99], v[48:63]
  v_add_u32 v138, 36864, v132
  ds_read_b128 v[80:83], v138
  ds_read_b64_tr_b16 v[84:85], v142 offset:8192
  ds_read_b64_tr_b16 v[86:87], v142 offset:9216
  ds_read_b64_tr_b16 v[88:89], v143 offset:8192
  ds_read_b64_tr_b16 v[90:91], v143 offset:9216
  ds_read_b64_tr_b16 v[92:93], v144 offset:8192
  ds_read_b64_tr_b16 v[94:95], v144 offset:9216
  ds_read_b64_tr_b16 v[96:97], v145 offset:8192
  ds_read_b64_tr_b16 v[98:99], v145 offset:9216
  s_waitcnt lgkmcnt(9)
  v_mfma_f32_32x32x16_bf16 v[0:15], v[104:107], v[108:111], v[0:15]
  s_waitcnt vmcnt(8)
  s_barrier
  v_mfma_f32_32x32x16_bf16 v[16:31], v[104:107], v[112:115], v[16:31]
  s_add_u32 m0, s51, 0
  s_add_u32 s56, s48, 512
  buffer_load_dwordx4 v190, s[16:19], s56 offen lds
  s_add_u32 m0, s51, 1024
  v_mfma_f32_32x32x16_bf16 v[32:47], v[104:107], v[116:119], v[32:47]
  s_add_u32 s56, s48, 37376
  buffer_load_dwordx4 v191, s[16:19], s56 offen lds
  s_add_u32 m0, s51, 2048
  s_add_u32 s56, s48, 74240
  v_mfma_f32_32x32x16_bf16 v[48:63], v[104:107], v[120:123], v[48:63]
  buffer_load_dwordx4 v190, s[16:19], s56 offen lds
  s_add_u32 m0, s51, 3072
  s_add_u32 s56, s48, 111104
  buffer_load_dwordx4 v191, s[16:19], s56 offen lds
  v_add_u32 v138, 36864, v133
  ds_read_b128 v[104:107], v138
  ds_read_b64_tr_b16 v[108:109], v142 offset:12288
  ds_read_b64_tr_b16 v[110:111], v142 offset:13312
  ds_read_b64_tr_b16 v[112:113], v143 offset:12288
  ds_read_b64_tr_b16 v[114:115], v143 offset:13312
  ds_read_b64_tr_b16 v[116:117], v144 offset:12288
  ds_read_b64_tr_b16 v[118:119], v144 offset:13312
  ds_read_b64_tr_b16 v[120:121], v145 offset:12288
  ds_read_b64_tr_b16 v[122:123], v145 offset:13312
  s_waitcnt lgkmcnt(9)
  v_mfma_f32_32x32x16_bf16 v[0:15], v[80:83], v[84:87], v[0:15]
  s_add_u32 m0, s52, 0
  s_add_u32 s56, s49, 393216
  buffer_load_dwordx4 v192, s[20:23], s56 offen lds
  s_add_u32 m0, s52, 1024
  v_mfma_f32_32x32x16_bf16 v[16:31], v[80:83], v[88:91], v[16:31]
  s_add_u32 s56, s49, 399360
  buffer_load_dwordx4 v192, s[20:23], s56 offen lds
  s_add_u32 m0, s52, 2048
  s_add_u32 s56, s49, 405504
  v_mfma_f32_32x32x16_bf16 v[32:47], v[80:83], v[92:95], v[32:47]
  buffer_load_dwordx4 v192, s[20:23], s56 offen lds
  s_add_u32 m0, s52, 3072
  s_add_u32 s56, s49, 411648
  buffer_load_dwordx4 v192, s[20:23], s56 offen lds
  v_mfma_f32_32x32x16_bf16 v[48:63], v[80:83], v[96:99], v[48:63]
  v_add_u32 v138, 73728, v130
  v_add_u32 v142, 73728, v134
  v_add_u32 v143, 73728, v135
  v_add_u32 v144, 73728, v136
  v_add_u32 v145, 73728, v137
  ds_read_b128 v[80:83], v138
  ds_read_b64_tr_b16 v[84:85], v142 offset:0
  ds_read_b64_tr_b16 v[86:87], v142 offset:1024
  ds_read_b64_tr_b16 v[88:89], v143 offset:0
  ds_read_b64_tr_b16 v[90:91], v143 offset:1024
  ds_read_b64_tr_b16 v[92:93], v144 offset:0
  ds_read_b64_tr_b16 v[94:95], v144 offset:1024
  ds_read_b64_tr_b16 v[96:97], v145 offset:0
  ds_read_b64_tr_b16 v[98:99], v145 offset:1024
  s_waitcnt lgkmcnt(9)
  v_mfma_f32_32x32x16_bf16 v[0:15], v[104:107], v[108:111], v[0:15]
  v_mfma_f32_32x32x16_bf16 v[16:31], v[104:107], v[112:115], v[16:31]
  v_mfma_f32_32x32x16_bf16 v[32:47], v[104:107], v[116:119], v[32:47]
  v_mfma_f32_32x32x16_bf16 v[48:63], v[104:107], v[120:123], v[48:63]
  v_add_u32 v138, 73728, v131
  ds_read_b128 v[104:107], v138
  ds_read_b64_tr_b16 v[108:109], v142 offset:4096
  ds_read_b64_tr_b16 v[110:111], v142 offset:5120
  ds_read_b64_tr_b16 v[112:113], v143 offset:4096
  ds_read_b64_tr_b16 v[114:115], v143 offset:5120
  ds_read_b64_tr_b16 v[116:117], v144 offset:4096
  ds_read_b64_tr_b16 v[118:119], v144 offset:5120
  ds_read_b64_tr_b16 v[120:121], v145 offset:4096
  ds_read_b64_tr_b16 v[122:123], v145 offset:5120
  s_waitcnt lgkmcnt(9)
  v_mfma_f32_32x32x16_bf16 v[0:15], v[80:83], v[84:87], v[0:15]
  v_mfma_f32_32x32x16_bf16 v[16:31], v[80:83], v[88:91], v[16:31]
  v_mfma_f32_32x32x16_bf16 v[32:47], v[80:83], v[92:95], v[32:47]
  v_mfma_f32_32x32x16_bf16 v[48:63], v[80:83], v[96:99], v[48:63]
  v_add_u32 v138, 73728, v132
  ds_read_b128 v[80:83], v138
  ds_read_b64_tr_b16 v[84:85], v142 offset:8192
  ds_read_b64_tr_b16 v[86:87], v142 offset:9216
  ds_read_b64_tr_b16 v[88:89], v143 offset:8192
  ds_read_b64_tr_b16 v[90:91], v143 offset:9216
  ds_read_b64_tr_b16 v[92:93], v144 offset:8192
  ds_read_b64_tr_b16 v[94:95], v144 offset:9216
  ds_read_b64_tr_b16 v[96:97], v145 offset:8192
  ds_read_b64_tr_b16 v[98:99], v145 offset:9216
  s_waitcnt lgkmcnt(9)
  v_mfma_f32_32x32x16_bf16 v[0:15], v[104:107], v[108:111], v[0:15]
  s_waitcnt vmcnt(8)
  s_barrier
  v_mfma_f32_32x32x16_bf16 v[16:31], v[104:107], v[112:115], v[16:31]
  s_add_u32 m0, s51, 36864
  s_add_u32 s56, s48, 640
  buffer_load_dwordx4 v190, s[16:19], s56 offen lds
  s_add_u32 m0, s51, 37888
  v_mfma_f32_32x32x16_bf16 v[32:47], v[104:107], v[116:119], v[32:47]
  s_add_u32 s56, s48, 37504
  buffer_load_dwordx4 v191, s[16:19], s56 offen lds
  s_add_u32 m0, s51, 38912
  s_add_u32 s56, s48, 74368
  v_mfma_f32_32x32x16_bf16 v[48:63], v[104:107], v[120:123], v[48:63]
  buffer_load_dwordx4 v190, s[16:19], s56 offen lds
  s_add_u32 m0, s51, 39936
  s_add_u32 s56, s48, 111232
  buffer_load_dwordx4 v191, s[16:19], s56 offen lds
  v_add_u32 v138, 73728, v133
  ds_read_b128 v[104:107], v138
  ds_read_b64_tr_b16 v[108:109], v142 offset:12288
  ds_read_b64_tr_b16 v[110:111], v142 offset:13312
  ds_read_b64_tr_b16 v[112:113], v143 offset:12288
  ds_read_b64_tr_b16 v[114:115], v143 offset:13312
  ds_read_b64_tr_b16 v[116:117], v144 offset:12288
  ds_read_b64_tr_b16 v[118:119], v144 offset:13312
  ds_read_b64_tr_b16 v[120:121], v145 offset:12288
  ds_read_b64_tr_b16 v[122:123], v145 offset:13312
  s_waitcnt lgkmcnt(9)
  v_mfma_f32_32x32x16_bf16 v[0:15], v[80:83], v[84:87], v[0:15]
  s_add_u32 m0, s52, 36864
  s_add_u32 s56, s49, 491520
  buffer_load_dwordx4 v192, s[20:23], s56 offen lds
  s_add_u32 m0, s52, 37888
  v_mfma_f32_32x32x16_bf16 v[16:31], v[80:83], v[88:91], v[16:31]
  s_add_u32 s56, s49, 497664
  buffer_load_dwordx4 v192, s[20:23], s56 offen lds
  s_add_u32 m0, s52, 38912
  s_add_u32 s56, s49, 503808
  v_mfma_f32_32x32x16_bf16 v[32:47], v[80:83], v[92:95], v[32:47]
  buffer_load_dwordx4 v192, s[20:23], s56 offen lds
  s_add_u32 m0, s52, 39936
  s_add_u32 s56, s49, 509952
  buffer_load_dwordx4 v192, s[20:23], s56 offen lds
  v_mfma_f32_32x32x16_bf16 v[48:63], v[80:83], v[96:99], v[48:63]
  v_add_u32 v138, 110592, v130
  v_add_u32 v142, 110592, v134
  v_add_u32 v143, 110592, v135
  v_add_u32 v144, 110592, v136
  v_add_u32 v145, 110592, v137
  ds_read_b128 v[80:83], v138
  ds_read_b64_tr_b16 v[84:85], v142 offset:0
  ds_read_b64_tr_b16 v[86:87], v142 offset:1024
  ds_read_b64_tr_b16 v[88:89], v143 offset:0
  ds_read_b64_tr_b16 v[90:91], v143 offset:1024
  ds_read_b64_tr_b16 v[92:93], v144 offset:0
  ds_read_b64_tr_b16 v[94:95], v144 offset:1024
  ds_read_b64_tr_b16 v[96:97], v145 offset:0
  ds_read_b64_tr_b16 v[98:99], v145 offset:1024
  s_waitcnt lgkmcnt(9)
  v_mfma_f32_32x32x16_bf16 v[0:15], v[104:107], v[108:111], v[0:15]
  v_mfma_f32_32x32x16_bf16 v[16:31], v[104:107], v[112:115], v[16:31]
  v_mfma_f32_32x32x16_bf16 v[32:47], v[104:107], v[116:119], v[32:47]
  v_mfma_f32_32x32x16_bf16 v[48:63], v[104:107], v[120:123], v[48:63]
  v_add_u32 v138, 110592, v131
  ds_read_b128 v[104:107], v138
  ds_read_b64_tr_b16 v[108:109], v142 offset:4096
  ds_read_b64_tr_b16 v[110:111], v142 offset:5120
  ds_read_b64_tr_b16 v[112:113], v143 offset:4096
  ds_read_b64_tr_b16 v[114:115], v143 offset:5120
  ds_read_b64_tr_b16 v[116:117], v144 offset:4096
  ds_read_b64_tr_b16 v[118:119], v144 offset:5120
  ds_read_b64_tr_b16 v[120:121], v145 offset:4096
  ds_read_b64_tr_b16 v[122:123], v145 offset:5120
  s_waitcnt lgkmcnt(9)
  v_mfma_f32_32x32x16_bf16 v[0:15], v[80:83], v[84:87], v[0:15]
  v_mfma_f32_32x32x16_bf16 v[16:31], v[80:83], v[88:91], v[16:31]
  v_mfma_f32_32x32x16_bf16 v[32:47], v[80:83], v[92:95], v[32:47]
  v_mfma_f32_32x32x16_bf16 v[48:63], v[80:83], v[96:99], v[48:63]
  v_add_u32 v138, 110592, v132
  ds_read_b128 v[80:83], v138
  ds_read_b64_tr_b16 v[84:85], v142 offset:8192
  ds_read_b64_tr_b16 v[86:87], v142 offset:9216
  ds_read_b64_tr_b16 v[88:89], v143 offset:8192
  ds_read_b64_tr_b16 v[90:91], v143 offset:9216
  ds_read_b64_tr_b16 v[92:93], v144 offset:8192
  ds_read_b64_tr_b16 v[94:95], v144 offset:9216
  ds_read_b64_tr_b16 v[96:97], v145 offset:8192
  ds_read_b64_tr_b16 v[98:99], v145 offset:9216
  s_waitcnt lgkmcnt(9)
  v_mfma_f32_32x32x16_bf16 v[0:15], v[104:107], v[108:111], v[0:15]
  s_waitcnt vmcnt(8)
  s_barrier
  v_mfma_f32_32x32x16_bf16 v[16:31], v[104:107], v[112:115], v[16:31]
  s_add_u32 m0, s51, 73728
  s_add_u32 s56, s48, 768
  buffer_load_dwordx4 v190, s[16:19], s56 offen lds
  s_add_u32 m0, s51, 74752
  v_mfma_f32_32x32x16_bf16 v[32:47], v[104:107], v[116:119], v[32:47]
  s_add_u32 s56, s48, 37632
  buffer_load_dwordx4 v191, s[16:19], s56 offen lds
  s_add_u32 m0, s51, 75776
  s_add_u32 s56, s48, 74496
  v_mfma_f32_32x32x16_bf16 v[48:63], v[104:107], v[120:123], v[48:63]
  buffer_load_dwordx4 v190, s[16:19], s56 offen lds
  s_add_u32 m0, s51, 76800
  s_add_u32 s56, s48, 111360
  buffer_load_dwordx4 v191, s[16:19], s56 offen lds
  v_add_u32 v138, 110592, v133
  ds_read_b128 v[104:107], v138
  ds_read_b64_tr_b16 v[108:109], v142 offset:12288
  ds_read_b64_tr_b16 v[110:111], v142 offset:13312
  ds_read_b64_tr_b16 v[112:113], v143 offset:12288
  ds_read_b64_tr_b16 v[114:115], v143 offset:13312
  ds_read_b64_tr_b16 v[116:117], v144 offset:12288
  ds_read_b64_tr_b16 v[118:119], v144 offset:13312
  ds_read_b64_tr_b16 v[120:121], v145 offset:12288
  ds_read_b64_tr_b16 v[122:123], v145 offset:13312
  s_waitcnt lgkmcnt(9)
  v_mfma_f32_32x32x16_bf16 v[0:15], v[80:83], v[84:87], v[0:15]
  s_add_u32 m0, s52, 73728
  s_add_u32 s56, s49, 589824
  buffer_load_dwordx4 v192, s[20:23], s56 offen lds
  s_add_u32 m0, s52, 74752
  v_mfma_f32_32x32x16_bf16 v[16:31], v[80:83], v[88:91], v[16:31]
  s_add_u32 s56, s49, 595968
  buffer_load_dwordx4 v192, s[20:23], s56 offen lds
  s_add_u32 m0, s52, 75776
  s_add_u32 s56, s49, 602112
  v_mfma_f32_32x32x16_bf16 v[32:47], v[80:83], v[92:95], v[32:47]
  buffer_load_dwordx4 v192, s[20:23], s56 offen lds
  s_add_u32 m0, s52, 76800
  s_add_u32 s56, s49, 608256
  buffer_load_dwordx4 v192, s[20:23], s56 offen lds
  v_mfma_f32_32x32x16_bf16 v[48:63], v[80:83], v[96:99], v[48:63]
  v_add_u32 v138, 0, v130
  v_add_u32 v142, 0, v134
  v_add_u32 v143, 0, v135
  v_add_u32 v144, 0, v136
  v_add_u32 v145, 0, v137
  ds_read_b128 v[80:83], v138
  ds_read_b64_tr_b16 v[84:85], v142 offset:0
  ds_read_b64_tr_b16 v[86:87], v142 offset:1024
  ds_read_b64_tr_b16 v[88:89], v143 offset:0
  ds_read_b64_tr_b16 v[90:91], v143 offset:1024
  ds_read_b64_tr_b16 v[92:93], v144 offset:0
  ds_read_b64_tr_b16 v[94:95], v144 offset:1024
  ds_read_b64_tr_b16 v[96:97], v145 offset:0
  ds_read_b64_tr_b16 v[98:99], v145 offset:1024
  s_waitcnt lgkmcnt(9)
  v_mfma_f32_32x32x16_bf16 v[0:15], v[104:107], v[108:111], v[0:15]
  v_mfma_f32_32x32x16_bf16 v[16:31], v[104:107], v[112:115], v[16:31]
  v_mfma_f32_32x32x16_bf16 v[32:47], v[104:107], v[116:119], v[32:47]
  v_mfma_f32_32x32x16_bf16 v[48:63], v[104:107], v[120:123], v[48:63]
  v_add_u32 v138, 0, v131
  ds_read_b128 v[104:107], v138
  ds_read_b64_tr_b16 v[108:109], v142 offset:4096
  ds_read_b64_tr_b16 v[110:111], v142 offset:5120
  ds_read_b64_tr_b16 v[112:113], v143 offset:4096
  ds_read_b64_tr_b16 v[114:115], v143 offset:5120
  ds_read_b64_tr_b16 v[116:117], v144 offset:4096
  ds_read_b64_tr_b16 v[118:119], v144 offset:5120
  ds_read_b64_tr_b16 v[120:121], v145 offset:4096
  ds_read_b64_tr_b16 v[122:123], v145 offset:5120
  s_waitcnt lgkmcnt(9)
  v_mfma_f32_32x32x16_bf16 v[0:15], v[80:83], v[84:87], v[0:15]
  v_mfma_f32_32x32x16_bf16 v[16:31], v[80:83], v[88:91], v[16:31]
  v_mfma_f32_32x32x16_bf16 v[32:47], v[80:83], v[92:95], v[32:47]
  v_mfma_f32_32x32x16_bf16 v[48:63], v[80:83], v[96:99], v[48:63]
  v_add_u32 v138, 0, v132
  ds_read_b128 v[80:83], v138
  ds_read_b64_tr_b16 v[84:85], v142 offset:8192
  ds_read_b64_tr_b16 v[86:87], v142 offset:9216
  ds_read_b64_tr_b16 v[88:89], v143 offset:8192
  ds_read_b64_tr_b16 v[90:91], v143 offset:9216
  ds_read_b64_tr_b16 v[92:93], v144 offset:8192
  ds_read_b64_tr_b16 v[94:95], v144 offset:9216
  ds_read_b64_tr_b16 v[96:97], v145 offset:8192
  ds_read_b64_tr_b16 v[98:99], v145 offset:9216
  s_waitcnt lgkmcnt(9)
  v_mfma_f32_32x32x16_bf16 v[0:15], v[104:107], v[108:111], v[0:15]
  s_waitcnt vmcnt(8)
  s_barrier
  v_mfma_f32_32x32x16_bf16 v[16:31], v[104:107], v[112:115], v[16:31]
  s_add_u32 m0, s51, 110592
  s_add_u32 s56, s48, 896
  buffer_load_dwordx4 v190, s[16:19], s56 offen lds
  s_add_u32 m0, s51, 111616
  v_mfma_f32_32x32x16_bf16 v[32:47], v[104:107], v[116:119], v[32:47]
  s_add_u32 s56, s48, 37760
  buffer_load_dwordx4 v191, s[16:19], s56 offen lds
  s_add_u32 m0, s51, 112640
  s_add_u32 s56, s48, 74624
  v_mfma_f32_32x32x16_bf16 v[48:63], v[104:107], v[120:123], v[48:63]
  buffer_load_dwordx4 v190, s[16:19], s56 offen lds
  s_add_u32 m0, s51, 113664
  s_add_u32 s56, s48, 111488
  buffer_load_dwordx4 v191, s[16:19], s56 offen lds
  v_add_u32 v138, 0, v133
  ds_read_b128 v[104:107], v138
  ds_read_b64_tr_b16 v[108:109], v142 offset:12288
  ds_read_b64_tr_b16 v[110:111], v142 offset:13312
  ds_read_b64_tr_b16 v[112:113], v143 offset:12288
  ds_read_b64_tr_b16 v[114:115], v143 offset:13312
  ds_read_b64_tr_b16 v[116:117], v144 offset:12288
  ds_read_b64_tr_b16 v[118:119], v144 offset:13312
  ds_read_b64_tr_b16 v[120:121], v145 offset:12288
  ds_read_b64_tr_b16 v[122:123], v145 offset:13312
  s_waitcnt lgkmcnt(9)
  v_mfma_f32_32x32x16_bf16 v[0:15], v[80:83], v[84:87], v[0:15]
  s_add_u32 m0, s52, 110592
  s_add_u32 s56, s49, 688128
  buffer_load_dwordx4 v192, s[20:23], s56 offen lds
  s_add_u32 m0, s52, 111616
  v_mfma_f32_32x32x16_bf16 v[16:31], v[80:83], v[88:91], v[16:31]
  s_add_u32 s56, s49, 694272
  buffer_load_dwordx4 v192, s[20:23], s56 offen lds
  s_add_u32 m0, s52, 112640
  s_add_u32 s56, s49, 700416
  v_mfma_f32_32x32x16_bf16 v[32:47], v[80:83], v[92:95], v[32:47]
  buffer_load_dwordx4 v192, s[20:23], s56 offen lds
  s_add_u32 m0, s52, 113664
  s_add_u32 s56, s49, 706560
  buffer_load_dwordx4 v192, s[20:23], s56 offen lds
  v_mfma_f32_32x32x16_bf16 v[48:63], v[80:83], v[96:99], v[48:63]
  v_add_u32 v138, 36864, v130
  v_add_u32 v142, 36864, v134
  v_add_u32 v143, 36864, v135
  v_add_u32 v144, 36864, v136
  v_add_u32 v145, 36864, v137
  ds_read_b128 v[80:83], v138
  ds_read_b64_tr_b16 v[84:85], v142 offset:0
  ds_read_b64_tr_b16 v[86:87], v142 offset:1024
  ds_read_b64_tr_b16 v[88:89], v143 offset:0
  ds_read_b64_tr_b16 v[90:91], v143 offset:1024
  ds_read_b64_tr_b16 v[92:93], v144 offset:0
  ds_read_b64_tr_b16 v[94:95], v144 offset:1024
  ds_read_b64_tr_b16 v[96:97], v145 offset:0
  ds_read_b64_tr_b16 v[98:99], v145 offset:1024
  s_waitcnt lgkmcnt(9)
  v_mfma_f32_32x32x16_bf16 v[0:15], v[104:107], v[108:111], v[0:15]
  v_mfma_f32_32x32x16_bf16 v[16:31], v[104:107], v[112:115], v[16:31]
  v_mfma_f32_32x32x16_bf16 v[32:47], v[104:107], v[116:119], v[32:47]
  v_mfma_f32_32x32x16_bf16 v[48:63], v[104:107], v[120:123], v[48:63]
  v_add_u32 v138, 36864, v131
  ds_read_b128 v[104:107], v138
  ds_read_b64_tr_b16 v[108:109], v142 offset:4096
  ds_read_b64_tr_b16 v[110:111], v142 offset:5120
  ds_read_b64_tr_b16 v[112:113], v143 offset:4096
  ds_read_b64_tr_b16 v[114:115], v143 offset:5120
  ds_read_b64_tr_b16 v[116:117], v144 offset:4096
  ds_read_b64_tr_b16 v[118:119], v144 offset:5120
  ds_read_b64_tr_b16 v[120:121], v145 offset:4096
  ds_read_b64_tr_b16 v[122:123], v145 offset:5120
  s_waitcnt lgkmcnt(9)
  v_mfma_f32_32x32x16_bf16 v[0:15], v[80:83], v[84:87], v[0:15]
  v_mfma_f32_32x32x16_bf16 v[16:31], v[80:83], v[88:91], v[16:31]
  v_mfma_f32_32x32x16_bf16 v[32:47], v[80:83], v[92:95], v[32:47]
  v_mfma_f32_32x32x16_bf16 v[48:63], v[80:83], v[96:99], v[48:63]
  v_add_u32 v138, 36864, v132
  ds_read_b128 v[80:83], v138
  ds_read_b64_tr_b16 v[84:85], v142 offset:8192
  ds_read_b64_tr_b16 v[86:87], v142 offset:9216
  ds_read_b64_tr_b16 v[88:89], v143 offset:8192
  ds_read_b64_tr_b16 v[90:91], v143 offset:9216
  ds_read_b64_tr_b16 v[92:93], v144 offset:8192
  ds_read_b64_tr_b16 v[94:95], v144 offset:9216
  ds_read_b64_tr_b16 v[96:97], v145 offset:8192
  ds_read_b64_tr_b16 v[98:99], v145 offset:9216
  s_waitcnt lgkmcnt(9)
  v_mfma_f32_32x32x16_bf16 v[0:15], v[104:107], v[108:111], v[0:15]
  s_waitcnt vmcnt(8)
  s_barrier
  v_mfma_f32_32x32x16_bf16 v[16:31], v[104:107], v[112:115], v[16:31]
  s_add_u32 m0, s51, 0
  s_add_u32 s56, s48, 1024
  buffer_load_dwordx4 v190, s[16:19], s56 offen lds
  s_add_u32 m0, s51, 1024
  v_mfma_f32_32x32x16_bf16 v[32:47], v[104:107], v[116:119], v[32:47]
  s_add_u32 s56, s48, 37888
  buffer_load_dwordx4 v191, s[16:19], s56 offen lds
  s_add_u32 m0, s51, 2048
  s_add_u32 s56, s48, 74752
  v_mfma_f32_32x32x16_bf16 v[48:63], v[104:107], v[120:123], v[48:63]
  buffer_load_dwordx4 v190, s[16:19], s56 offen lds
  s_add_u32 m0, s51, 3072
  s_add_u32 s56, s48, 111616
  buffer_load_dwordx4 v191, s[16:19], s56 offen lds
  v_add_u32 v138, 36864, v133
  ds_read_b128 v[104:107], v138
  ds_read_b64_tr_b16 v[108:109], v142 offset:12288
  ds_read_b64_tr_b16 v[110:111], v142 offset:13312
  ds_read_b64_tr_b16 v[112:113], v143 offset:12288
  ds_read_b64_tr_b16 v[114:115], v143 offset:13312
  ds_read_b64_tr_b16 v[116:117], v144 offset:12288
  ds_read_b64_tr_b16 v[118:119], v144 offset:13312
  ds_read_b64_tr_b16 v[120:121], v145 offset:12288
  ds_read_b64_tr_b16 v[122:123], v145 offset:13312
  s_waitcnt lgkmcnt(9)
  v_mfma_f32_32x32x16_bf16 v[0:15], v[80:83], v[84:87], v[0:15]
  s_add_u32 m0, s52, 0
  s_add_u32 s56, s49, 786432
  buffer_load_dwordx4 v192, s[20:23], s56 offen lds
  s_add_u32 m0, s52, 1024
  v_mfma_f32_32x32x16_bf16 v[16:31], v[80:83], v[88:91], v[16:31]
  s_add_u32 s56, s49, 792576
  buffer_load_dwordx4 v192, s[20:23], s56 offen lds
  s_add_u32 m0, s52, 2048
  s_add_u32 s56, s49, 798720
  v_mfma_f32_32x32x16_bf16 v[32:47], v[80:83], v[92:95], v[32:47]
  buffer_load_dwordx4 v192, s[20:23], s56 offen lds
  s_add_u32 m0, s52, 3072
  s_add_u32 s56, s49, 804864
  buffer_load_dwordx4 v192, s[20:23], s56 offen lds
  v_mfma_f32_32x32x16_bf16 v[48:63], v[80:83], v[96:99], v[48:63]
  v_add_u32 v138, 73728, v130
  v_add_u32 v142, 73728, v134
  v_add_u32 v143, 73728, v135
  v_add_u32 v144, 73728, v136
  v_add_u32 v145, 73728, v137
  ds_read_b128 v[80:83], v138
  ds_read_b64_tr_b16 v[84:85], v142 offset:0
  ds_read_b64_tr_b16 v[86:87], v142 offset:1024
  ds_read_b64_tr_b16 v[88:89], v143 offset:0
  ds_read_b64_tr_b16 v[90:91], v143 offset:1024
  ds_read_b64_tr_b16 v[92:93], v144 offset:0
  ds_read_b64_tr_b16 v[94:95], v144 offset:1024
  ds_read_b64_tr_b16 v[96:97], v145 offset:0
  ds_read_b64_tr_b16 v[98:99], v145 offset:1024
  s_waitcnt lgkmcnt(9)
  v_mfma_f32_32x32x16_bf16 v[0:15], v[104:107], v[108:111], v[0:15]
  v_mfma_f32_32x32x16_bf16 v[16:31], v[104:107], v[112:115], v[16:31]
  v_mfma_f32_32x32x16_bf16 v[32:47], v[104:107], v[116:119], v[32:47]
  v_mfma_f32_32x32x16_bf16 v[48:63], v[104:107], v[120:123], v[48:63]
  v_add_u32 v138, 73728, v131
  ds_read_b128 v[104:107], v138
  ds_read_b64_tr_b16 v[108:109], v142 offset:4096
  ds_read_b64_tr_b16 v[110:111], v142 offset:5120
  ds_read_b64_tr_b16 v[112:113], v143 offset:4096
  ds_read_b64_tr_b16 v[114:115], v143 offset:5120
  ds_read_b64_tr_b16 v[116:117], v144 offset:4096
  ds_read_b64_tr_b16 v[118:119], v144 offset:5120
  ds_read_b64_tr_b16 v[120:121], v145 offset:4096
  ds_read_b64_tr_b16 v[122:123], v145 offset:5120
  s_waitcnt lgkmcnt(9)
  v_mfma_f32_32x32x16_bf16 v[0:15], v[80:83], v[84:87], v[0:15]
  v_mfma_f32_32x32x16_bf16 v[16:31], v[80:83], v[88:91], v[16:31]
  v_mfma_f32_32x32x16_bf16 v[32:47], v[80:83], v[92:95], v[32:47]
  v_mfma_f32_32x32x16_bf16 v[48:63], v[80:83], v[96:99], v[48:63]
  v_add_u32 v138, 73728, v132
  ds_read_b128 v[80:83], v138
  ds_read_b64_tr_b16 v[84:85], v142 offset:8192
  ds_read_b64_tr_b16 v[86:87], v142 offset:9216
  ds_read_b64_tr_b16 v[88:89], v143 offset:8192
  ds_read_b64_tr_b16 v[90:91], v143 offset:9216
  ds_read_b64_tr_b16 v[92:93], v144 offset:8192
  ds_read_b64_tr_b16 v[94:95], v144 offset:9216
  ds_read_b64_tr_b16 v[96:97], v145 offset:8192
  ds_read_b64_tr_b16 v[98:99], v145 offset:9216
  s_waitcnt lgkmcnt(9)
  v_mfma_f32_32x32x16_bf16 v[0:15], v[104:107], v[108:111], v[0:15]
  s_waitcnt vmcnt(8)
  s_barrier
  v_mfma_f32_32x32x16_bf16 v[16:31], v[104:107], v[112:115], v[16:31]
  s_add_u32 m0, s51, 36864
  s_add_u32 s56, s48, 1152
  buffer_load_dwordx4 v190, s[16:19], s56 offen lds
  s_add_u32 m0, s51, 37888
  v_mfma_f32_32x32x16_bf16 v[32:47], v[104:107], v[116:119], v[32:47]
  s_add_u32 s56, s48, 38016
  buffer_load_dwordx4 v191, s[16:19], s56 offen lds
  s_add_u32 m0, s51, 38912
  s_add_u32 s56, s48, 74880
  v_mfma_f32_32x32x16_bf16 v[48:63], v[104:107], v[120:123], v[48:63]
  buffer_load_dwordx4 v190, s[16:19], s56 offen lds
  s_add_u32 m0, s51, 39936
  s_add_u32 s56, s48, 111744
  buffer_load_dwordx4 v191, s[16:19], s56 offen lds
  v_add_u32 v138, 73728, v133
  ds_read_b128 v[104:107], v138
  ds_read_b64_tr_b16 v[108:109], v142 offset:12288
  ds_read_b64_tr_b16 v[110:111], v142 offset:13312
  ds_read_b64_tr_b16 v[112:113], v143 offset:12288
  ds_read_b64_tr_b16 v[114:115], v143 offset:13312
  ds_read_b64_tr_b16 v[116:117], v144 offset:12288
  ds_read_b64_tr_b16 v[118:119], v144 offset:13312
  ds_read_b64_tr_b16 v[120:121], v145 offset:12288
  ds_read_b64_tr_b16 v[122:123], v145 offset:13312
  s_waitcnt lgkmcnt(9)
  v_mfma_f32_32x32x16_bf16 v[0:15], v[80:83], v[84:87], v[0:15]
  s_add_u32 m0, s52, 36864
  s_add_u32 s56, s49, 884736
  buffer_load_dwordx4 v192, s[20:23], s56 offen lds
  s_add_u32 m0, s52, 37888
  v_mfma_f32_32x32x16_bf16 v[16:31], v[80:83], v[88:91], v[16:31]
  s_add_u32 s56, s49, 890880
  buffer_load_dwordx4 v192, s[20:23], s56 offen lds
  s_add_u32 m0, s52, 38912
  s_add_u32 s56, s49, 897024
  v_mfma_f32_32x32x16_bf16 v[32:47], v[80:83], v[92:95], v[32:47]
  buffer_load_dwordx4 v192, s[20:23], s56 offen lds
  s_add_u32 m0, s52, 39936
  s_add_u32 s56, s49, 903168
  buffer_load_dwordx4 v192, s[20:23], s56 offen lds
  v_mfma_f32_32x32x16_bf16 v[48:63], v[80:83], v[96:99], v[48:63]
  v_add_u32 v138, 110592, v130
  v_add_u32 v142, 110592, v134
  v_add_u32 v143, 110592, v135
  v_add_u32 v144, 110592, v136
  v_add_u32 v145, 110592, v137
  ds_read_b128 v[80:83], v138
  ds_read_b64_tr_b16 v[84:85], v142 offset:0
  ds_read_b64_tr_b16 v[86:87], v142 offset:1024
  ds_read_b64_tr_b16 v[88:89], v143 offset:0
  ds_read_b64_tr_b16 v[90:91], v143 offset:1024
  ds_read_b64_tr_b16 v[92:93], v144 offset:0
  ds_read_b64_tr_b16 v[94:95], v144 offset:1024
  ds_read_b64_tr_b16 v[96:97], v145 offset:0
  ds_read_b64_tr_b16 v[98:99], v145 offset:1024
  s_waitcnt lgkmcnt(9)
  v_mfma_f32_32x32x16_bf16 v[0:15], v[104:107], v[108:111], v[0:15]
  v_mfma_f32_32x32x16_bf16 v[16:31], v[104:107], v[112:115], v[16:31]
  v_mfma_f32_32x32x16_bf16 v[32:47], v[104:107], v[116:119], v[32:47]
  v_mfma_f32_32x32x16_bf16 v[48:63], v[104:107], v[120:123], v[48:63]
  v_add_u32 v138, 110592, v131
  ds_read_b128 v[104:107], v138
  ds_read_b64_tr_b16 v[108:109], v142 offset:4096
  ds_read_b64_tr_b16 v[110:111], v142 offset:5120
  ds_read_b64_tr_b16 v[112:113], v143 offset:4096
  ds_read_b64_tr_b16 v[114:115], v143 offset:5120
  ds_read_b64_tr_b16 v[116:117], v144 offset:4096
  ds_read_b64_tr_b16 v[118:119], v144 offset:5120
  ds_read_b64_tr_b16 v[120:121], v145 offset:4096
  ds_read_b64_tr_b16 v[122:123], v145 offset:5120
  s_waitcnt lgkmcnt(9)
  v_mfma_f32_32x32x16_bf16 v[0:15], v[80:83], v[84:87], v[0:15]
  v_mfma_f32_32x32x16_bf16 v[16:31], v[80:83], v[88:91], v[16:31]
  v_mfma_f32_32x32x16_bf16 v[32:47], v[80:83], v[92:95], v[32:47]
  v_mfma_f32_32x32x16_bf16 v[48:63], v[80:83], v[96:99], v[48:63]
  v_add_u32 v138, 110592, v132
  ds_read_b128 v[80:83], v138
  ds_read_b64_tr_b16 v[84:85], v142 offset:8192
  ds_read_b64_tr_b16 v[86:87], v142 offset:9216
  ds_read_b64_tr_b16 v[88:89], v143 offset:8192
  ds_read_b64_tr_b16 v[90:91], v143 offset:9216
  ds_read_b64_tr_b16 v[92:93], v144 offset:8192
  ds_read_b64_tr_b16 v[94:95], v144 offset:9216
  ds_read_b64_tr_b16 v[96:97], v145 offset:8192
  ds_read_b64_tr_b16 v[98:99], v145 offset:9216
  s_waitcnt lgkmcnt(9)
  v_mfma_f32_32x32x16_bf16 v[0:15], v[104:107], v[108:111], v[0:15]
  s_waitcnt vmcnt(8)
  s_barrier
  v_mfma_f32_32x32x16_bf16 v[16:31], v[104:107], v[112:115], v[16:31]
  s_add_u32 m0, s51, 73728
  s_add_u32 s56, s48, 1280
  buffer_load_dwordx4 v190, s[16:19], s56 offen lds
  s_add_u32 m0, s51, 74752
  v_mfma_f32_32x32x16_bf16 v[32:47], v[104:107], v[116:119], v[32:47]
  s_add_u32 s56, s48, 38144
  buffer_load_dwordx4 v191, s[16:19], s56 offen lds
  s_add_u32 m0, s51, 75776
  s_add_u32 s56, s48, 75008
  v_mfma_f32_32x32x16_bf16 v[48:63], v[104:107], v[120:123], v[48:63]
  buffer_load_dwordx4 v190, s[16:19], s56 offen lds
  s_add_u32 m0, s51, 76800
  s_add_u32 s56, s48, 111872
  buffer_load_dwordx4 v191, s[16:19], s56 offen lds
  v_add_u32 v138, 110592, v133
  ds_read_b128 v[104:107], v138
  ds_read_b64_tr_b16 v[108:109], v142 offset:12288
  ds_read_b64_tr_b16 v[110:111], v142 offset:13312
  ds_read_b64_tr_b16 v[112:113], v143 offset:12288
  ds_read_b64_tr_b16 v[114:115], v143 offset:13312
  ds_read_b64_tr_b16 v[116:117], v144 offset:12288
  ds_read_b64_tr_b16 v[118:119], v144 offset:13312
  ds_read_b64_tr_b16 v[120:121], v145 offset:12288
  ds_read_b64_tr_b16 v[122:123], v145 offset:13312
  s_waitcnt lgkmcnt(9)
  v_mfma_f32_32x32x16_bf16 v[0:15], v[80:83], v[84:87], v[0:15]
  s_add_u32 m0, s52, 73728
  s_add_u32 s56, s49, 983040
  buffer_load_dwordx4 v192, s[20:23], s56 offen lds
  s_add_u32 m0, s52, 74752
  v_mfma_f32_32x32x16_bf16 v[16:31], v[80:83], v[88:91], v[16:31]
  s_add_u32 s56, s49, 989184
  buffer_load_dwordx4 v192, s[20:23], s56 offen lds
  s_add_u32 m0, s52, 75776
  s_add_u32 s56, s49, 995328
  v_mfma_f32_32x32x16_bf16 v[32:47], v[80:83], v[92:95], v[32:47]
  buffer_load_dwordx4 v192, s[20:23], s56 offen lds
  s_add_u32 m0, s52, 76800
  s_add_u32 s56, s49, 1001472
  buffer_load_dwordx4 v192, s[20:23], s56 offen lds
  v_mfma_f32_32x32x16_bf16 v[48:63], v[80:83], v[96:99], v[48:63]
  v_add_u32 v138, 0, v130
  v_add_u32 v142, 0, v134
  v_add_u32 v143, 0, v135
  v_add_u32 v144, 0, v136
  v_add_u32 v145, 0, v137
  ds_read_b128 v[80:83], v138
  ds_read_b64_tr_b16 v[84:85], v142 offset:0
  ds_read_b64_tr_b16 v[86:87], v142 offset:1024
  ds_read_b64_tr_b16 v[88:89], v143 offset:0
  ds_read_b64_tr_b16 v[90:91], v143 offset:1024
  ds_read_b64_tr_b16 v[92:93], v144 offset:0
  ds_read_b64_tr_b16 v[94:95], v144 offset:1024
  ds_read_b64_tr_b16 v[96:97], v145 offset:0
  ds_read_b64_tr_b16 v[98:99], v145 offset:1024
  s_waitcnt lgkmcnt(9)
  v_mfma_f32_32x32x16_bf16 v[0:15], v[104:107], v[108:111], v[0:15]
  v_mfma_f32_32x32x16_bf16 v[16:31], v[104:107], v[112:115], v[16:31]
  v_mfma_f32_32x32x16_bf16 v[32:47], v[104:107], v[116:119], v[32:47]
  v_mfma_f32_32x32x16_bf16 v[48:63], v[104:107], v[120:123], v[48:63]
  v_add_u32 v138, 0, v131
  ds_read_b128 v[104:107], v138
  ds_read_b64_tr_b16 v[108:109], v142 offset:4096
  ds_read_b64_tr_b16 v[110:111], v142 offset:5120
  ds_read_b64_tr_b16 v[112:113], v143 offset:4096
  ds_read_b64_tr_b16 v[114:115], v143 offset:5120
  ds_read_b64_tr_b16 v[116:117], v144 offset:4096
  ds_read_b64_tr_b16 v[118:119], v144 offset:5120
  ds_read_b64_tr_b16 v[120:121], v145 offset:4096
  ds_read_b64_tr_b16 v[122:123], v145 offset:5120
  s_waitcnt lgkmcnt(9)
  v_mfma_f32_32x32x16_bf16 v[0:15], v[80:83], v[84:87], v[0:15]
  v_mfma_f32_32x32x16_bf16 v[16:31], v[80:83], v[88:91], v[16:31]
  v_mfma_f32_32x32x16_bf16 v[32:47], v[80:83], v[92:95], v[32:47]
  v_mfma_f32_32x32x16_bf16 v[48:63], v[80:83], v[96:99], v[48:63]
  v_add_u32 v138, 0, v132
  ds_read_b128 v[80:83], v138
  ds_read_b64_tr_b16 v[84:85], v142 offset:8192
  ds_read_b64_tr_b16 v[86:87], v142 offset:9216
  ds_read_b64_tr_b16 v[88:89], v143 offset:8192
  ds_read_b64_tr_b16 v[90:91], v143 offset:9216
  ds_read_b64_tr_b16 v[92:93], v144 offset:8192
  ds_read_b64_tr_b16 v[94:95], v144 offset:9216
  ds_read_b64_tr_b16 v[96:97], v145 offset:8192
  ds_read_b64_tr_b16 v[98:99], v145 offset:9216
  s_waitcnt lgkmcnt(9)
  v_mfma_f32_32x32x16_bf16 v[0:15], v[104:107], v[108:111], v[0:15]
  s_waitcnt vmcnt(8)
  s_barrier
  v_mfma_f32_32x32x16_bf16 v[16:31], v[104:107], v[112:115], v[16:31]
  s_add_u32 m0, s51, 110592
  s_add_u32 s56, s48, 1408
  buffer_load_dwordx4 v190, s[16:19], s56 offen lds
  s_add_u32 m0, s51, 111616
  v_mfma_f32_32x32x16_bf16 v[32:47], v[104:107], v[116:119], v[32:47]
  s_add_u32 s56, s48, 38272
  buffer_load_dwordx4 v191, s[16:19], s56 offen lds
  s_add_u32 m0, s51, 112640
  s_add_u32 s56, s48, 75136
  v_mfma_f32_32x32x16_bf16 v[48:63], v[104:107], v[120:123], v[48:63]
  buffer_load_dwordx4 v190, s[16:19], s56 offen lds
  s_add_u32 m0, s51, 113664
  s_add_u32 s56, s48, 112000
  buffer_load_dwordx4 v191, s[16:19], s56 offen lds
  v_add_u32 v138, 0, v133
  ds_read_b128 v[104:107], v138
  ds_read_b64_tr_b16 v[108:109], v142 offset:12288
  ds_read_b64_tr_b16 v[110:111], v142 offset:13312
  ds_read_b64_tr_b16 v[112:113], v143 offset:12288
  ds_read_b64_tr_b16 v[114:115], v143 offset:13312
  ds_read_b64_tr_b16 v[116:117], v144 offset:12288
  ds_read_b64_tr_b16 v[118:119], v144 offset:13312
  ds_read_b64_tr_b16 v[120:121], v145 offset:12288
  ds_read_b64_tr_b16 v[122:123], v145 offset:13312
  s_waitcnt lgkmcnt(9)
  v_mfma_f32_32x32x16_bf16 v[0:15], v[80:83], v[84:87], v[0:15]
  s_add_u32 m0, s52, 110592
  s_add_u32 s56, s49, 1081344
  buffer_load_dwordx4 v192, s[20:23], s56 offen lds
  s_add_u32 m0, s52, 111616
  v_mfma_f32_32x32x16_bf16 v[16:31], v[80:83], v[88:91], v[16:31]
  s_add_u32 s56, s49, 1087488
  buffer_load_dwordx4 v192, s[20:23], s56 offen lds
  s_add_u32 m0, s52, 112640
  s_add_u32 s56, s49, 1093632
  v_mfma_f32_32x32x16_bf16 v[32:47], v[80:83], v[92:95], v[32:47]
  buffer_load_dwordx4 v192, s[20:23], s56 offen lds
  s_add_u32 m0, s52, 113664
  s_add_u32 s56, s49, 1099776
  buffer_load_dwordx4 v192, s[20:23], s56 offen lds
  v_mfma_f32_32x32x16_bf16 v[48:63], v[80:83], v[96:99], v[48:63]
  v_add_u32 v138, 36864, v130
  v_add_u32 v142, 36864, v134
  v_add_u32 v143, 36864, v135
  v_add_u32 v144, 36864, v136
  v_add_u32 v145, 36864, v137
  ds_read_b128 v[80:83], v138
  ds_read_b64_tr_b16 v[84:85], v142 offset:0
  ds_read_b64_tr_b16 v[86:87], v142 offset:1024
  ds_read_b64_tr_b16 v[88:89], v143 offset:0
  ds_read_b64_tr_b16 v[90:91], v143 offset:1024
  ds_read_b64_tr_b16 v[92:93], v144 offset:0
  ds_read_b64_tr_b16 v[94:95], v144 offset:1024
  ds_read_b64_tr_b16 v[96:97], v145 offset:0
  ds_read_b64_tr_b16 v[98:99], v145 offset:1024
  s_waitcnt lgkmcnt(9)
  v_mfma_f32_32x32x16_bf16 v[0:15], v[104:107], v[108:111], v[0:15]
  v_mfma_f32_32x32x16_bf16 v[16:31], v[104:107], v[112:115], v[16:31]
  v_mfma_f32_32x32x16_bf16 v[32:47], v[104:107], v[116:119], v[32:47]
  v_mfma_f32_32x32x16_bf16 v[48:63], v[104:107], v[120:123], v[48:63]
  v_add_u32 v138, 36864, v131
  ds_read_b128 v[104:107], v138
  ds_read_b64_tr_b16 v[108:109], v142 offset:4096
  ds_read_b64_tr_b16 v[110:111], v142 offset:5120
  ds_read_b64_tr_b16 v[112:113], v143 offset:4096
  ds_read_b64_tr_b16 v[114:115], v143 offset:5120
  ds_read_b64_tr_b16 v[116:117], v144 offset:4096
  ds_read_b64_tr_b16 v[118:119], v144 offset:5120
  ds_read_b64_tr_b16 v[120:121], v145 offset:4096
  ds_read_b64_tr_b16 v[122:123], v145 offset:5120
  s_waitcnt lgkmcnt(9)
  v_mfma_f32_32x32x16_bf16 v[0:15], v[80:83], v[84:87], v[0:15]
  v_mfma_f32_32x32x16_bf16 v[16:31], v[80:83], v[88:91], v[16:31]
  v_mfma_f32_32x32x16_bf16 v[32:47], v[80:83], v[92:95], v[32:47]
  v_mfma_f32_32x32x16_bf16 v[48:63], v[80:83], v[96:99], v[48:63]
  v_add_u32 v138, 36864, v132
  ds_read_b128 v[80:83], v138
  ds_read_b64_tr_b16 v[84:85], v142 offset:8192
  ds_read_b64_tr_b16 v[86:87], v142 offset:9216
  ds_read_b64_tr_b16 v[88:89], v143 offset:8192
  ds_read_b64_tr_b16 v[90:91], v143 offset:9216
  ds_read_b64_tr_b16 v[92:93], v144 offset:8192
  ds_read_b64_tr_b16 v[94:95], v144 offset:9216
  ds_read_b64_tr_b16 v[96:97], v145 offset:8192
  ds_read_b64_tr_b16 v[98:99], v145 offset:9216
  s_waitcnt lgkmcnt(9)
  v_mfma_f32_32x32x16_bf16 v[0:15], v[104:107], v[108:111], v[0:15]
  s_waitcnt vmcnt(8)
  s_barrier
  v_mfma_f32_32x32x16_bf16 v[16:31], v[104:107], v[112:115], v[16:31]
  v_mfma_f32_32x32x16_bf16 v[32:47], v[104:107], v[116:119], v[32:47]
  v_mfma_f32_32x32x16_bf16 v[48:63], v[104:107], v[120:123], v[48:63]
  v_add_u32 v138, 36864, v133
  ds_read_b128 v[104:107], v138
  ds_read_b64_tr_b16 v[108:109], v142 offset:12288
  ds_read_b64_tr_b16 v[110:111], v142 offset:13312
  ds_read_b64_tr_b16 v[112:113], v143 offset:12288
  ds_read_b64_tr_b16 v[114:115], v143 offset:13312
  ds_read_b64_tr_b16 v[116:117], v144 offset:12288
  ds_read_b64_tr_b16 v[118:119], v144 offset:13312
  ds_read_b64_tr_b16 v[120:121], v145 offset:12288
  ds_read_b64_tr_b16 v[122:123], v145 offset:13312
  s_waitcnt lgkmcnt(9)
  v_mfma_f32_32x32x16_bf16 v[0:15], v[80:83], v[84:87], v[0:15]
  v_mfma_f32_32x32x16_bf16 v[16:31], v[80:83], v[88:91], v[16:31]
  v_mfma_f32_32x32x16_bf16 v[32:47], v[80:83], v[92:95], v[32:47]
  v_mfma_f32_32x32x16_bf16 v[48:63], v[80:83], v[96:99], v[48:63]
  v_add_u32 v138, 73728, v130
  v_add_u32 v142, 73728, v134
  v_add_u32 v143, 73728, v135
  v_add_u32 v144, 73728, v136
  v_add_u32 v145, 73728, v137
  ds_read_b128 v[80:83], v138
  ds_read_b64_tr_b16 v[84:85], v142 offset:0
  ds_read_b64_tr_b16 v[86:87], v142 offset:1024
  ds_read_b64_tr_b16 v[88:89], v143 offset:0
  ds_read_b64_tr_b16 v[90:91], v143 offset:1024
  ds_read_b64_tr_b16 v[92:93], v144 offset:0
  ds_read_b64_tr_b16 v[94:95], v144 offset:1024
  ds_read_b64_tr_b16 v[96:97], v145 offset:0
  ds_read_b64_tr_b16 v[98:99], v145 offset:1024
  s_waitcnt lgkmcnt(9)
  v_mfma_f32_32x32x16_bf16 v[0:15], v[104:107], v[108:111], v[0:15]
  v_mfma_f32_32x32x16_bf16 v[16:31], v[104:107], v[112:115], v[16:31]
  v_mfma_f32_32x32x16_bf16 v[32:47], v[104:107], v[116:119], v[32:47]
  v_mfma_f32_32x32x16_bf16 v[48:63], v[104:107], v[120:123], v[48:63]
  v_add_u32 v138, 73728, v131
  ds_read_b128 v[104:107], v138
  ds_read_b64_tr_b16 v[108:109], v142 offset:4096
  ds_read_b64_tr_b16 v[110:111], v142 offset:5120
  ds_read_b64_tr_b16 v[112:113], v143 offset:4096
  ds_read_b64_tr_b16 v[114:115], v143 offset:5120
  ds_read_b64_tr_b16 v[116:117], v144 offset:4096
  ds_read_b64_tr_b16 v[118:119], v144 offset:5120
  ds_read_b64_tr_b16 v[120:121], v145 offset:4096
  ds_read_b64_tr_b16 v[122:123], v145 offset:5120
  s_waitcnt lgkmcnt(9)
  v_mfma_f32_32x32x16_bf16 v[0:15], v[80:83], v[84:87], v[0:15]
  v_mfma_f32_32x32x16_bf16 v[16:31], v[80:83], v[88:91], v[16:31]
  v_mfma_f32_32x32x16_bf16 v[32:47], v[80:83], v[92:95], v[32:47]
  v_mfma_f32_32x32x16_bf16 v[48:63], v[80:83], v[96:99], v[48:63]
  v_add_u32 v138, 73728, v132
  ds_read_b128 v[80:83], v138
  ds_read_b64_tr_b16 v[84:85], v142 offset:8192
  ds_read_b64_tr_b16 v[86:87], v142 offset:9216
  ds_read_b64_tr_b16 v[88:89], v143 offset:8192
  ds_read_b64_tr_b16 v[90:91], v143 offset:9216
  ds_read_b64_tr_b16 v[92:93], v144 offset:8192
  ds_read_b64_tr_b16 v[94:95], v144 offset:9216
  ds_read_b64_tr_b16 v[96:97], v145 offset:8192
  ds_read_b64_tr_b16 v[98:99], v145 offset:9216
  s_waitcnt lgkmcnt(9)
  v_mfma_f32_32x32x16_bf16 v[0:15], v[104:107], v[108:111], v[0:15]
  s_waitcnt vmcnt(0)
  s_barrier
  v_mfma_f32_32x32x16_bf16 v[16:31], v[104:107], v[112:115], v[16:31]
  v_mfma_f32_32x32x16_bf16 v[32:47], v[104:107], v[116:119], v[32:47]
  v_mfma_f32_32x32x16_bf16 v[48:63], v[104:107], v[120:123], v[48:63]
  v_add_u32 v138, 73728, v133
  ds_read_b128 v[104:107], v138
  ds_read_b64_tr_b16 v[108:109], v142 offset:12288
  ds_read_b64_tr_b16 v[110:111], v142 offset:13312
  ds_read_b64_tr_b16 v[112:113], v143 offset:12288
  ds_read_b64_tr_b16 v[114:115], v143 offset:13312
  ds_read_b64_tr_b16 v[116:117], v144 offset:12288
  ds_read_b64_tr_b16 v[118:119], v144 offset:13312
  ds_read_b64_tr_b16 v[120:121], v145 offset:12288
  ds_read_b64_tr_b16 v[122:123], v145 offset:13312
  s_waitcnt lgkmcnt(9)
  v_mfma_f32_32x32x16_bf16 v[0:15], v[80:83], v[84:87], v[0:15]
  v_mfma_f32_32x32x16_bf16 v[16:31], v[80:83], v[88:91], v[16:31]
  v_mfma_f32_32x32x16_bf16 v[32:47], v[80:83], v[92:95], v[32:47]
  v_mfma_f32_32x32x16_bf16 v[48:63], v[80:83], v[96:99], v[48:63]
  v_add_u32 v138, 110592, v130
  v_add_u32 v142, 110592, v134
  v_add_u32 v143, 110592, v135
  v_add_u32 v144, 110592, v136
  v_add_u32 v145, 110592, v137
  ds_read_b128 v[80:83], v138
  ds_read_b64_tr_b16 v[84:85], v142 offset:0
  ds_read_b64_tr_b16 v[86:87], v142 offset:1024
  ds_read_b64_tr_b16 v[88:89], v143 offset:0
  ds_read_b64_tr_b16 v[90:91], v143 offset:1024
  ds_read_b64_tr_b16 v[92:93], v144 offset:0
  ds_read_b64_tr_b16 v[94:95], v144 offset:1024
  ds_read_b64_tr_b16 v[96:97], v145 offset:0
  ds_read_b64_tr_b16 v[98:99], v145 offset:1024
  s_waitcnt lgkmcnt(9)
  v_mfma_f32_32x32x16_bf16 v[0:15], v[104:107], v[108:111], v[0:15]
  v_mfma_f32_32x32x16_bf16 v[16:31], v[104:107], v[112:115], v[16:31]
  v_mfma_f32_32x32x16_bf16 v[32:47], v[104:107], v[116:119], v[32:47]
  v_mfma_f32_32x32x16_bf16 v[48:63], v[104:107], v[120:123], v[48:63]
  v_add_u32 v138, 110592, v131
  ds_read_b128 v[104:107], v138
  ds_read_b64_tr_b16 v[108:109], v142 offset:4096
  ds_read_b64_tr_b16 v[110:111], v142 offset:5120
  ds_read_b64_tr_b16 v[112:113], v143 offset:4096
  ds_read_b64_tr_b16 v[114:115], v143 offset:5120
  ds_read_b64_tr_b16 v[116:117], v144 offset:4096
  ds_read_b64_tr_b16 v[118:119], v144 offset:5120
  ds_read_b64_tr_b16 v[120:121], v145 offset:4096
  ds_read_b64_tr_b16 v[122:123], v145 offset:5120
  s_waitcnt lgkmcnt(9)
  v_mfma_f32_32x32x16_bf16 v[0:15], v[80:83], v[84:87], v[0:15]
  v_mfma_f32_32x32x16_bf16 v[16:31], v[80:83], v[88:91], v[16:31]
  v_mfma_f32_32x32x16_bf16 v[32:47], v[80:83], v[92:95], v[32:47]
  v_mfma_f32_32x32x16_bf16 v[48:63], v[80:83], v[96:99], v[48:63]
  v_add_u32 v138, 110592, v132
  ds_read_b128 v[80:83], v138
  ds_read_b64_tr_b16 v[84:85], v142 offset:8192
  ds_read_b64_tr_b16 v[86:87], v142 offset:9216
  ds_read_b64_tr_b16 v[88:89], v143 offset:8192
  ds_read_b64_tr_b16 v[90:91], v143 offset:9216
  ds_read_b64_tr_b16 v[92:93], v144 offset:8192
  ds_read_b64_tr_b16 v[94:95], v144 offset:9216
  ds_read_b64_tr_b16 v[96:97], v145 offset:8192
  ds_read_b64_tr_b16 v[98:99], v145 offset:9216
  s_waitcnt lgkmcnt(9)
  v_mfma_f32_32x32x16_bf16 v[0:15], v[104:107], v[108:111], v[0:15]
  v_mfma_f32_32x32x16_bf16 v[16:31], v[104:107], v[112:115], v[16:31]
  v_mfma_f32_32x32x16_bf16 v[32:47], v[104:107], v[116:119], v[32:47]
  v_mfma_f32_32x32x16_bf16 v[48:63], v[104:107], v[120:123], v[48:63]
  v_add_u32 v138, 110592, v133
  ds_read_b128 v[104:107], v138
  ds_read_b64_tr_b16 v[108:109], v142 offset:12288
  ds_read_b64_tr_b16 v[110:111], v142 offset:13312
  ds_read_b64_tr_b16 v[112:113], v143 offset:12288
  ds_read_b64_tr_b16 v[114:115], v143 offset:13312
  ds_read_b64_tr_b16 v[116:117], v144 offset:12288
  ds_read_b64_tr_b16 v[118:119], v144 offset:13312
  ds_read_b64_tr_b16 v[120:121], v145 offset:12288
  ds_read_b64_tr_b16 v[122:123], v145 offset:13312
  s_waitcnt lgkmcnt(9)
  v_mfma_f32_32x32x16_bf16 v[0:15], v[80:83], v[84:87], v[0:15]
  v_mfma_f32_32x32x16_bf16 v[16:31], v[80:83], v[88:91], v[16:31]
  v_mfma_f32_32x32x16_bf16 v[32:47], v[80:83], v[92:95], v[32:47]
  v_mfma_f32_32x32x16_bf16 v[48:63], v[80:83], v[96:99], v[48:63]
  s_waitcnt lgkmcnt(0)
  v_mfma_f32_32x32x16_bf16 v[0:15], v[104:107], v[108:111], v[0:15]
  v_mfma_f32_32x32x16_bf16 v[16:31], v[104:107], v[112:115], v[16:31]
  v_mfma_f32_32x32x16_bf16 v[32:47], v[104:107], v[116:119], v[32:47]
  v_mfma_f32_32x32x16_bf16 v[48:63], v[104:107], v[120:123], v[48:63]
  s_nop 15
  s_nop 7
  s_cmp_eq_u32 s42, 0
  s_cbranch_scc1 K3_end
  s_mul_i32 s54, s43, 768
  s_lshl_b32 s55, s45, 7
  s_add_u32 s54, s54, s55
  v_add_u32 v204, s54, v202
  v_mul_u32_u24 v205, 2176, v204
  v_lshl_add_u32 v205, v203, 4, v205
  s_lshl_b32 s54, s44, 1

  v_cvt_pk_bf16_f32 v80, v0, v1
  v_cvt_pk_bf16_f32 v81, v2, v3
  v_cvt_pk_bf16_f32 v82, v4, v5
  v_cvt_pk_bf16_f32 v83, v6, v7
  s_add_u32 s55, s54, 0
  buffer_store_dwordx4 v[80:83], v205, s[24:27], s55 offen

  v_cvt_pk_bf16_f32 v84, v8, v9
  v_cvt_pk_bf16_f32 v85, v10, v11
  v_cvt_pk_bf16_f32 v86, v12, v13
  v_cvt_pk_bf16_f32 v87, v14, v15
  s_add_u32 s55, s54, 32
  buffer_store_dwordx4 v[84:87], v205, s[24:27], s55 offen

  v_cvt_pk_bf16_f32 v88, v16, v17
  v_cvt_pk_bf16_f32 v89, v18, v19
  v_cvt_pk_bf16_f32 v90, v20, v21
  v_cvt_pk_bf16_f32 v91, v22, v23
  s_add_u32 s55, s54, 69632
  buffer_store_dwordx4 v[88:91], v205, s[24:27], s55 offen

  v_cvt_pk_bf16_f32 v92, v24, v25
  v_cvt_pk_bf16_f32 v93, v26, v27
  v_cvt_pk_bf16_f32 v94, v28, v29
  v_cvt_pk_bf16_f32 v95, v30, v31
  s_add_u32 s55, s54, 69664
  buffer_store_dwordx4 v[92:95], v205, s[24:27], s55 offen

  v_cvt_pk_bf16_f32 v96, v32, v33
  v_cvt_pk_bf16_f32 v97, v34, v35
  v_cvt_pk_bf16_f32 v98, v36, v37
  v_cvt_pk_bf16_f32 v99, v38, v39
  s_add_u32 s55, s54, 139264
  buffer_store_dwordx4 v[96:99], v205, s[24:27], s55 offen

  v_cvt_pk_bf16_f32 v100, v40, v41
  v_cvt_pk_bf16_f32 v101, v42, v43
  v_cvt_pk_bf16_f32 v102, v44, v45
  v_cvt_pk_bf16_f32 v103, v46, v47
  s_add_u32 s55, s54, 139296
  buffer_store_dwordx4 v[100:103], v205, s[24:27], s55 offen

  v_cvt_pk_bf16_f32 v104, v48, v49
  v_cvt_pk_bf16_f32 v105, v50, v51
  v_cvt_pk_bf16_f32 v106, v52, v53
  v_cvt_pk_bf16_f32 v107, v54, v55
  s_add_u32 s55, s54, 208896
  buffer_store_dwordx4 v[104:107], v205, s[24:27], s55 offen

  v_cvt_pk_bf16_f32 v108, v56, v57
  v_cvt_pk_bf16_f32 v109, v58, v59
  v_cvt_pk_bf16_f32 v110, v60, v61
  v_cvt_pk_bf16_f32 v111, v62, v63
  s_add_u32 s55, s54, 208928
  buffer_store_dwordx4 v[108:111], v205, s[24:27], s55 offen

  s_endpgm
K3_gate:
  s_waitcnt lgkmcnt(0)
  s_mov_b32 s16, s12
  s_mov_b32 s17, s13
  s_mov_b32 s18, 1048576
  s_mov_b32 s19, 0x00020000
  v_lshrrev_b32 v1, 6, v0
  v_and_b32 v2, 63, v0
  v_mul_u32_u24 v2, 12, v2
  v_lshrrev_b32 v3, 1, v1
  v_and_b32 v4, 1, v1
  v_mul_u32_u24 v5, 4608, v4
  v_mul_u32_u24 v6, 2304, v3
  v_add3_u32 v5, v5, v6, v2
  v_add_u32 v5, 1536, v5
  v_lshlrev_b32 v5, 2, v5
  s_mov_b32 s20, 36864
  s_mov_b32 s21, 73728

  buffer_load_dwordx4 v[8:11], v5, s[16:19], 0 offen offset:0
  buffer_load_dwordx4 v[12:15], v5, s[16:19], 0 offen offset:16
  buffer_load_dwordx4 v[16:19], v5, s[16:19], 0 offen offset:32
  buffer_load_dwordx4 v[20:23], v5, s[16:19], s20 offen offset:0
  buffer_load_dwordx4 v[24:27], v5, s[16:19], s20 offen offset:16
  buffer_load_dwordx4 v[28:31], v5, s[16:19], s20 offen offset:32
  buffer_load_dwordx4 v[32:35], v5, s[16:19], s21 offen offset:0
  buffer_load_dwordx4 v[36:39], v5, s[16:19], s21 offen offset:16
  buffer_load_dwordx4 v[40:43], v5, s[16:19], s21 offen offset:32
  s_waitcnt vmcnt(0)
  v_add_f32 v8, v8, v20
  v_add_f32 v8, v8, v32
  v_add_f32 v9, v9, v21
  v_add_f32 v9, v9, v33
  v_add_f32 v10, v10, v22
  v_add_f32 v10, v10, v34
  v_add_f32 v11, v11, v23
  v_add_f32 v11, v11, v35
  v_add_f32 v12, v12, v24
  v_add_f32 v12, v12, v36
  v_add_f32 v13, v13, v25
  v_add_f32 v13, v13, v37
  v_add_f32 v14, v14, v26
  v_add_f32 v14, v14, v38
  v_add_f32 v15, v15, v27
  v_add_f32 v15, v15, v39
  v_add_f32 v16, v16, v28
  v_add_f32 v16, v16, v40
  v_add_f32 v17, v17, v29
  v_add_f32 v17, v17, v41
  v_add_f32 v18, v18, v30
  v_add_f32 v18, v18, v42
  v_add_f32 v19, v19, v31
  v_add_f32 v19, v19, v43
  v_cvt_pk_bf16_f32 v20, v8, v9
  v_lshlrev_b32 v8, 16, v20
  v_and_b32 v9, 0xffff0000, v20
  v_cvt_pk_bf16_f32 v20, v10, v11
  v_lshlrev_b32 v10, 16, v20
  v_and_b32 v11, 0xffff0000, v20
  v_cvt_pk_bf16_f32 v20, v12, v13
  v_lshlrev_b32 v12, 16, v20
  v_and_b32 v13, 0xffff0000, v20
  v_cvt_pk_bf16_f32 v20, v14, v15
  v_lshlrev_b32 v14, 16, v20
  v_and_b32 v15, 0xffff0000, v20
  v_cvt_pk_bf16_f32 v20, v16, v17
  v_lshlrev_b32 v16, 16, v20
  v_and_b32 v17, 0xffff0000, v20
  v_cvt_pk_bf16_f32 v20, v18, v19
  v_lshlrev_b32 v18, 16, v20
  v_and_b32 v19, 0xffff0000, v20
  v_mul_u32_u24 v5, 768, v1
  v_add_u32 v5, v5, v2
  v_lshlrev_b32 v5, 2, v5
  s_mov_b32 s20, 196608
  buffer_store_dwordx4 v[8:11], v5, s[16:19], s20 offen
  buffer_store_dwordx4 v[12:15], v5, s[16:19], s20 offen offset:16
  buffer_store_dwordx4 v[16:19], v5, s[16:19], s20 offen offset:32

K3_end:
  s_endpgm

k3_kernel_END:
.globl k4_kernel
.p2align 8
.type k4_kernel,@function
k4_kernel:
  s_cmp_ge_u32 s2, 256
  s_cbranch_scc1 K4_end
  s_load_dwordx4 s[4:7], s[0:1], 0
  s_load_dwordx2 s[8:9], s[0:1], 72
  s_load_dwordx2 s[10:11], s[0:1], 48
  s_load_dwordx2 s[12:13], s[0:1], 88
  v_and_b32 v194, 63, v0
  v_lshrrev_b32 v198, 6, v0
  v_mov_b32 v199, v0
  s_nop 0
  v_readfirstlane_b32 s40, v198
  s_and_b32 s57, s2, 7
  s_lshr_b32 s58, s2, 3
  s_lshr_b32 s44, s57, 2
  s_cmp_ge_u32 s58, 24
  s_cbranch_scc1 K4_txt
  s_and_b32 s41, s40, 1
  s_lshr_b32 s42, s40, 1
  s_bfe_u32 s45, s57, 0x10001
  s_lshl_b32 s45, s45, 3
  s_and_b32 s59, s58, 7
  s_add_u32 s45, s45, s59
  s_and_b32 s46, s57, 1
  s_mul_i32 s46, s46, 3
  s_lshr_b32 s59, s58, 3
  s_add_u32 s46, s46, s59
  s_lshl_b32 s47, s45, 6
  v_lshrrev_b32 v200, 3, v194
  v_and_b32 v201, 7, v194
  v_lshrrev_b32 v202, 4, v194
  v_xor_b32 v203, v201, v202
  v_xor_b32 v204, 4, v203
  v_mul_u32_u24 v200, 2176, v200
  v_lshl_add_u32 v176, v203, 4, v200
  v_lshl_add_u32 v177, v204, 4, v200
  s_mul_i32 s48, s44, 1056
  s_add_u32 s48, s48, s47
  s_mul_i32 s49, s48, 2176
  s_mul_i32 s50, s40, 34816
  s_add_u32 s49, s49, s50
  s_mul_i32 s50, s44, 768
  s_lshl_b32 s51, s46, 7
  s_add_u32 s50, s50, s51
  s_mul_i32 s50, s50, 2176
  s_mul_i32 s51, s40, 69632
  s_add_u32 s50, s50, s51
  s_lshl_b32 s51, s40, 11
  s_lshl_b32 s52, s40, 12
  s_add_u32 s52, s52, 8192
  s_waitcnt lgkmcnt(0)

  s_add_u32 s20, s12, 16777216
  s_addc_u32 s21, s13, 0
  s_mov_b32 s22, 4595712
  s_mov_b32 s23, 0x00020000
  s_add_u32 s28, s12, 26214400
  s_addc_u32 s29, s13, 0
  s_mov_b32 s30, 3342336
  s_mov_b32 s31, 0x00020000
  s_add_u32 m0, s51, 0
  s_add_u32 s56, s49, 0
  buffer_load_dwordx4 v176, s[20:23], s56 offen lds
  s_add_u32 m0, s51, 1024
  s_add_u32 s56, s49, 17408
  buffer_load_dwordx4 v177, s[20:23], s56 offen lds
  s_add_u32 m0, s52, 0
  s_add_u32 s56, s50, 0
  buffer_load_dwordx4 v176, s[28:31], s56 offen lds
  s_add_u32 m0, s52, 1024
  s_add_u32 s56, s50, 17408
  buffer_load_dwordx4 v177, s[28:31], s56 offen lds
  s_add_u32 m0, s52, 2048
  s_add_u32 s56, s50, 34816
  buffer_load_dwordx4 v176, s[28:31], s56 offen lds
  s_add_u32 m0, s52, 3072
  s_add_u32 s56, s50, 52224
  buffer_load_dwordx4 v177, s[28:31], s56 offen lds
  s_add_u32 m0, s51, 24576
  s_add_u32 s56, s49, 128
  buffer_load_dwordx4 v176, s[20:23], s56 offen lds
  s_add_u32 m0, s51, 25600
  s_add_u32 s56, s49, 17536
  buffer_load_dwordx4 v177, s[20:23], s56 offen lds
  s_add_u32 m0, s52, 24576
  s_add_u32 s56, s50, 128
  buffer_load_dwordx4 v176, s[28:31], s56 offen lds
  s_add_u32 m0, s52, 25600
  s_add_u32 s56, s50, 17536
  buffer_load_dwordx4 v177, s[28:31], s56 offen lds
  s_add_u32 m0, s52, 26624
  s_add_u32 s56, s50, 34944
  buffer_load_dwordx4 v176, s[28:31], s56 offen lds
  s_add_u32 m0, s52, 27648
  s_add_u32 s56, s50, 52352
  buffer_load_dwordx4 v177, s[28:31], s56 offen lds
  s_mov_b32 s16, s12
  s_mov_b32 s17, s13
  s_mov_b32 s18, 1048576
  s_mov_b32 s19, 0x00020000
  s_add_u32 s24, s12, 25165824
  s_addc_u32 s25, s13, 0
  s_mov_b32 s26, 135168
  s_mov_b32 s27, 0x00020000
  s_mov_b32 s32, s4
  s_mov_b32 s33, s5
  s_mov_b32 s34, 3145728
  s_mov_b32 s35, 0x00020000
  s_mov_b32 s36, s8
  s_mov_b32 s37, s9
  s_mov_b32 s38, 3145728
  s_mov_b32 s39, 0x00020000
  v_and_b32 v195, 31, v194
  v_lshrrev_b32 v196, 5, v194
  s_lshl_b32 s53, s41, 5
  s_add_u32 s53, s53, s48
  v_add_u32 v200, s53, v195
  v_lshlrev_b32 v200, 6, v200

  buffer_load_dwordx4 v[144:147], v200, s[24:27], 0 offen offset:0
  buffer_load_dwordx4 v[148:151], v200, s[24:27], 0 offen offset:16
  buffer_load_dwordx4 v[152:155], v200, s[24:27], 0 offen offset:32
  buffer_load_dwordx4 v[156:159], v200, s[24:27], 0 offen offset:48
  s_add_u32 m0, s51, 49152
  s_add_u32 s56, s49, 256
  buffer_load_dwordx4 v176, s[20:23], s56 offen lds
  s_add_u32 m0, s51, 50176
  s_add_u32 s56, s49, 17664
  buffer_load_dwordx4 v177, s[20:23], s56 offen lds
  s_add_u32 m0, s52, 49152
  s_add_u32 s56, s50, 256
  buffer_load_dwordx4 v176, s[28:31], s56 offen lds
  s_add_u32 m0, s52, 50176
  s_add_u32 s56, s50, 17664
  buffer_load_dwordx4 v177, s[28:31], s56 offen lds
  s_add_u32 m0, s52, 51200
  s_add_u32 s56, s50, 35072
  buffer_load_dwordx4 v176, s[28:31], s56 offen lds
  s_add_u32 m0, s52, 52224
  s_add_u32 s56, s50, 52480
  buffer_load_dwordx4 v177, s[28:31], s56 offen lds
  s_add_u32 m0, s51, 73728
  s_add_u32 s56, s49, 384
  buffer_load_dwordx4 v176, s[20:23], s56 offen lds
  s_add_u32 m0, s51, 74752
  s_add_u32 s56, s49, 17792
  buffer_load_dwordx4 v177, s[20:23], s56 offen lds
  s_add_u32 m0, s52, 73728
  s_add_u32 s56, s50, 384
  buffer_load_dwordx4 v176, s[28:31], s56 offen lds
  s_add_u32 m0, s52, 74752
  s_add_u32 s56, s50, 17792
  buffer_load_dwordx4 v177, s[28:31], s56 offen lds
  s_add_u32 m0, s52, 75776
  s_add_u32 s56, s50, 35200
  buffer_load_dwordx4 v176, s[28:31], s56 offen lds
  s_add_u32 m0, s52, 76800
  s_add_u32 s56, s50, 52608
  buffer_load_dwordx4 v177, s[28:31], s56 offen lds
  s_lshl_b32 s53, s44, 10
  s_add_u32 s53, s53, s47
  s_lshl_b32 s54, s41, 5
  s_add_u32 s53, s53, s54
  v_add_u32 v205, s53, v195
  v_mul_u32_u24 v205, 1536, v205
  v_lshl_add_u32 v205, v196, 4, v205
  s_lshl_b32 s57, s46, 8
  s_lshl_b32 s53, s42, 7
  s_add_u32 s57, s57, s53
  v_bfe_u32 v202, v195, 1, 3
  v_xor_b32 v202, v202, v196
  v_lshlrev_b32 v202, 4, v202
  v_lshl_add_u32 v202, v195, 7, v202
  s_lshl_b32 s53, s41, 12
  v_add_u32 v178, s53, v202

  v_and_b32 v203, 3, v195
  v_bfe_u32 v204, v195, 2, 1
  v_lshl_add_u32 v203, v204, 3, v203
  v_bfe_u32 v204, v195, 3, 1
  v_lshl_add_u32 v203, v204, 2, v203
  v_bfe_u32 v204, v195, 4, 1
  v_lshl_add_u32 v203, v204, 4, v203

  v_bfe_u32 v204, v203, 1, 3
  v_xor_b32 v204, v204, v196
  v_lshlrev_b32 v204, 4, v204
  v_lshl_add_u32 v204, v203, 7, v204
  s_lshl_b32 s53, s42, 13
  s_add_u32 s53, s53, 8192
  v_add_u32 v182, s53, v204

  v_xor_b32 v179, 32, v178
  v_xor_b32 v183, 32, v182
  v_xor_b32 v180, 64, v178
  v_xor_b32 v184, 64, v182
  v_xor_b32 v181, 96, v178
  v_xor_b32 v185, 96, v182
  s_waitcnt vmcnt(12)
  v_max3_f32 v206, v144, v146, v148
  v_max3_f32 v206, v206, v150, v152
  v_max3_f32 v206, v206, v154, v156
  v_max_f32 v206, v206, v158
  v_sub_f32 v120, v144, v206
  v_sub_f32 v121, v146, v206
  v_sub_f32 v122, v148, v206
  v_sub_f32 v123, v150, v206
  v_sub_f32 v124, v152, v206
  v_sub_f32 v125, v154, v206
  v_sub_f32 v126, v156, v206
  v_sub_f32 v127, v158, v206
  v_exp_f32 v120, v120
  v_exp_f32 v121, v121
  v_exp_f32 v122, v122
  v_exp_f32 v123, v123
  v_exp_f32 v124, v124
  v_exp_f32 v125, v125
  v_exp_f32 v126, v126
  v_exp_f32 v127, v127
  s_nop 0
  v_mul_f32 v207, v120, v145
  v_fmac_f32 v207, v121, v147
  v_fmac_f32 v207, v122, v149
  v_fmac_f32 v207, v123, v151
  v_fmac_f32 v207, v124, v153
  v_fmac_f32 v207, v125, v155
  v_fmac_f32 v207, v126, v157
  v_fmac_f32 v207, v127, v159
  v_rcp_f32 v207, v207
  s_nop 0
  v_mul_f32 v120, v120, v207
  v_mul_f32 v121, v121, v207
  v_mul_f32 v122, v122, v207
  v_mul_f32 v123, v123, v207
  v_mul_f32 v124, v124, v207
  v_mul_f32 v125, v125, v207
  v_mul_f32 v126, v126, v207
  v_mul_f32 v127, v127, v207
  s_waitcnt vmcnt(22)
  s_barrier
  v_add_u32 v186, 0, v178
  v_add_u32 v190, 0, v182
  v_add_u32 v187, 0, v179
  v_add_u32 v191, 0, v183
  v_add_u32 v188, 0, v180
  v_add_u32 v192, 0, v184
  v_add_u32 v189, 0, v181
  v_add_u32 v193, 0, v185
  ds_read_b128 v[96:99], v186
  ds_read_b128 v[100:103], v190 offset:0
  ds_read_b128 v[104:107], v190 offset:4096
  ds_read_b128 v[108:111], v187
  ds_read_b128 v[112:115], v191 offset:0
  ds_read_b128 v[116:119], v191 offset:4096
  s_waitcnt lgkmcnt(3)
  v_mfma_f32_32x32x16_bf16 v[32:47], v[100:103], v[96:99], 0
  v_mfma_f32_32x32x16_bf16 v[48:63], v[104:107], v[96:99], 0
  ds_read_b128 v[96:99], v188
  ds_read_b128 v[100:103], v192 offset:0
  ds_read_b128 v[104:107], v192 offset:4096
  s_waitcnt lgkmcnt(3)
  v_mfma_f32_32x32x16_bf16 v[32:47], v[112:115], v[108:111], v[32:47]
  v_mfma_f32_32x32x16_bf16 v[48:63], v[116:119], v[108:111], v[48:63]
  ds_read_b128 v[108:111], v189
  ds_read_b128 v[112:115], v193 offset:0
  ds_read_b128 v[116:119], v193 offset:4096
  s_waitcnt lgkmcnt(3)
  v_mfma_f32_32x32x16_bf16 v[32:47], v[100:103], v[96:99], v[32:47]
  v_mfma_f32_32x32x16_bf16 v[48:63], v[104:107], v[96:99], v[48:63]
  s_waitcnt lgkmcnt(0)
  s_waitcnt vmcnt(16)
  s_barrier
  v_add_u32 v186, 24576, v178
  v_add_u32 v190, 24576, v182
  v_add_u32 v187, 24576, v179
  v_add_u32 v191, 24576, v183
  v_add_u32 v188, 24576, v180
  v_add_u32 v192, 24576, v184
  v_add_u32 v189, 24576, v181
  v_add_u32 v193, 24576, v185
  ds_read_b128 v[96:99], v186
  ds_read_b128 v[100:103], v190 offset:0
  ds_read_b128 v[104:107], v190 offset:4096
  v_mfma_f32_32x32x16_bf16 v[32:47], v[112:115], v[108:111], v[32:47]
  s_add_u32 m0, s51, 98304
  s_add_u32 s56, s49, 512
  buffer_load_dwordx4 v176, s[20:23], s56 offen lds
  s_add_u32 m0, s51, 99328
  s_add_u32 s56, s49, 17920
  buffer_load_dwordx4 v177, s[20:23], s56 offen lds
  s_add_u32 m0, s52, 98304
  s_add_u32 s56, s50, 512
  buffer_load_dwordx4 v176, s[28:31], s56 offen lds
  v_mfma_f32_32x32x16_bf16 v[48:63], v[116:119], v[108:111], v[48:63]
  s_add_u32 m0, s52, 99328
  s_add_u32 s56, s50, 17920
  buffer_load_dwordx4 v177, s[28:31], s56 offen lds
  s_add_u32 m0, s52, 100352
  s_add_u32 s56, s50, 35328
  buffer_load_dwordx4 v176, s[28:31], s56 offen lds
  s_add_u32 m0, s52, 101376
  s_add_u32 s56, s50, 52736
  buffer_load_dwordx4 v177, s[28:31], s56 offen lds
  ds_read_b128 v[108:111], v187
  ds_read_b128 v[112:115], v191 offset:0
  ds_read_b128 v[116:119], v191 offset:4096
  s_waitcnt lgkmcnt(3)
  v_mfma_f32_32x32x16_bf16 v[32:47], v[100:103], v[96:99], v[32:47]
  v_mfma_f32_32x32x16_bf16 v[48:63], v[104:107], v[96:99], v[48:63]
  ds_read_b128 v[96:99], v188
  ds_read_b128 v[100:103], v192 offset:0
  ds_read_b128 v[104:107], v192 offset:4096
  s_waitcnt lgkmcnt(3)
  v_mfma_f32_32x32x16_bf16 v[32:47], v[112:115], v[108:111], v[32:47]
  v_mfma_f32_32x32x16_bf16 v[48:63], v[116:119], v[108:111], v[48:63]
  ds_read_b128 v[108:111], v189
  ds_read_b128 v[112:115], v193 offset:0
  ds_read_b128 v[116:119], v193 offset:4096
  s_waitcnt lgkmcnt(3)
  v_mfma_f32_32x32x16_bf16 v[32:47], v[100:103], v[96:99], v[32:47]
  v_mfma_f32_32x32x16_bf16 v[48:63], v[104:107], v[96:99], v[48:63]
  s_waitcnt lgkmcnt(0)
  s_waitcnt vmcnt(12)
  s_barrier
  v_add_u32 v186, 49152, v178
  v_add_u32 v190, 49152, v182
  v_add_u32 v187, 49152, v179
  v_add_u32 v191, 49152, v183
  v_add_u32 v188, 49152, v180
  v_add_u32 v192, 49152, v184
  v_add_u32 v189, 49152, v181
  v_add_u32 v193, 49152, v185
  ds_read_b128 v[96:99], v186
  ds_read_b128 v[100:103], v190 offset:0
  ds_read_b128 v[104:107], v190 offset:4096
  v_mfma_f32_32x32x16_bf16 v[32:47], v[112:115], v[108:111], v[32:47]
  s_add_u32 m0, s51, 0
  s_add_u32 s56, s49, 640
  buffer_load_dwordx4 v176, s[20:23], s56 offen lds
  s_add_u32 m0, s51, 1024
  s_add_u32 s56, s49, 18048
  buffer_load_dwordx4 v177, s[20:23], s56 offen lds
  s_add_u32 m0, s52, 0
  s_add_u32 s56, s50, 640
  buffer_load_dwordx4 v176, s[28:31], s56 offen lds
  v_mfma_f32_32x32x16_bf16 v[48:63], v[116:119], v[108:111], v[48:63]
  s_add_u32 m0, s52, 1024
  s_add_u32 s56, s50, 18048
  buffer_load_dwordx4 v177, s[28:31], s56 offen lds
  s_add_u32 m0, s52, 2048
  s_add_u32 s56, s50, 35456
  buffer_load_dwordx4 v176, s[28:31], s56 offen lds
  s_add_u32 m0, s52, 3072
  s_add_u32 s56, s50, 52864
  buffer_load_dwordx4 v177, s[28:31], s56 offen lds
  ds_read_b128 v[108:111], v187
  ds_read_b128 v[112:115], v191 offset:0
  ds_read_b128 v[116:119], v191 offset:4096
  s_waitcnt lgkmcnt(3)
  v_mfma_f32_32x32x16_bf16 v[64:79], v[100:103], v[96:99], 0
  v_mfma_f32_32x32x16_bf16 v[80:95], v[104:107], v[96:99], 0
  ds_read_b128 v[96:99], v188
  ds_read_b128 v[100:103], v192 offset:0
  ds_read_b128 v[104:107], v192 offset:4096
  s_waitcnt lgkmcnt(3)
  v_mfma_f32_32x32x16_bf16 v[64:79], v[112:115], v[108:111], v[64:79]
  v_mfma_f32_32x32x16_bf16 v[80:95], v[116:119], v[108:111], v[80:95]
  ds_read_b128 v[108:111], v189
  ds_read_b128 v[112:115], v193 offset:0
  ds_read_b128 v[116:119], v193 offset:4096
  s_waitcnt lgkmcnt(3)
  v_mfma_f32_32x32x16_bf16 v[64:79], v[100:103], v[96:99], v[64:79]
  v_mul_f32 v0, v32, v120
  v_mul_f32 v1, v33, v120
  v_mul_f32 v2, v34, v120
  v_mul_f32 v3, v35, v120
  v_mfma_f32_32x32x16_bf16 v[80:95], v[104:107], v[96:99], v[80:95]
  v_mul_f32 v4, v36, v120
  v_mul_f32 v5, v37, v120
  v_mul_f32 v6, v38, v120
  v_mul_f32 v7, v39, v120
  s_waitcnt lgkmcnt(0)
  s_waitcnt vmcnt(12)
  s_barrier
  v_add_u32 v186, 73728, v178
  v_add_u32 v190, 73728, v182
  v_add_u32 v187, 73728, v179
  v_add_u32 v191, 73728, v183
  v_add_u32 v188, 73728, v180
  v_add_u32 v192, 73728, v184
  v_add_u32 v189, 73728, v181
  v_add_u32 v193, 73728, v185
  ds_read_b128 v[96:99], v186
  ds_read_b128 v[100:103], v190 offset:0
  ds_read_b128 v[104:107], v190 offset:4096
  v_mfma_f32_32x32x16_bf16 v[64:79], v[112:115], v[108:111], v[64:79]
  s_add_u32 m0, s51, 24576
  s_add_u32 s56, s49, 768
  buffer_load_dwordx4 v176, s[20:23], s56 offen lds
  s_add_u32 m0, s51, 25600
  s_add_u32 s56, s49, 18176
  buffer_load_dwordx4 v177, s[20:23], s56 offen lds
  s_add_u32 m0, s52, 24576
  s_add_u32 s56, s50, 768
  buffer_load_dwordx4 v176, s[28:31], s56 offen lds
  v_mul_f32 v8, v40, v120
  v_mul_f32 v9, v41, v120
  v_mul_f32 v10, v42, v120
  v_mul_f32 v11, v43, v120
  v_mfma_f32_32x32x16_bf16 v[80:95], v[116:119], v[108:111], v[80:95]
  s_add_u32 m0, s52, 25600
  s_add_u32 s56, s50, 18176
  buffer_load_dwordx4 v177, s[28:31], s56 offen lds
  s_add_u32 m0, s52, 26624
  s_add_u32 s56, s50, 35584
  buffer_load_dwordx4 v176, s[28:31], s56 offen lds
  s_add_u32 m0, s52, 27648
  s_add_u32 s56, s50, 52992
  buffer_load_dwordx4 v177, s[28:31], s56 offen lds
  v_mul_f32 v12, v44, v120
  v_mul_f32 v13, v45, v120
  v_mul_f32 v14, v46, v120
  v_mul_f32 v15, v47, v120
  ds_read_b128 v[108:111], v187
  ds_read_b128 v[112:115], v191 offset:0
  ds_read_b128 v[116:119], v191 offset:4096
  s_waitcnt lgkmcnt(3)
  v_mfma_f32_32x32x16_bf16 v[64:79], v[100:103], v[96:99], v[64:79]
  v_mul_f32 v16, v48, v120
  v_mul_f32 v17, v49, v120
  v_mul_f32 v18, v50, v120
  v_mul_f32 v19, v51, v120
  v_mfma_f32_32x32x16_bf16 v[80:95], v[104:107], v[96:99], v[80:95]
  v_mul_f32 v20, v52, v120
  v_mul_f32 v21, v53, v120
  v_mul_f32 v22, v54, v120
  v_mul_f32 v23, v55, v120
  ds_read_b128 v[96:99], v188
  ds_read_b128 v[100:103], v192 offset:0
  ds_read_b128 v[104:107], v192 offset:4096
  s_waitcnt lgkmcnt(3)
  v_mfma_f32_32x32x16_bf16 v[64:79], v[112:115], v[108:111], v[64:79]
  v_mul_f32 v24, v56, v120
  v_mul_f32 v25, v57, v120
  v_mul_f32 v26, v58, v120
  v_mul_f32 v27, v59, v120
  v_mfma_f32_32x32x16_bf16 v[80:95], v[116:119], v[108:111], v[80:95]
  v_mul_f32 v28, v60, v120
  v_mul_f32 v29, v61, v120
  v_mul_f32 v30, v62, v120
  v_mul_f32 v31, v63, v120
  ds_read_b128 v[108:111], v189
  ds_read_b128 v[112:115], v193 offset:0
  ds_read_b128 v[116:119], v193 offset:4096
  s_waitcnt lgkmcnt(3)
  v_mfma_f32_32x32x16_bf16 v[64:79], v[100:103], v[96:99], v[64:79]
  v_mfma_f32_32x32x16_bf16 v[80:95], v[104:107], v[96:99], v[80:95]
  s_waitcnt lgkmcnt(0)
  s_waitcnt vmcnt(12)
  s_barrier
  v_add_u32 v186, 98304, v178
  v_add_u32 v190, 98304, v182
  v_add_u32 v187, 98304, v179
  v_add_u32 v191, 98304, v183
  v_add_u32 v188, 98304, v180
  v_add_u32 v192, 98304, v184
  v_add_u32 v189, 98304, v181
  v_add_u32 v193, 98304, v185
  ds_read_b128 v[96:99], v186
  ds_read_b128 v[100:103], v190 offset:0
  ds_read_b128 v[104:107], v190 offset:4096
  v_mfma_f32_32x32x16_bf16 v[64:79], v[112:115], v[108:111], v[64:79]
  s_add_u32 m0, s51, 49152
  s_add_u32 s56, s49, 896
  buffer_load_dwordx4 v176, s[20:23], s56 offen lds
  s_add_u32 m0, s51, 50176
  s_add_u32 s56, s49, 18304
  buffer_load_dwordx4 v177, s[20:23], s56 offen lds
  s_add_u32 m0, s52, 49152
  s_add_u32 s56, s50, 896
  buffer_load_dwordx4 v176, s[28:31], s56 offen lds
  v_mfma_f32_32x32x16_bf16 v[80:95], v[116:119], v[108:111], v[80:95]
  s_add_u32 m0, s52, 50176
  s_add_u32 s56, s50, 18304
  buffer_load_dwordx4 v177, s[28:31], s56 offen lds
  s_add_u32 m0, s52, 51200
  s_add_u32 s56, s50, 35712
  buffer_load_dwordx4 v176, s[28:31], s56 offen lds
  s_add_u32 m0, s52, 52224
  s_add_u32 s56, s50, 53120
  buffer_load_dwordx4 v177, s[28:31], s56 offen lds
  ds_read_b128 v[108:111], v187
  ds_read_b128 v[112:115], v191 offset:0
  ds_read_b128 v[116:119], v191 offset:4096
  s_waitcnt lgkmcnt(3)
  v_mfma_f32_32x32x16_bf16 v[32:47], v[100:103], v[96:99], 0
  v_mfma_f32_32x32x16_bf16 v[48:63], v[104:107], v[96:99], 0
  ds_read_b128 v[96:99], v188
  ds_read_b128 v[100:103], v192 offset:0
  ds_read_b128 v[104:107], v192 offset:4096
  s_waitcnt lgkmcnt(3)
  v_mfma_f32_32x32x16_bf16 v[32:47], v[112:115], v[108:111], v[32:47]
  v_mfma_f32_32x32x16_bf16 v[48:63], v[116:119], v[108:111], v[48:63]
  ds_read_b128 v[108:111], v189
  ds_read_b128 v[112:115], v193 offset:0
  ds_read_b128 v[116:119], v193 offset:4096
  s_waitcnt lgkmcnt(3)
  v_mfma_f32_32x32x16_bf16 v[32:47], v[100:103], v[96:99], v[32:47]
  v_fmac_f32 v0, v64, v121
  v_fmac_f32 v1, v65, v121
  v_fmac_f32 v2, v66, v121
  v_fmac_f32 v3, v67, v121
  v_mfma_f32_32x32x16_bf16 v[48:63], v[104:107], v[96:99], v[48:63]
  v_fmac_f32 v4, v68, v121
  v_fmac_f32 v5, v69, v121
  v_fmac_f32 v6, v70, v121
  v_fmac_f32 v7, v71, v121
  s_waitcnt lgkmcnt(0)
  s_waitcnt vmcnt(12)
  s_barrier
  v_add_u32 v186, 0, v178
  v_add_u32 v190, 0, v182
  v_add_u32 v187, 0, v179
  v_add_u32 v191, 0, v183
  v_add_u32 v188, 0, v180
  v_add_u32 v192, 0, v184
  v_add_u32 v189, 0, v181
  v_add_u32 v193, 0, v185
  ds_read_b128 v[96:99], v186
  ds_read_b128 v[100:103], v190 offset:0
  ds_read_b128 v[104:107], v190 offset:4096
  v_mfma_f32_32x32x16_bf16 v[32:47], v[112:115], v[108:111], v[32:47]
  s_add_u32 m0, s51, 73728
  s_add_u32 s56, s49, 1024
  buffer_load_dwordx4 v176, s[20:23], s56 offen lds
  s_add_u32 m0, s51, 74752
  s_add_u32 s56, s49, 18432
  buffer_load_dwordx4 v177, s[20:23], s56 offen lds
  s_add_u32 m0, s52, 73728
  s_add_u32 s56, s50, 1024
  buffer_load_dwordx4 v176, s[28:31], s56 offen lds
  v_fmac_f32 v8, v72, v121
  v_fmac_f32 v9, v73, v121
  v_fmac_f32 v10, v74, v121
  v_fmac_f32 v11, v75, v121
  v_mfma_f32_32x32x16_bf16 v[48:63], v[116:119], v[108:111], v[48:63]
  s_add_u32 m0, s52, 74752
  s_add_u32 s56, s50, 18432
  buffer_load_dwordx4 v177, s[28:31], s56 offen lds
  s_add_u32 m0, s52, 75776
  s_add_u32 s56, s50, 35840
  buffer_load_dwordx4 v176, s[28:31], s56 offen lds
  s_add_u32 m0, s52, 76800
  s_add_u32 s56, s50, 53248
  buffer_load_dwordx4 v177, s[28:31], s56 offen lds
  v_fmac_f32 v12, v76, v121
  v_fmac_f32 v13, v77, v121
  v_fmac_f32 v14, v78, v121
  v_fmac_f32 v15, v79, v121
  ds_read_b128 v[108:111], v187
  ds_read_b128 v[112:115], v191 offset:0
  ds_read_b128 v[116:119], v191 offset:4096
  s_waitcnt lgkmcnt(3)
  v_mfma_f32_32x32x16_bf16 v[32:47], v[100:103], v[96:99], v[32:47]
  v_fmac_f32 v16, v80, v121
  v_fmac_f32 v17, v81, v121
  v_fmac_f32 v18, v82, v121
  v_fmac_f32 v19, v83, v121
  v_mfma_f32_32x32x16_bf16 v[48:63], v[104:107], v[96:99], v[48:63]
  v_fmac_f32 v20, v84, v121
  v_fmac_f32 v21, v85, v121
  v_fmac_f32 v22, v86, v121
  v_fmac_f32 v23, v87, v121
  ds_read_b128 v[96:99], v188
  ds_read_b128 v[100:103], v192 offset:0
  ds_read_b128 v[104:107], v192 offset:4096
  s_waitcnt lgkmcnt(3)
  v_mfma_f32_32x32x16_bf16 v[32:47], v[112:115], v[108:111], v[32:47]
  v_fmac_f32 v24, v88, v121
  v_fmac_f32 v25, v89, v121
  v_fmac_f32 v26, v90, v121
  v_fmac_f32 v27, v91, v121
  v_mfma_f32_32x32x16_bf16 v[48:63], v[116:119], v[108:111], v[48:63]
  v_fmac_f32 v28, v92, v121
  v_fmac_f32 v29, v93, v121
  v_fmac_f32 v30, v94, v121
  v_fmac_f32 v31, v95, v121
  ds_read_b128 v[108:111], v189
  ds_read_b128 v[112:115], v193 offset:0
  ds_read_b128 v[116:119], v193 offset:4096
  s_waitcnt lgkmcnt(3)
  v_mfma_f32_32x32x16_bf16 v[32:47], v[100:103], v[96:99], v[32:47]
  v_mfma_f32_32x32x16_bf16 v[48:63], v[104:107], v[96:99], v[48:63]
  s_waitcnt lgkmcnt(0)
  s_waitcnt vmcnt(12)
  s_barrier
  v_add_u32 v186, 24576, v178
  v_add_u32 v190, 24576, v182
  v_add_u32 v187, 24576, v179
  v_add_u32 v191, 24576, v183
  v_add_u32 v188, 24576, v180
  v_add_u32 v192, 24576, v184
  v_add_u32 v189, 24576, v181
  v_add_u32 v193, 24576, v185
  ds_read_b128 v[96:99], v186
  ds_read_b128 v[100:103], v190 offset:0
  ds_read_b128 v[104:107], v190 offset:4096
  v_mfma_f32_32x32x16_bf16 v[32:47], v[112:115], v[108:111], v[32:47]
  s_add_u32 m0, s51, 98304
  s_add_u32 s56, s49, 1152
  buffer_load_dwordx4 v176, s[20:23], s56 offen lds
  s_add_u32 m0, s51, 99328
  s_add_u32 s56, s49, 18560
  buffer_load_dwordx4 v177, s[20:23], s56 offen lds
  s_add_u32 m0, s52, 98304
  s_add_u32 s56, s50, 1152
  buffer_load_dwordx4 v176, s[28:31], s56 offen lds
  v_mfma_f32_32x32x16_bf16 v[48:63], v[116:119], v[108:111], v[48:63]
  s_add_u32 m0, s52, 99328
  s_add_u32 s56, s50, 18560
  buffer_load_dwordx4 v177, s[28:31], s56 offen lds
  s_add_u32 m0, s52, 100352
  s_add_u32 s56, s50, 35968
  buffer_load_dwordx4 v176, s[28:31], s56 offen lds
  s_add_u32 m0, s52, 101376
  s_add_u32 s56, s50, 53376
  buffer_load_dwordx4 v177, s[28:31], s56 offen lds
  ds_read_b128 v[108:111], v187
  ds_read_b128 v[112:115], v191 offset:0
  ds_read_b128 v[116:119], v191 offset:4096
  s_waitcnt lgkmcnt(3)
  v_mfma_f32_32x32x16_bf16 v[64:79], v[100:103], v[96:99], 0
  v_mfma_f32_32x32x16_bf16 v[80:95], v[104:107], v[96:99], 0
  ds_read_b128 v[96:99], v188
  ds_read_b128 v[100:103], v192 offset:0
  ds_read_b128 v[104:107], v192 offset:4096
  s_waitcnt lgkmcnt(3)
  v_mfma_f32_32x32x16_bf16 v[64:79], v[112:115], v[108:111], v[64:79]
  v_mfma_f32_32x32x16_bf16 v[80:95], v[116:119], v[108:111], v[80:95]
  ds_read_b128 v[108:111], v189
  ds_read_b128 v[112:115], v193 offset:0
  ds_read_b128 v[116:119], v193 offset:4096
  s_waitcnt lgkmcnt(3)
  v_mfma_f32_32x32x16_bf16 v[64:79], v[100:103], v[96:99], v[64:79]
  v_fmac_f32 v0, v32, v122
  v_fmac_f32 v1, v33, v122
  v_fmac_f32 v2, v34, v122
  v_fmac_f32 v3, v35, v122
  v_mfma_f32_32x32x16_bf16 v[80:95], v[104:107], v[96:99], v[80:95]
  v_fmac_f32 v4, v36, v122
  v_fmac_f32 v5, v37, v122
  v_fmac_f32 v6, v38, v122
  v_fmac_f32 v7, v39, v122
  s_waitcnt lgkmcnt(0)
  s_waitcnt vmcnt(12)
  s_barrier
  v_add_u32 v186, 49152, v178
  v_add_u32 v190, 49152, v182
  v_add_u32 v187, 49152, v179
  v_add_u32 v191, 49152, v183
  v_add_u32 v188, 49152, v180
  v_add_u32 v192, 49152, v184
  v_add_u32 v189, 49152, v181
  v_add_u32 v193, 49152, v185
  ds_read_b128 v[96:99], v186
  ds_read_b128 v[100:103], v190 offset:0
  ds_read_b128 v[104:107], v190 offset:4096
  v_mfma_f32_32x32x16_bf16 v[64:79], v[112:115], v[108:111], v[64:79]
  s_add_u32 m0, s51, 0
  s_add_u32 s56, s49, 1280
  buffer_load_dwordx4 v176, s[20:23], s56 offen lds
  s_add_u32 m0, s51, 1024
  s_add_u32 s56, s49, 18688
  buffer_load_dwordx4 v177, s[20:23], s56 offen lds
  s_add_u32 m0, s52, 0
  s_add_u32 s56, s50, 1280
  buffer_load_dwordx4 v176, s[28:31], s56 offen lds
  v_fmac_f32 v8, v40, v122
  v_fmac_f32 v9, v41, v122
  v_fmac_f32 v10, v42, v122
  v_fmac_f32 v11, v43, v122
  v_mfma_f32_32x32x16_bf16 v[80:95], v[116:119], v[108:111], v[80:95]
  s_add_u32 m0, s52, 1024
  s_add_u32 s56, s50, 18688
  buffer_load_dwordx4 v177, s[28:31], s56 offen lds
  s_add_u32 m0, s52, 2048
  s_add_u32 s56, s50, 36096
  buffer_load_dwordx4 v176, s[28:31], s56 offen lds
  s_add_u32 m0, s52, 3072
  s_add_u32 s56, s50, 53504
  buffer_load_dwordx4 v177, s[28:31], s56 offen lds
  v_fmac_f32 v12, v44, v122
  v_fmac_f32 v13, v45, v122
  v_fmac_f32 v14, v46, v122
  v_fmac_f32 v15, v47, v122
  ds_read_b128 v[108:111], v187
  ds_read_b128 v[112:115], v191 offset:0
  ds_read_b128 v[116:119], v191 offset:4096
  s_waitcnt lgkmcnt(3)
  v_mfma_f32_32x32x16_bf16 v[64:79], v[100:103], v[96:99], v[64:79]
  v_fmac_f32 v16, v48, v122
  v_fmac_f32 v17, v49, v122
  v_fmac_f32 v18, v50, v122
  v_fmac_f32 v19, v51, v122
  v_mfma_f32_32x32x16_bf16 v[80:95], v[104:107], v[96:99], v[80:95]
  v_fmac_f32 v20, v52, v122
  v_fmac_f32 v21, v53, v122
  v_fmac_f32 v22, v54, v122
  v_fmac_f32 v23, v55, v122
  ds_read_b128 v[96:99], v188
  ds_read_b128 v[100:103], v192 offset:0
  ds_read_b128 v[104:107], v192 offset:4096
  s_waitcnt lgkmcnt(3)
  v_mfma_f32_32x32x16_bf16 v[64:79], v[112:115], v[108:111], v[64:79]
  v_fmac_f32 v24, v56, v122
  v_fmac_f32 v25, v57, v122
  v_fmac_f32 v26, v58, v122
  v_fmac_f32 v27, v59, v122
  v_mfma_f32_32x32x16_bf16 v[80:95], v[116:119], v[108:111], v[80:95]
  v_fmac_f32 v28, v60, v122
  v_fmac_f32 v29, v61, v122
  v_fmac_f32 v30, v62, v122
  v_fmac_f32 v31, v63, v122
  ds_read_b128 v[108:111], v189
  ds_read_b128 v[112:115], v193 offset:0
  ds_read_b128 v[116:119], v193 offset:4096
  s_waitcnt lgkmcnt(3)
  v_mfma_f32_32x32x16_bf16 v[64:79], v[100:103], v[96:99], v[64:79]
  v_mfma_f32_32x32x16_bf16 v[80:95], v[104:107], v[96:99], v[80:95]
  s_waitcnt lgkmcnt(0)
  s_waitcnt vmcnt(12)
  s_barrier
  v_add_u32 v186, 73728, v178
  v_add_u32 v190, 73728, v182
  v_add_u32 v187, 73728, v179
  v_add_u32 v191, 73728, v183
  v_add_u32 v188, 73728, v180
  v_add_u32 v192, 73728, v184
  v_add_u32 v189, 73728, v181
  v_add_u32 v193, 73728, v185
  ds_read_b128 v[96:99], v186
  ds_read_b128 v[100:103], v190 offset:0
  ds_read_b128 v[104:107], v190 offset:4096
  v_mfma_f32_32x32x16_bf16 v[64:79], v[112:115], v[108:111], v[64:79]
  s_add_u32 m0, s51, 24576
  s_add_u32 s56, s49, 1408
  buffer_load_dwordx4 v176, s[20:23], s56 offen lds
  s_add_u32 m0, s51, 25600
  s_add_u32 s56, s49, 18816
  buffer_load_dwordx4 v177, s[20:23], s56 offen lds
  s_add_u32 m0, s52, 24576
  s_add_u32 s56, s50, 1408
  buffer_load_dwordx4 v176, s[28:31], s56 offen lds
  v_mfma_f32_32x32x16_bf16 v[80:95], v[116:119], v[108:111], v[80:95]
  s_add_u32 m0, s52, 25600
  s_add_u32 s56, s50, 18816
  buffer_load_dwordx4 v177, s[28:31], s56 offen lds
  s_add_u32 m0, s52, 26624
  s_add_u32 s56, s50, 36224
  buffer_load_dwordx4 v176, s[28:31], s56 offen lds
  s_add_u32 m0, s52, 27648
  s_add_u32 s56, s50, 53632
  buffer_load_dwordx4 v177, s[28:31], s56 offen lds
  ds_read_b128 v[108:111], v187
  ds_read_b128 v[112:115], v191 offset:0
  ds_read_b128 v[116:119], v191 offset:4096
  s_waitcnt lgkmcnt(3)
  v_mfma_f32_32x32x16_bf16 v[32:47], v[100:103], v[96:99], 0
  v_mfma_f32_32x32x16_bf16 v[48:63], v[104:107], v[96:99], 0
  ds_read_b128 v[96:99], v188
  ds_read_b128 v[100:103], v192 offset:0
  ds_read_b128 v[104:107], v192 offset:4096
  s_waitcnt lgkmcnt(3)
  v_mfma_f32_32x32x16_bf16 v[32:47], v[112:115], v[108:111], v[32:47]
  v_mfma_f32_32x32x16_bf16 v[48:63], v[116:119], v[108:111], v[48:63]
  ds_read_b128 v[108:111], v189
  ds_read_b128 v[112:115], v193 offset:0
  ds_read_b128 v[116:119], v193 offset:4096
  s_waitcnt lgkmcnt(3)
  v_mfma_f32_32x32x16_bf16 v[32:47], v[100:103], v[96:99], v[32:47]
  v_fmac_f32 v0, v64, v123
  v_fmac_f32 v1, v65, v123
  v_fmac_f32 v2, v66, v123
  v_fmac_f32 v3, v67, v123
  v_mfma_f32_32x32x16_bf16 v[48:63], v[104:107], v[96:99], v[48:63]
  v_fmac_f32 v4, v68, v123
  v_fmac_f32 v5, v69, v123
  v_fmac_f32 v6, v70, v123
  v_fmac_f32 v7, v71, v123
  s_waitcnt lgkmcnt(0)
  s_waitcnt vmcnt(12)
  s_barrier
  v_add_u32 v186, 98304, v178
  v_add_u32 v190, 98304, v182
  v_add_u32 v187, 98304, v179
  v_add_u32 v191, 98304, v183
  v_add_u32 v188, 98304, v180
  v_add_u32 v192, 98304, v184
  v_add_u32 v189, 98304, v181
  v_add_u32 v193, 98304, v185
  ds_read_b128 v[96:99], v186
  ds_read_b128 v[100:103], v190 offset:0
  ds_read_b128 v[104:107], v190 offset:4096
  v_mfma_f32_32x32x16_bf16 v[32:47], v[112:115], v[108:111], v[32:47]
  s_add_u32 m0, s51, 49152
  s_add_u32 s56, s49, 1536
  buffer_load_dwordx4 v176, s[20:23], s56 offen lds
  s_add_u32 m0, s51, 50176
  s_add_u32 s56, s49, 18944
  buffer_load_dwordx4 v177, s[20:23], s56 offen lds
  s_add_u32 m0, s52, 49152
  s_add_u32 s56, s50, 1536
  buffer_load_dwordx4 v176, s[28:31], s56 offen lds
  v_fmac_f32 v8, v72, v123
  v_fmac_f32 v9, v73, v123
  v_fmac_f32 v10, v74, v123
  v_fmac_f32 v11, v75, v123
  v_mfma_f32_32x32x16_bf16 v[48:63], v[116:119], v[108:111], v[48:63]
  s_add_u32 m0, s52, 50176
  s_add_u32 s56, s50, 18944
  buffer_load_dwordx4 v177, s[28:31], s56 offen lds
  s_add_u32 m0, s52, 51200
  s_add_u32 s56, s50, 36352
  buffer_load_dwordx4 v176, s[28:31], s56 offen lds
  s_add_u32 m0, s52, 52224
  s_add_u32 s56, s50, 53760
  buffer_load_dwordx4 v177, s[28:31], s56 offen lds
  v_fmac_f32 v12, v76, v123
  v_fmac_f32 v13, v77, v123
  v_fmac_f32 v14, v78, v123
  v_fmac_f32 v15, v79, v123
  ds_read_b128 v[108:111], v187
  ds_read_b128 v[112:115], v191 offset:0
  ds_read_b128 v[116:119], v191 offset:4096
  s_waitcnt lgkmcnt(3)
  v_mfma_f32_32x32x16_bf16 v[32:47], v[100:103], v[96:99], v[32:47]
  v_fmac_f32 v16, v80, v123
  v_fmac_f32 v17, v81, v123
  v_fmac_f32 v18, v82, v123
  v_fmac_f32 v19, v83, v123
  v_mfma_f32_32x32x16_bf16 v[48:63], v[104:107], v[96:99], v[48:63]
  v_fmac_f32 v20, v84, v123
  v_fmac_f32 v21, v85, v123
  v_fmac_f32 v22, v86, v123
  v_fmac_f32 v23, v87, v123
  ds_read_b128 v[96:99], v188
  ds_read_b128 v[100:103], v192 offset:0
  ds_read_b128 v[104:107], v192 offset:4096
  s_waitcnt lgkmcnt(3)
  v_mfma_f32_32x32x16_bf16 v[32:47], v[112:115], v[108:111], v[32:47]
  v_fmac_f32 v24, v88, v123
  v_fmac_f32 v25, v89, v123
  v_fmac_f32 v26, v90, v123
  v_fmac_f32 v27, v91, v123
  v_mfma_f32_32x32x16_bf16 v[48:63], v[116:119], v[108:111], v[48:63]
  v_fmac_f32 v28, v92, v123
  v_fmac_f32 v29, v93, v123
  v_fmac_f32 v30, v94, v123
  v_fmac_f32 v31, v95, v123
  ds_read_b128 v[108:111], v189
  ds_read_b128 v[112:115], v193 offset:0
  ds_read_b128 v[116:119], v193 offset:4096
  s_waitcnt lgkmcnt(3)
  v_mfma_f32_32x32x16_bf16 v[32:47], v[100:103], v[96:99], v[32:47]
  v_mfma_f32_32x32x16_bf16 v[48:63], v[104:107], v[96:99], v[48:63]
  s_waitcnt lgkmcnt(0)
  s_waitcnt vmcnt(12)
  s_barrier
  v_add_u32 v186, 0, v178
  v_add_u32 v190, 0, v182
  v_add_u32 v187, 0, v179
  v_add_u32 v191, 0, v183
  v_add_u32 v188, 0, v180
  v_add_u32 v192, 0, v184
  v_add_u32 v189, 0, v181
  v_add_u32 v193, 0, v185
  ds_read_b128 v[96:99], v186
  ds_read_b128 v[100:103], v190 offset:0
  ds_read_b128 v[104:107], v190 offset:4096
  v_mfma_f32_32x32x16_bf16 v[32:47], v[112:115], v[108:111], v[32:47]
  s_add_u32 m0, s51, 73728
  s_add_u32 s56, s49, 1664
  buffer_load_dwordx4 v176, s[20:23], s56 offen lds
  s_add_u32 m0, s51, 74752
  s_add_u32 s56, s49, 19072
  buffer_load_dwordx4 v177, s[20:23], s56 offen lds
  s_add_u32 m0, s52, 73728
  s_add_u32 s56, s50, 1664
  buffer_load_dwordx4 v176, s[28:31], s56 offen lds
  v_mfma_f32_32x32x16_bf16 v[48:63], v[116:119], v[108:111], v[48:63]
  s_add_u32 m0, s52, 74752
  s_add_u32 s56, s50, 19072
  buffer_load_dwordx4 v177, s[28:31], s56 offen lds
  s_add_u32 m0, s52, 75776
  s_add_u32 s56, s50, 36480
  buffer_load_dwordx4 v176, s[28:31], s56 offen lds
  s_add_u32 m0, s52, 76800
  s_add_u32 s56, s50, 53888
  buffer_load_dwordx4 v177, s[28:31], s56 offen lds
  ds_read_b128 v[108:111], v187
  ds_read_b128 v[112:115], v191 offset:0
  ds_read_b128 v[116:119], v191 offset:4096
  s_waitcnt lgkmcnt(3)
  v_mfma_f32_32x32x16_bf16 v[64:79], v[100:103], v[96:99], 0
  v_mfma_f32_32x32x16_bf16 v[80:95], v[104:107], v[96:99], 0
  ds_read_b128 v[96:99], v188
  ds_read_b128 v[100:103], v192 offset:0
  ds_read_b128 v[104:107], v192 offset:4096
  s_waitcnt lgkmcnt(3)
  v_mfma_f32_32x32x16_bf16 v[64:79], v[112:115], v[108:111], v[64:79]
  v_mfma_f32_32x32x16_bf16 v[80:95], v[116:119], v[108:111], v[80:95]
  ds_read_b128 v[108:111], v189
  ds_read_b128 v[112:115], v193 offset:0
  ds_read_b128 v[116:119], v193 offset:4096
  s_waitcnt lgkmcnt(3)
  v_mfma_f32_32x32x16_bf16 v[64:79], v[100:103], v[96:99], v[64:79]
  v_fmac_f32 v0, v32, v124
  v_fmac_f32 v1, v33, v124
  v_fmac_f32 v2, v34, v124
  v_fmac_f32 v3, v35, v124
  v_mfma_f32_32x32x16_bf16 v[80:95], v[104:107], v[96:99], v[80:95]
  v_fmac_f32 v4, v36, v124
  v_fmac_f32 v5, v37, v124
  v_fmac_f32 v6, v38, v124
  v_fmac_f32 v7, v39, v124
  s_waitcnt lgkmcnt(0)
  s_waitcnt vmcnt(12)
  s_barrier
  v_add_u32 v186, 24576, v178
  v_add_u32 v190, 24576, v182
  v_add_u32 v187, 24576, v179
  v_add_u32 v191, 24576, v183
  v_add_u32 v188, 24576, v180
  v_add_u32 v192, 24576, v184
  v_add_u32 v189, 24576, v181
  v_add_u32 v193, 24576, v185
  ds_read_b128 v[96:99], v186
  ds_read_b128 v[100:103], v190 offset:0
  ds_read_b128 v[104:107], v190 offset:4096
  v_mfma_f32_32x32x16_bf16 v[64:79], v[112:115], v[108:111], v[64:79]
  s_add_u32 m0, s51, 98304
  s_add_u32 s56, s49, 1792
  buffer_load_dwordx4 v176, s[20:23], s56 offen lds
  s_add_u32 m0, s51, 99328
  s_add_u32 s56, s49, 19200
  buffer_load_dwordx4 v177, s[20:23], s56 offen lds
  s_add_u32 m0, s52, 98304
  s_add_u32 s56, s50, 1792
  buffer_load_dwordx4 v176, s[28:31], s56 offen lds
  v_fmac_f32 v8, v40, v124
  v_fmac_f32 v9, v41, v124
  v_fmac_f32 v10, v42, v124
  v_fmac_f32 v11, v43, v124
  v_mfma_f32_32x32x16_bf16 v[80:95], v[116:119], v[108:111], v[80:95]
  s_add_u32 m0, s52, 99328
  s_add_u32 s56, s50, 19200
  buffer_load_dwordx4 v177, s[28:31], s56 offen lds
  s_add_u32 m0, s52, 100352
  s_add_u32 s56, s50, 36608
  buffer_load_dwordx4 v176, s[28:31], s56 offen lds
  s_add_u32 m0, s52, 101376
  s_add_u32 s56, s50, 54016
  buffer_load_dwordx4 v177, s[28:31], s56 offen lds
  v_fmac_f32 v12, v44, v124
  v_fmac_f32 v13, v45, v124
  v_fmac_f32 v14, v46, v124
  v_fmac_f32 v15, v47, v124
  ds_read_b128 v[108:111], v187
  ds_read_b128 v[112:115], v191 offset:0
  ds_read_b128 v[116:119], v191 offset:4096
  s_waitcnt lgkmcnt(3)
  v_mfma_f32_32x32x16_bf16 v[64:79], v[100:103], v[96:99], v[64:79]
  v_fmac_f32 v16, v48, v124
  v_fmac_f32 v17, v49, v124
  v_fmac_f32 v18, v50, v124
  v_fmac_f32 v19, v51, v124
  v_mfma_f32_32x32x16_bf16 v[80:95], v[104:107], v[96:99], v[80:95]
  v_fmac_f32 v20, v52, v124
  v_fmac_f32 v21, v53, v124
  v_fmac_f32 v22, v54, v124
  v_fmac_f32 v23, v55, v124
  ds_read_b128 v[96:99], v188
  ds_read_b128 v[100:103], v192 offset:0
  ds_read_b128 v[104:107], v192 offset:4096
  s_waitcnt lgkmcnt(3)
  v_mfma_f32_32x32x16_bf16 v[64:79], v[112:115], v[108:111], v[64:79]
  v_fmac_f32 v24, v56, v124
  v_fmac_f32 v25, v57, v124
  v_fmac_f32 v26, v58, v124
  v_fmac_f32 v27, v59, v124
  v_mfma_f32_32x32x16_bf16 v[80:95], v[116:119], v[108:111], v[80:95]
  v_fmac_f32 v28, v60, v124
  v_fmac_f32 v29, v61, v124
  v_fmac_f32 v30, v62, v124
  v_fmac_f32 v31, v63, v124
  ds_read_b128 v[108:111], v189
  ds_read_b128 v[112:115], v193 offset:0
  ds_read_b128 v[116:119], v193 offset:4096
  s_waitcnt lgkmcnt(3)
  v_mfma_f32_32x32x16_bf16 v[64:79], v[100:103], v[96:99], v[64:79]
  v_mfma_f32_32x32x16_bf16 v[80:95], v[104:107], v[96:99], v[80:95]
  s_waitcnt lgkmcnt(0)
  s_waitcnt vmcnt(12)
  s_barrier
  v_add_u32 v186, 49152, v178
  v_add_u32 v190, 49152, v182
  v_add_u32 v187, 49152, v179
  v_add_u32 v191, 49152, v183
  v_add_u32 v188, 49152, v180
  v_add_u32 v192, 49152, v184
  v_add_u32 v189, 49152, v181
  v_add_u32 v193, 49152, v185
  ds_read_b128 v[96:99], v186
  ds_read_b128 v[100:103], v190 offset:0
  ds_read_b128 v[104:107], v190 offset:4096
  v_mfma_f32_32x32x16_bf16 v[64:79], v[112:115], v[108:111], v[64:79]
  s_add_u32 m0, s51, 0
  s_add_u32 s56, s49, 1920
  buffer_load_dwordx4 v176, s[20:23], s56 offen lds
  s_add_u32 m0, s51, 1024
  s_add_u32 s56, s49, 19328
  buffer_load_dwordx4 v177, s[20:23], s56 offen lds
  s_add_u32 m0, s52, 0
  s_add_u32 s56, s50, 1920
  buffer_load_dwordx4 v176, s[28:31], s56 offen lds
  v_mfma_f32_32x32x16_bf16 v[80:95], v[116:119], v[108:111], v[80:95]
  s_add_u32 m0, s52, 1024
  s_add_u32 s56, s50, 19328
  buffer_load_dwordx4 v177, s[28:31], s56 offen lds
  s_add_u32 m0, s52, 2048
  s_add_u32 s56, s50, 36736
  buffer_load_dwordx4 v176, s[28:31], s56 offen lds
  s_add_u32 m0, s52, 3072
  s_add_u32 s56, s50, 54144
  buffer_load_dwordx4 v177, s[28:31], s56 offen lds
  ds_read_b128 v[108:111], v187
  ds_read_b128 v[112:115], v191 offset:0
  ds_read_b128 v[116:119], v191 offset:4096
  s_waitcnt lgkmcnt(3)
  v_mfma_f32_32x32x16_bf16 v[32:47], v[100:103], v[96:99], 0
  v_mfma_f32_32x32x16_bf16 v[48:63], v[104:107], v[96:99], 0
  ds_read_b128 v[96:99], v188
  ds_read_b128 v[100:103], v192 offset:0
  ds_read_b128 v[104:107], v192 offset:4096
  s_waitcnt lgkmcnt(3)
  v_mfma_f32_32x32x16_bf16 v[32:47], v[112:115], v[108:111], v[32:47]
  v_mfma_f32_32x32x16_bf16 v[48:63], v[116:119], v[108:111], v[48:63]
  ds_read_b128 v[108:111], v189
  ds_read_b128 v[112:115], v193 offset:0
  ds_read_b128 v[116:119], v193 offset:4096
  s_waitcnt lgkmcnt(3)
  v_mfma_f32_32x32x16_bf16 v[32:47], v[100:103], v[96:99], v[32:47]
  v_fmac_f32 v0, v64, v125
  v_fmac_f32 v1, v65, v125
  v_fmac_f32 v2, v66, v125
  v_fmac_f32 v3, v67, v125
  v_mfma_f32_32x32x16_bf16 v[48:63], v[104:107], v[96:99], v[48:63]
  v_fmac_f32 v4, v68, v125
  v_fmac_f32 v5, v69, v125
  v_fmac_f32 v6, v70, v125
  v_fmac_f32 v7, v71, v125
  s_waitcnt lgkmcnt(0)
  s_waitcnt vmcnt(12)
  s_barrier
  v_add_u32 v186, 73728, v178
  v_add_u32 v190, 73728, v182
  v_add_u32 v187, 73728, v179
  v_add_u32 v191, 73728, v183
  v_add_u32 v188, 73728, v180
  v_add_u32 v192, 73728, v184
  v_add_u32 v189, 73728, v181
  v_add_u32 v193, 73728, v185
  ds_read_b128 v[96:99], v186
  ds_read_b128 v[100:103], v190 offset:0
  ds_read_b128 v[104:107], v190 offset:4096
  v_mfma_f32_32x32x16_bf16 v[32:47], v[112:115], v[108:111], v[32:47]
  s_add_u32 m0, s51, 24576
  s_add_u32 s56, s49, 2048
  buffer_load_dwordx4 v176, s[20:23], s56 offen lds
  s_add_u32 m0, s51, 25600
  s_add_u32 s56, s49, 19456
  buffer_load_dwordx4 v177, s[20:23], s56 offen lds
  s_add_u32 m0, s52, 24576
  s_add_u32 s56, s50, 2048
  buffer_load_dwordx4 v176, s[28:31], s56 offen lds
  v_fmac_f32 v8, v72, v125
  v_fmac_f32 v9, v73, v125
  v_fmac_f32 v10, v74, v125
  v_fmac_f32 v11, v75, v125
  v_mfma_f32_32x32x16_bf16 v[48:63], v[116:119], v[108:111], v[48:63]
  s_add_u32 m0, s52, 25600
  s_add_u32 s56, s50, 19456
  buffer_load_dwordx4 v177, s[28:31], s56 offen lds
  s_add_u32 m0, s52, 26624
  s_add_u32 s56, s50, 36864
  buffer_load_dwordx4 v176, s[28:31], s56 offen lds
  s_add_u32 m0, s52, 27648
  s_add_u32 s56, s50, 54272
  buffer_load_dwordx4 v177, s[28:31], s56 offen lds
  v_fmac_f32 v12, v76, v125
  v_fmac_f32 v13, v77, v125
  v_fmac_f32 v14, v78, v125
  v_fmac_f32 v15, v79, v125
  ds_read_b128 v[108:111], v187
  ds_read_b128 v[112:115], v191 offset:0
  ds_read_b128 v[116:119], v191 offset:4096
  s_waitcnt lgkmcnt(3)
  v_mfma_f32_32x32x16_bf16 v[32:47], v[100:103], v[96:99], v[32:47]
  v_fmac_f32 v16, v80, v125
  v_fmac_f32 v17, v81, v125
  v_fmac_f32 v18, v82, v125
  v_fmac_f32 v19, v83, v125
  v_mfma_f32_32x32x16_bf16 v[48:63], v[104:107], v[96:99], v[48:63]
  v_fmac_f32 v20, v84, v125
  v_fmac_f32 v21, v85, v125
  v_fmac_f32 v22, v86, v125
  v_fmac_f32 v23, v87, v125
  ds_read_b128 v[96:99], v188
  ds_read_b128 v[100:103], v192 offset:0
  ds_read_b128 v[104:107], v192 offset:4096
  s_waitcnt lgkmcnt(3)
  v_mfma_f32_32x32x16_bf16 v[32:47], v[112:115], v[108:111], v[32:47]
  v_fmac_f32 v24, v88, v125
  v_fmac_f32 v25, v89, v125
  v_fmac_f32 v26, v90, v125
  v_fmac_f32 v27, v91, v125
  v_mfma_f32_32x32x16_bf16 v[48:63], v[116:119], v[108:111], v[48:63]
  v_fmac_f32 v28, v92, v125
  v_fmac_f32 v29, v93, v125
  v_fmac_f32 v30, v94, v125
  v_fmac_f32 v31, v95, v125
  ds_read_b128 v[108:111], v189
  ds_read_b128 v[112:115], v193 offset:0
  ds_read_b128 v[116:119], v193 offset:4096
  s_waitcnt lgkmcnt(3)
  v_mfma_f32_32x32x16_bf16 v[32:47], v[100:103], v[96:99], v[32:47]
  v_mfma_f32_32x32x16_bf16 v[48:63], v[104:107], v[96:99], v[48:63]
  s_waitcnt lgkmcnt(0)
  s_waitcnt vmcnt(12)
  s_barrier
  v_add_u32 v186, 98304, v178
  v_add_u32 v190, 98304, v182
  v_add_u32 v187, 98304, v179
  v_add_u32 v191, 98304, v183
  v_add_u32 v188, 98304, v180
  v_add_u32 v192, 98304, v184
  v_add_u32 v189, 98304, v181
  v_add_u32 v193, 98304, v185
  ds_read_b128 v[96:99], v186
  ds_read_b128 v[100:103], v190 offset:0
  ds_read_b128 v[104:107], v190 offset:4096
  v_mfma_f32_32x32x16_bf16 v[32:47], v[112:115], v[108:111], v[32:47]
  buffer_load_dwordx4 v[128:131], v205, s[32:35], s57 offen offset:0
  buffer_load_dwordx4 v[132:135], v205, s[32:35], s57 offen offset:32
  buffer_load_dwordx4 v[136:139], v205, s[32:35], s57 offen offset:64
  buffer_load_dwordx4 v[140:143], v205, s[32:35], s57 offen offset:96
  s_mul_i32 s53, s44, 3072
  s_lshl_b32 s54, s57, 1
  s_add_u32 s53, s53, s54
  s_add_u32 s53, s53, 196608
  v_lshlrev_b32 v208, 5, v196
  v_mfma_f32_32x32x16_bf16 v[48:63], v[116:119], v[108:111], v[48:63]
  buffer_load_dwordx4 v[144:147], v208, s[16:19], s53 offen offset:0
  buffer_load_dwordx4 v[148:151], v208, s[16:19], s53 offen offset:16
  buffer_load_dwordx4 v[152:155], v208, s[16:19], s53 offen offset:64
  buffer_load_dwordx4 v[156:159], v208, s[16:19], s53 offen offset:80
  buffer_load_dwordx4 v[160:163], v208, s[16:19], s53 offen offset:128
  buffer_load_dwordx4 v[164:167], v208, s[16:19], s53 offen offset:144
  buffer_load_dwordx4 v[168:171], v208, s[16:19], s53 offen offset:192
  buffer_load_dwordx4 v[172:175], v208, s[16:19], s53 offen offset:208
  ds_read_b128 v[108:111], v187
  ds_read_b128 v[112:115], v191 offset:0
  ds_read_b128 v[116:119], v191 offset:4096
  s_waitcnt lgkmcnt(3)
  v_mfma_f32_32x32x16_bf16 v[64:79], v[100:103], v[96:99], 0
  v_mfma_f32_32x32x16_bf16 v[80:95], v[104:107], v[96:99], 0
  ds_read_b128 v[96:99], v188
  ds_read_b128 v[100:103], v192 offset:0
  ds_read_b128 v[104:107], v192 offset:4096
  s_waitcnt lgkmcnt(3)
  v_mfma_f32_32x32x16_bf16 v[64:79], v[112:115], v[108:111], v[64:79]
  v_mfma_f32_32x32x16_bf16 v[80:95], v[116:119], v[108:111], v[80:95]
  ds_read_b128 v[108:111], v189
  ds_read_b128 v[112:115], v193 offset:0
  ds_read_b128 v[116:119], v193 offset:4096
  s_waitcnt lgkmcnt(3)
  v_mfma_f32_32x32x16_bf16 v[64:79], v[100:103], v[96:99], v[64:79]
  v_fmac_f32 v0, v32, v126
  v_fmac_f32 v1, v33, v126
  v_fmac_f32 v2, v34, v126
  v_fmac_f32 v3, v35, v126
  v_mfma_f32_32x32x16_bf16 v[80:95], v[104:107], v[96:99], v[80:95]
  v_fmac_f32 v4, v36, v126
  v_fmac_f32 v5, v37, v126
  v_fmac_f32 v6, v38, v126
  v_fmac_f32 v7, v39, v126
  s_waitcnt lgkmcnt(0)
  s_waitcnt vmcnt(18)
  s_barrier
  v_add_u32 v186, 0, v178
  v_add_u32 v190, 0, v182
  v_add_u32 v187, 0, v179
  v_add_u32 v191, 0, v183
  v_add_u32 v188, 0, v180
  v_add_u32 v192, 0, v184
  v_add_u32 v189, 0, v181
  v_add_u32 v193, 0, v185
  ds_read_b128 v[96:99], v186
  ds_read_b128 v[100:103], v190 offset:0
  ds_read_b128 v[104:107], v190 offset:4096
  v_mfma_f32_32x32x16_bf16 v[64:79], v[112:115], v[108:111], v[64:79]
  v_fmac_f32 v8, v40, v126
  v_fmac_f32 v9, v41, v126
  v_fmac_f32 v10, v42, v126
  v_fmac_f32 v11, v43, v126
  v_mfma_f32_32x32x16_bf16 v[80:95], v[116:119], v[108:111], v[80:95]
  v_fmac_f32 v12, v44, v126
  v_fmac_f32 v13, v45, v126
  v_fmac_f32 v14, v46, v126
  v_fmac_f32 v15, v47, v126
  ds_read_b128 v[108:111], v187
  ds_read_b128 v[112:115], v191 offset:0
  ds_read_b128 v[116:119], v191 offset:4096
  s_waitcnt lgkmcnt(3)
  v_mfma_f32_32x32x16_bf16 v[64:79], v[100:103], v[96:99], v[64:79]
  v_fmac_f32 v16, v48, v126
  v_fmac_f32 v17, v49, v126
  v_fmac_f32 v18, v50, v126
  v_fmac_f32 v19, v51, v126
  v_mfma_f32_32x32x16_bf16 v[80:95], v[104:107], v[96:99], v[80:95]
  v_fmac_f32 v20, v52, v126
  v_fmac_f32 v21, v53, v126
  v_fmac_f32 v22, v54, v126
  v_fmac_f32 v23, v55, v126
  ds_read_b128 v[96:99], v188
  ds_read_b128 v[100:103], v192 offset:0
  ds_read_b128 v[104:107], v192 offset:4096
  s_waitcnt lgkmcnt(3)
  v_mfma_f32_32x32x16_bf16 v[64:79], v[112:115], v[108:111], v[64:79]
  v_fmac_f32 v24, v56, v126
  v_fmac_f32 v25, v57, v126
  v_fmac_f32 v26, v58, v126
  v_fmac_f32 v27, v59, v126
  v_mfma_f32_32x32x16_bf16 v[80:95], v[116:119], v[108:111], v[80:95]
  v_fmac_f32 v28, v60, v126
  v_fmac_f32 v29, v61, v126
  v_fmac_f32 v30, v62, v126
  v_fmac_f32 v31, v63, v126
  ds_read_b128 v[108:111], v189
  ds_read_b128 v[112:115], v193 offset:0
  ds_read_b128 v[116:119], v193 offset:4096
  s_waitcnt lgkmcnt(3)
  v_mfma_f32_32x32x16_bf16 v[64:79], v[100:103], v[96:99], v[64:79]
  v_mfma_f32_32x32x16_bf16 v[80:95], v[104:107], v[96:99], v[80:95]
  s_waitcnt lgkmcnt(0)
  s_waitcnt vmcnt(12)
  s_barrier
  v_add_u32 v186, 24576, v178
  v_add_u32 v190, 24576, v182
  v_add_u32 v187, 24576, v179
  v_add_u32 v191, 24576, v183
  ds_read_b128 v[96:99], v186
  ds_read_b128 v[100:103], v190 offset:0
  ds_read_b128 v[104:107], v190 offset:4096
  v_mfma_f32_32x32x16_bf16 v[64:79], v[112:115], v[108:111], v[64:79]
  v_mfma_f32_32x32x16_bf16 v[80:95], v[116:119], v[108:111], v[80:95]
  ds_read_b128 v[108:111], v187
  ds_read_b128 v[112:115], v191 offset:0
  ds_read_b128 v[116:119], v191 offset:4096
  s_waitcnt lgkmcnt(3)
  v_mfma_f32_32x32x16_bf16 v[64:79], v[100:103], v[96:99], v[64:79]
  v_mfma_f32_32x32x16_bf16 v[80:95], v[104:107], v[96:99], v[80:95]
  s_waitcnt lgkmcnt(0)
  v_mfma_f32_32x32x16_bf16 v[64:79], v[112:115], v[108:111], v[64:79]
  v_mfma_f32_32x32x16_bf16 v[80:95], v[116:119], v[108:111], v[80:95]
  s_nop 15
  s_nop 7
  v_fmac_f32 v0, v64, v127
  v_fmac_f32 v1, v65, v127
  v_fmac_f32 v2, v66, v127
  v_fmac_f32 v3, v67, v127
  v_fmac_f32 v4, v68, v127
  v_fmac_f32 v5, v69, v127
  v_fmac_f32 v6, v70, v127
  v_fmac_f32 v7, v71, v127
  v_fmac_f32 v8, v72, v127
  v_fmac_f32 v9, v73, v127
  v_fmac_f32 v10, v74, v127
  v_fmac_f32 v11, v75, v127
  v_fmac_f32 v12, v76, v127
  v_fmac_f32 v13, v77, v127
  v_fmac_f32 v14, v78, v127
  v_fmac_f32 v15, v79, v127
  v_fmac_f32 v16, v80, v127
  v_fmac_f32 v17, v81, v127
  v_fmac_f32 v18, v82, v127
  v_fmac_f32 v19, v83, v127
  v_fmac_f32 v20, v84, v127
  v_fmac_f32 v21, v85, v127
  v_fmac_f32 v22, v86, v127
  v_fmac_f32 v23, v87, v127
  v_fmac_f32 v24, v88, v127
  v_fmac_f32 v25, v89, v127
  v_fmac_f32 v26, v90, v127
  v_fmac_f32 v27, v91, v127
  v_fmac_f32 v28, v92, v127
  v_fmac_f32 v29, v93, v127
  v_fmac_f32 v30, v94, v127
  v_fmac_f32 v31, v95, v127
  s_waitcnt vmcnt(0)
  v_lshlrev_b32 v203, 16, v128
  v_and_b32 v204, 0xffff0000, v128
  v_fmac_f32 v203, v0, v144
  v_fmac_f32 v204, v1, v145
  v_cvt_pk_bf16_f32 v128, v203, v204
  v_lshlrev_b32 v203, 16, v129
  v_and_b32 v204, 0xffff0000, v129
  v_fmac_f32 v203, v2, v146
  v_fmac_f32 v204, v3, v147
  v_cvt_pk_bf16_f32 v129, v203, v204
  v_lshlrev_b32 v203, 16, v130
  v_and_b32 v204, 0xffff0000, v130
  v_fmac_f32 v203, v4, v148
  v_fmac_f32 v204, v5, v149
  v_cvt_pk_bf16_f32 v130, v203, v204
  v_lshlrev_b32 v203, 16, v131
  v_and_b32 v204, 0xffff0000, v131
  v_fmac_f32 v203, v6, v150
  v_fmac_f32 v204, v7, v151
  v_cvt_pk_bf16_f32 v131, v203, v204
  buffer_store_dwordx4 v[128:131], v205, s[36:39], s57 offen offset:0
  v_lshlrev_b32 v203, 16, v132
  v_and_b32 v204, 0xffff0000, v132
  v_fmac_f32 v203, v8, v152
  v_fmac_f32 v204, v9, v153
  v_cvt_pk_bf16_f32 v132, v203, v204
  v_lshlrev_b32 v203, 16, v133
  v_and_b32 v204, 0xffff0000, v133
  v_fmac_f32 v203, v10, v154
  v_fmac_f32 v204, v11, v155
  v_cvt_pk_bf16_f32 v133, v203, v204
  v_lshlrev_b32 v203, 16, v134
  v_and_b32 v204, 0xffff0000, v134
  v_fmac_f32 v203, v12, v156
  v_fmac_f32 v204, v13, v157
  v_cvt_pk_bf16_f32 v134, v203, v204
  v_lshlrev_b32 v203, 16, v135
  v_and_b32 v204, 0xffff0000, v135
  v_fmac_f32 v203, v14, v158
  v_fmac_f32 v204, v15, v159
  v_cvt_pk_bf16_f32 v135, v203, v204
  buffer_store_dwordx4 v[132:135], v205, s[36:39], s57 offen offset:32
  v_lshlrev_b32 v203, 16, v136
  v_and_b32 v204, 0xffff0000, v136
  v_fmac_f32 v203, v16, v160
  v_fmac_f32 v204, v17, v161
  v_cvt_pk_bf16_f32 v136, v203, v204
  v_lshlrev_b32 v203, 16, v137
  v_and_b32 v204, 0xffff0000, v137
  v_fmac_f32 v203, v18, v162
  v_fmac_f32 v204, v19, v163
  v_cvt_pk_bf16_f32 v137, v203, v204
  v_lshlrev_b32 v203, 16, v138
  v_and_b32 v204, 0xffff0000, v138
  v_fmac_f32 v203, v20, v164
  v_fmac_f32 v204, v21, v165
  v_cvt_pk_bf16_f32 v138, v203, v204
  v_lshlrev_b32 v203, 16, v139
  v_and_b32 v204, 0xffff0000, v139
  v_fmac_f32 v203, v22, v166
  v_fmac_f32 v204, v23, v167
  v_cvt_pk_bf16_f32 v139, v203, v204
  buffer_store_dwordx4 v[136:139], v205, s[36:39], s57 offen offset:64
  v_lshlrev_b32 v203, 16, v140
  v_and_b32 v204, 0xffff0000, v140
  v_fmac_f32 v203, v24, v168
  v_fmac_f32 v204, v25, v169
  v_cvt_pk_bf16_f32 v140, v203, v204
  v_lshlrev_b32 v203, 16, v141
  v_and_b32 v204, 0xffff0000, v141
  v_fmac_f32 v203, v26, v170
  v_fmac_f32 v204, v27, v171
  v_cvt_pk_bf16_f32 v141, v203, v204
  v_lshlrev_b32 v203, 16, v142
  v_and_b32 v204, 0xffff0000, v142
  v_fmac_f32 v203, v28, v172
  v_fmac_f32 v204, v29, v173
  v_cvt_pk_bf16_f32 v142, v203, v204
  v_lshlrev_b32 v203, 16, v143
  v_and_b32 v204, 0xffff0000, v143
  v_fmac_f32 v203, v30, v174
  v_fmac_f32 v204, v31, v175
  v_cvt_pk_bf16_f32 v143, v203, v204
  buffer_store_dwordx4 v[140:143], v205, s[36:39], s57 offen offset:96
  s_endpgm
K4_txt:
  s_and_b32 s57, s57, 3
  s_lshl_b32 s57, s57, 3
  s_add_u32 s57, s57, s58
  s_sub_u32 s57, s57, 24
  s_lshr_b32 s41, s57, 4
  s_and_b32 s42, s57, 15
  s_waitcnt lgkmcnt(0)

  s_mov_b32 s16, s12
  s_mov_b32 s17, s13
  s_mov_b32 s18, 1048576
  s_mov_b32 s19, 0x00020000
  s_mov_b32 s20, s10
  s_mov_b32 s21, s11
  s_mov_b32 s22, 1179648
  s_mov_b32 s23, 0x00020000
  s_add_u32 s24, s12, 33554432
  s_addc_u32 s25, s13, 0
  s_mov_b32 s26, 8192
  s_mov_b32 s27, 0x00020000
  s_add_u32 s28, s12, 34603008
  s_addc_u32 s29, s13, 0
  s_mov_b32 s30, 1081344
  s_mov_b32 s31, 0x00020000
  s_mov_b32 s32, s6
  s_mov_b32 s33, s7
  s_mov_b32 s34, 98304
  s_mov_b32 s35, 0x00020000
  s_add_u32 s36, s8, 3145728
  s_addc_u32 s37, s9, 0
  s_mov_b32 s38, 98304
  s_mov_b32 s39, 0x00020000
  s_mul_i32 s45, s42, 96
  s_mul_i32 s46, s40, 1152
  v_add_u32 v2, s46, v194

  v_add_u32 v3, 0, v2
  v_mul_u32_u24 v4, 10923, v3
  v_lshrrev_b32 v4, 16, v4
  v_mul_u32_u24 v5, 6, v4
  v_sub_u32 v5, v3, v5
  v_mul_u32_u24 v4, 1536, v4
  v_lshl_add_u32 v4, v5, 4, v4
  s_mul_i32 s47, s40, 18432
  s_add_u32 m0, s47, 0
  s_nop 0
  buffer_load_dwordx4 v4, s[20:23], s45 offen lds

  v_add_u32 v3, 64, v2
  v_mul_u32_u24 v4, 10923, v3
  v_lshrrev_b32 v4, 16, v4
  v_mul_u32_u24 v5, 6, v4
  v_sub_u32 v5, v3, v5
  v_mul_u32_u24 v4, 1536, v4
  v_lshl_add_u32 v4, v5, 4, v4
  s_mul_i32 s47, s40, 18432
  s_add_u32 m0, s47, 1024
  s_nop 0
  buffer_load_dwordx4 v4, s[20:23], s45 offen lds

  v_add_u32 v3, 128, v2
  v_mul_u32_u24 v4, 10923, v3
  v_lshrrev_b32 v4, 16, v4
  v_mul_u32_u24 v5, 6, v4
  v_sub_u32 v5, v3, v5
  v_mul_u32_u24 v4, 1536, v4
  v_lshl_add_u32 v4, v5, 4, v4
  s_mul_i32 s47, s40, 18432
  s_add_u32 m0, s47, 2048
  s_nop 0
  buffer_load_dwordx4 v4, s[20:23], s45 offen lds

  v_add_u32 v3, 192, v2
  v_mul_u32_u24 v4, 10923, v3
  v_lshrrev_b32 v4, 16, v4
  v_mul_u32_u24 v5, 6, v4
  v_sub_u32 v5, v3, v5
  v_mul_u32_u24 v4, 1536, v4
  v_lshl_add_u32 v4, v5, 4, v4
  s_mul_i32 s47, s40, 18432
  s_add_u32 m0, s47, 3072
  s_nop 0
  buffer_load_dwordx4 v4, s[20:23], s45 offen lds

  v_add_u32 v3, 256, v2
  v_mul_u32_u24 v4, 10923, v3
  v_lshrrev_b32 v4, 16, v4
  v_mul_u32_u24 v5, 6, v4
  v_sub_u32 v5, v3, v5
  v_mul_u32_u24 v4, 1536, v4
  v_lshl_add_u32 v4, v5, 4, v4
  s_mul_i32 s47, s40, 18432
  s_add_u32 m0, s47, 4096
  s_nop 0
  buffer_load_dwordx4 v4, s[20:23], s45 offen lds

  v_add_u32 v3, 320, v2
  v_mul_u32_u24 v4, 10923, v3
  v_lshrrev_b32 v4, 16, v4
  v_mul_u32_u24 v5, 6, v4
  v_sub_u32 v5, v3, v5
  v_mul_u32_u24 v4, 1536, v4
  v_lshl_add_u32 v4, v5, 4, v4
  s_mul_i32 s47, s40, 18432
  s_add_u32 m0, s47, 5120
  s_nop 0
  buffer_load_dwordx4 v4, s[20:23], s45 offen lds

  v_add_u32 v3, 384, v2
  v_mul_u32_u24 v4, 10923, v3
  v_lshrrev_b32 v4, 16, v4
  v_mul_u32_u24 v5, 6, v4
  v_sub_u32 v5, v3, v5
  v_mul_u32_u24 v4, 1536, v4
  v_lshl_add_u32 v4, v5, 4, v4
  s_mul_i32 s47, s40, 18432
  s_add_u32 m0, s47, 6144
  s_nop 0
  buffer_load_dwordx4 v4, s[20:23], s45 offen lds

  v_add_u32 v3, 448, v2
  v_mul_u32_u24 v4, 10923, v3
  v_lshrrev_b32 v4, 16, v4
  v_mul_u32_u24 v5, 6, v4
  v_sub_u32 v5, v3, v5
  v_mul_u32_u24 v4, 1536, v4
  v_lshl_add_u32 v4, v5, 4, v4
  s_mul_i32 s47, s40, 18432
  s_add_u32 m0, s47, 7168
  s_nop 0
  buffer_load_dwordx4 v4, s[20:23], s45 offen lds

  v_add_u32 v3, 512, v2
  v_mul_u32_u24 v4, 10923, v3
  v_lshrrev_b32 v4, 16, v4
  v_mul_u32_u24 v5, 6, v4
  v_sub_u32 v5, v3, v5
  v_mul_u32_u24 v4, 1536, v4
  v_lshl_add_u32 v4, v5, 4, v4
  s_mul_i32 s47, s40, 18432
  s_add_u32 m0, s47, 8192
  s_nop 0
  buffer_load_dwordx4 v4, s[20:23], s45 offen lds

  v_add_u32 v3, 576, v2
  v_mul_u32_u24 v4, 10923, v3
  v_lshrrev_b32 v4, 16, v4
  v_mul_u32_u24 v5, 6, v4
  v_sub_u32 v5, v3, v5
  v_mul_u32_u24 v4, 1536, v4
  v_lshl_add_u32 v4, v5, 4, v4
  s_mul_i32 s47, s40, 18432
  s_add_u32 m0, s47, 9216
  s_nop 0
  buffer_load_dwordx4 v4, s[20:23], s45 offen lds

  v_add_u32 v3, 640, v2
  v_mul_u32_u24 v4, 10923, v3
  v_lshrrev_b32 v4, 16, v4
  v_mul_u32_u24 v5, 6, v4
  v_sub_u32 v5, v3, v5
  v_mul_u32_u24 v4, 1536, v4
  v_lshl_add_u32 v4, v5, 4, v4
  s_mul_i32 s47, s40, 18432
  s_add_u32 m0, s47, 10240
  s_nop 0
  buffer_load_dwordx4 v4, s[20:23], s45 offen lds

  v_add_u32 v3, 704, v2
  v_mul_u32_u24 v4, 10923, v3
  v_lshrrev_b32 v4, 16, v4
  v_mul_u32_u24 v5, 6, v4
  v_sub_u32 v5, v3, v5
  v_mul_u32_u24 v4, 1536, v4
  v_lshl_add_u32 v4, v5, 4, v4
  s_mul_i32 s47, s40, 18432
  s_add_u32 m0, s47, 11264
  s_nop 0
  buffer_load_dwordx4 v4, s[20:23], s45 offen lds

  v_add_u32 v3, 768, v2
  v_mul_u32_u24 v4, 10923, v3
  v_lshrrev_b32 v4, 16, v4
  v_mul_u32_u24 v5, 6, v4
  v_sub_u32 v5, v3, v5
  v_mul_u32_u24 v4, 1536, v4
  v_lshl_add_u32 v4, v5, 4, v4
  s_mul_i32 s47, s40, 18432
  s_add_u32 m0, s47, 12288
  s_nop 0
  buffer_load_dwordx4 v4, s[20:23], s45 offen lds

  v_add_u32 v3, 832, v2
  v_mul_u32_u24 v4, 10923, v3
  v_lshrrev_b32 v4, 16, v4
  v_mul_u32_u24 v5, 6, v4
  v_sub_u32 v5, v3, v5
  v_mul_u32_u24 v4, 1536, v4
  v_lshl_add_u32 v4, v5, 4, v4
  s_mul_i32 s47, s40, 18432
  s_add_u32 m0, s47, 13312
  s_nop 0
  buffer_load_dwordx4 v4, s[20:23], s45 offen lds

  v_add_u32 v3, 896, v2
  v_mul_u32_u24 v4, 10923, v3
  v_lshrrev_b32 v4, 16, v4
  v_mul_u32_u24 v5, 6, v4
  v_sub_u32 v5, v3, v5
  v_mul_u32_u24 v4, 1536, v4
  v_lshl_add_u32 v4, v5, 4, v4
  s_mul_i32 s47, s40, 18432
  s_add_u32 m0, s47, 14336
  s_nop 0
  buffer_load_dwordx4 v4, s[20:23], s45 offen lds

  v_add_u32 v3, 960, v2
  v_mul_u32_u24 v4, 10923, v3
  v_lshrrev_b32 v4, 16, v4
  v_mul_u32_u24 v5, 6, v4
  v_sub_u32 v5, v3, v5
  v_mul_u32_u24 v4, 1536, v4
  v_lshl_add_u32 v4, v5, 4, v4
  s_mul_i32 s47, s40, 18432
  s_add_u32 m0, s47, 15360
  s_nop 0
  buffer_load_dwordx4 v4, s[20:23], s45 offen lds

  v_add_u32 v3, 1024, v2
  v_mul_u32_u24 v4, 10923, v3
  v_lshrrev_b32 v4, 16, v4
  v_mul_u32_u24 v5, 6, v4
  v_sub_u32 v5, v3, v5
  v_mul_u32_u24 v4, 1536, v4
  v_lshl_add_u32 v4, v5, 4, v4
  s_mul_i32 s47, s40, 18432
  s_add_u32 m0, s47, 16384
  s_nop 0
  buffer_load_dwordx4 v4, s[20:23], s45 offen lds

  v_add_u32 v3, 1088, v2
  v_mul_u32_u24 v4, 10923, v3
  v_lshrrev_b32 v4, 16, v4
  v_mul_u32_u24 v5, 6, v4
  v_sub_u32 v5, v3, v5
  v_mul_u32_u24 v4, 1536, v4
  v_lshl_add_u32 v4, v5, 4, v4
  s_mul_i32 s47, s40, 18432
  s_add_u32 m0, s47, 17408
  s_nop 0
  buffer_load_dwordx4 v4, s[20:23], s45 offen lds

  v_lshrrev_b32 v2, 4, v199
  v_and_b32 v3, 15, v199
  s_lshl_b32 s46, s44, 5
  s_lshl_b32 s47, s41, 4
  s_add_u32 s46, s46, s47
  v_add_u32 v4, s46, v2
  v_lshlrev_b32 v4, 7, v4

  buffer_load_dwordx4 v[128:131], v4, s[24:27], 0 offen offset:0
  buffer_load_dwordx4 v[132:135], v4, s[24:27], 0 offen offset:16
  buffer_load_dwordx4 v[136:139], v4, s[24:27], 0 offen offset:32
  buffer_load_dwordx4 v[140:143], v4, s[24:27], 0 offen offset:48
  buffer_load_dwordx4 v[144:147], v4, s[24:27], 0 offen offset:64
  buffer_load_dwordx4 v[148:151], v4, s[24:27], 0 offen offset:80
  s_mul_i32 s46, s44, 352
  s_lshl_b32 s47, s41, 4
  s_add_u32 s46, s46, s47
  v_add_u32 v5, s46, v2
  v_mul_u32_u24 v5, 1536, v5
  v_lshl_add_u32 v5, v3, 4, v5

  s_mov_b32 s47, 0
  buffer_load_dwordx4 v[32:35], v5, s[28:31], s47 offen offset:0
  buffer_load_dwordx4 v[36:39], v5, s[28:31], s47 offen offset:256
  buffer_load_dwordx4 v[40:43], v5, s[28:31], s47 offen offset:512
  buffer_load_dwordx4 v[44:47], v5, s[28:31], s47 offen offset:768
  buffer_load_dwordx4 v[48:51], v5, s[28:31], s47 offen offset:1024
  buffer_load_dwordx4 v[52:55], v5, s[28:31], s47 offen offset:1280
  s_mov_b32 s47, 49152
  buffer_load_dwordx4 v[56:59], v5, s[28:31], s47 offen offset:0
  buffer_load_dwordx4 v[60:63], v5, s[28:31], s47 offen offset:256
  buffer_load_dwordx4 v[64:67], v5, s[28:31], s47 offen offset:512
  buffer_load_dwordx4 v[68:71], v5, s[28:31], s47 offen offset:768
  buffer_load_dwordx4 v[72:75], v5, s[28:31], s47 offen offset:1024
  buffer_load_dwordx4 v[76:79], v5, s[28:31], s47 offen offset:1280
  s_waitcnt vmcnt(12)
  v_max3_f32 v6, v128, v130, v132
  v_max3_f32 v6, v6, v134, v136
  v_max3_f32 v6, v6, v138, v140
  v_max3_f32 v6, v6, v142, v144
  v_max3_f32 v6, v6, v146, v148
  v_sub_f32 v8, v128, v6
  v_sub_f32 v9, v130, v6
  v_sub_f32 v10, v132, v6
  v_sub_f32 v11, v134, v6
  v_sub_f32 v12, v136, v6
  v_sub_f32 v13, v138, v6
  v_sub_f32 v14, v140, v6
  v_sub_f32 v15, v142, v6
  v_sub_f32 v16, v144, v6
  v_sub_f32 v17, v146, v6
  v_sub_f32 v18, v148, v6
  v_exp_f32 v8, v8
  v_exp_f32 v9, v9
  v_exp_f32 v10, v10
  v_exp_f32 v11, v11
  v_exp_f32 v12, v12
  v_exp_f32 v13, v13
  v_exp_f32 v14, v14
  v_exp_f32 v15, v15
  v_exp_f32 v16, v16
  v_exp_f32 v17, v17
  v_exp_f32 v18, v18
  s_nop 0
  v_mul_f32 v7, v8, v129
  v_fmac_f32 v7, v9, v131
  v_fmac_f32 v7, v10, v133
  v_fmac_f32 v7, v11, v135
  v_fmac_f32 v7, v12, v137
  v_fmac_f32 v7, v13, v139
  v_fmac_f32 v7, v14, v141
  v_fmac_f32 v7, v15, v143
  v_fmac_f32 v7, v16, v145
  v_fmac_f32 v7, v17, v147
  v_fmac_f32 v7, v18, v149
  v_rcp_f32 v7, v7
  s_nop 0
  v_mul_f32 v8, v8, v7
  v_mul_f32 v9, v9, v7
  v_mul_f32 v10, v10, v7
  v_mul_f32 v11, v11, v7
  v_mul_f32 v12, v12, v7
  v_mul_f32 v13, v13, v7
  v_mul_f32 v14, v14, v7
  v_mul_f32 v15, v15, v7
  v_mul_f32 v16, v16, v7
  v_mul_f32 v17, v17, v7
  v_mul_f32 v18, v18, v7
  s_waitcnt vmcnt(6)
  v_lshlrev_b32 v6, 16, v32
  v_and_b32 v7, 0xffff0000, v32
  v_mul_f32 v80, v6, v8
  v_mul_f32 v81, v7, v8
  v_lshlrev_b32 v6, 16, v33
  v_and_b32 v7, 0xffff0000, v33
  v_mul_f32 v82, v6, v8
  v_mul_f32 v83, v7, v8
  v_lshlrev_b32 v6, 16, v34
  v_and_b32 v7, 0xffff0000, v34
  v_mul_f32 v84, v6, v8
  v_mul_f32 v85, v7, v8
  v_lshlrev_b32 v6, 16, v35
  v_and_b32 v7, 0xffff0000, v35
  v_mul_f32 v86, v6, v8
  v_mul_f32 v87, v7, v8
  v_lshlrev_b32 v6, 16, v36
  v_and_b32 v7, 0xffff0000, v36
  v_mul_f32 v88, v6, v8
  v_mul_f32 v89, v7, v8
  v_lshlrev_b32 v6, 16, v37
  v_and_b32 v7, 0xffff0000, v37
  v_mul_f32 v90, v6, v8
  v_mul_f32 v91, v7, v8
  v_lshlrev_b32 v6, 16, v38
  v_and_b32 v7, 0xffff0000, v38
  v_mul_f32 v92, v6, v8
  v_mul_f32 v93, v7, v8
  v_lshlrev_b32 v6, 16, v39
  v_and_b32 v7, 0xffff0000, v39
  v_mul_f32 v94, v6, v8
  v_mul_f32 v95, v7, v8
  v_lshlrev_b32 v6, 16, v40
  v_and_b32 v7, 0xffff0000, v40
  v_mul_f32 v96, v6, v8
  v_mul_f32 v97, v7, v8
  v_lshlrev_b32 v6, 16, v41
  v_and_b32 v7, 0xffff0000, v41
  v_mul_f32 v98, v6, v8
  v_mul_f32 v99, v7, v8
  v_lshlrev_b32 v6, 16, v42
  v_and_b32 v7, 0xffff0000, v42
  v_mul_f32 v100, v6, v8
  v_mul_f32 v101, v7, v8
  v_lshlrev_b32 v6, 16, v43
  v_and_b32 v7, 0xffff0000, v43
  v_mul_f32 v102, v6, v8
  v_mul_f32 v103, v7, v8
  v_lshlrev_b32 v6, 16, v44
  v_and_b32 v7, 0xffff0000, v44
  v_mul_f32 v104, v6, v8
  v_mul_f32 v105, v7, v8
  v_lshlrev_b32 v6, 16, v45
  v_and_b32 v7, 0xffff0000, v45
  v_mul_f32 v106, v6, v8
  v_mul_f32 v107, v7, v8
  v_lshlrev_b32 v6, 16, v46
  v_and_b32 v7, 0xffff0000, v46
  v_mul_f32 v108, v6, v8
  v_mul_f32 v109, v7, v8
  v_lshlrev_b32 v6, 16, v47
  v_and_b32 v7, 0xffff0000, v47
  v_mul_f32 v110, v6, v8
  v_mul_f32 v111, v7, v8
  v_lshlrev_b32 v6, 16, v48
  v_and_b32 v7, 0xffff0000, v48
  v_mul_f32 v112, v6, v8
  v_mul_f32 v113, v7, v8
  v_lshlrev_b32 v6, 16, v49
  v_and_b32 v7, 0xffff0000, v49
  v_mul_f32 v114, v6, v8
  v_mul_f32 v115, v7, v8
  v_lshlrev_b32 v6, 16, v50
  v_and_b32 v7, 0xffff0000, v50
  v_mul_f32 v116, v6, v8
  v_mul_f32 v117, v7, v8
  v_lshlrev_b32 v6, 16, v51
  v_and_b32 v7, 0xffff0000, v51
  v_mul_f32 v118, v6, v8
  v_mul_f32 v119, v7, v8
  v_lshlrev_b32 v6, 16, v52
  v_and_b32 v7, 0xffff0000, v52
  v_mul_f32 v120, v6, v8
  v_mul_f32 v121, v7, v8
  v_lshlrev_b32 v6, 16, v53
  v_and_b32 v7, 0xffff0000, v53
  v_mul_f32 v122, v6, v8
  v_mul_f32 v123, v7, v8
  v_lshlrev_b32 v6, 16, v54
  v_and_b32 v7, 0xffff0000, v54
  v_mul_f32 v124, v6, v8
  v_mul_f32 v125, v7, v8
  v_lshlrev_b32 v6, 16, v55
  v_and_b32 v7, 0xffff0000, v55
  v_mul_f32 v126, v6, v8
  v_mul_f32 v127, v7, v8
  s_mov_b32 s47, 98304
  buffer_load_dwordx4 v[32:35], v5, s[28:31], s47 offen offset:0
  buffer_load_dwordx4 v[36:39], v5, s[28:31], s47 offen offset:256
  buffer_load_dwordx4 v[40:43], v5, s[28:31], s47 offen offset:512
  buffer_load_dwordx4 v[44:47], v5, s[28:31], s47 offen offset:768
  buffer_load_dwordx4 v[48:51], v5, s[28:31], s47 offen offset:1024
  buffer_load_dwordx4 v[52:55], v5, s[28:31], s47 offen offset:1280
  s_waitcnt vmcnt(6)
  v_lshlrev_b32 v6, 16, v56
  v_and_b32 v7, 0xffff0000, v56
  v_fmac_f32 v80, v6, v9
  v_fmac_f32 v81, v7, v9
  v_lshlrev_b32 v6, 16, v57
  v_and_b32 v7, 0xffff0000, v57
  v_fmac_f32 v82, v6, v9
  v_fmac_f32 v83, v7, v9
  v_lshlrev_b32 v6, 16, v58
  v_and_b32 v7, 0xffff0000, v58
  v_fmac_f32 v84, v6, v9
  v_fmac_f32 v85, v7, v9
  v_lshlrev_b32 v6, 16, v59
  v_and_b32 v7, 0xffff0000, v59
  v_fmac_f32 v86, v6, v9
  v_fmac_f32 v87, v7, v9
  v_lshlrev_b32 v6, 16, v60
  v_and_b32 v7, 0xffff0000, v60
  v_fmac_f32 v88, v6, v9
  v_fmac_f32 v89, v7, v9
  v_lshlrev_b32 v6, 16, v61
  v_and_b32 v7, 0xffff0000, v61
  v_fmac_f32 v90, v6, v9
  v_fmac_f32 v91, v7, v9
  v_lshlrev_b32 v6, 16, v62
  v_and_b32 v7, 0xffff0000, v62
  v_fmac_f32 v92, v6, v9
  v_fmac_f32 v93, v7, v9
  v_lshlrev_b32 v6, 16, v63
  v_and_b32 v7, 0xffff0000, v63
  v_fmac_f32 v94, v6, v9
  v_fmac_f32 v95, v7, v9
  v_lshlrev_b32 v6, 16, v64
  v_and_b32 v7, 0xffff0000, v64
  v_fmac_f32 v96, v6, v9
  v_fmac_f32 v97, v7, v9
  v_lshlrev_b32 v6, 16, v65
  v_and_b32 v7, 0xffff0000, v65
  v_fmac_f32 v98, v6, v9
  v_fmac_f32 v99, v7, v9
  v_lshlrev_b32 v6, 16, v66
  v_and_b32 v7, 0xffff0000, v66
  v_fmac_f32 v100, v6, v9
  v_fmac_f32 v101, v7, v9
  v_lshlrev_b32 v6, 16, v67
  v_and_b32 v7, 0xffff0000, v67
  v_fmac_f32 v102, v6, v9
  v_fmac_f32 v103, v7, v9
  v_lshlrev_b32 v6, 16, v68
  v_and_b32 v7, 0xffff0000, v68
  v_fmac_f32 v104, v6, v9
  v_fmac_f32 v105, v7, v9
  v_lshlrev_b32 v6, 16, v69
  v_and_b32 v7, 0xffff0000, v69
  v_fmac_f32 v106, v6, v9
  v_fmac_f32 v107, v7, v9
  v_lshlrev_b32 v6, 16, v70
  v_and_b32 v7, 0xffff0000, v70
  v_fmac_f32 v108, v6, v9
  v_fmac_f32 v109, v7, v9
  v_lshlrev_b32 v6, 16, v71
  v_and_b32 v7, 0xffff0000, v71
  v_fmac_f32 v110, v6, v9
  v_fmac_f32 v111, v7, v9
  v_lshlrev_b32 v6, 16, v72
  v_and_b32 v7, 0xffff0000, v72
  v_fmac_f32 v112, v6, v9
  v_fmac_f32 v113, v7, v9
  v_lshlrev_b32 v6, 16, v73
  v_and_b32 v7, 0xffff0000, v73
  v_fmac_f32 v114, v6, v9
  v_fmac_f32 v115, v7, v9
  v_lshlrev_b32 v6, 16, v74
  v_and_b32 v7, 0xffff0000, v74
  v_fmac_f32 v116, v6, v9
  v_fmac_f32 v117, v7, v9
  v_lshlrev_b32 v6, 16, v75
  v_and_b32 v7, 0xffff0000, v75
  v_fmac_f32 v118, v6, v9
  v_fmac_f32 v119, v7, v9
  v_lshlrev_b32 v6, 16, v76
  v_and_b32 v7, 0xffff0000, v76
  v_fmac_f32 v120, v6, v9
  v_fmac_f32 v121, v7, v9
  v_lshlrev_b32 v6, 16, v77
  v_and_b32 v7, 0xffff0000, v77
  v_fmac_f32 v122, v6, v9
  v_fmac_f32 v123, v7, v9
  v_lshlrev_b32 v6, 16, v78
  v_and_b32 v7, 0xffff0000, v78
  v_fmac_f32 v124, v6, v9
  v_fmac_f32 v125, v7, v9
  v_lshlrev_b32 v6, 16, v79
  v_and_b32 v7, 0xffff0000, v79
  v_fmac_f32 v126, v6, v9
  v_fmac_f32 v127, v7, v9
  s_mov_b32 s47, 147456
  buffer_load_dwordx4 v[56:59], v5, s[28:31], s47 offen offset:0
  buffer_load_dwordx4 v[60:63], v5, s[28:31], s47 offen offset:256
  buffer_load_dwordx4 v[64:67], v5, s[28:31], s47 offen offset:512
  buffer_load_dwordx4 v[68:71], v5, s[28:31], s47 offen offset:768
  buffer_load_dwordx4 v[72:75], v5, s[28:31], s47 offen offset:1024
  buffer_load_dwordx4 v[76:79], v5, s[28:31], s47 offen offset:1280
  s_waitcnt vmcnt(6)
  v_lshlrev_b32 v6, 16, v32
  v_and_b32 v7, 0xffff0000, v32
  v_fmac_f32 v80, v6, v10
  v_fmac_f32 v81, v7, v10
  v_lshlrev_b32 v6, 16, v33
  v_and_b32 v7, 0xffff0000, v33
  v_fmac_f32 v82, v6, v10
  v_fmac_f32 v83, v7, v10
  v_lshlrev_b32 v6, 16, v34
  v_and_b32 v7, 0xffff0000, v34
  v_fmac_f32 v84, v6, v10
  v_fmac_f32 v85, v7, v10
  v_lshlrev_b32 v6, 16, v35
  v_and_b32 v7, 0xffff0000, v35
  v_fmac_f32 v86, v6, v10
  v_fmac_f32 v87, v7, v10
  v_lshlrev_b32 v6, 16, v36
  v_and_b32 v7, 0xffff0000, v36
  v_fmac_f32 v88, v6, v10
  v_fmac_f32 v89, v7, v10
  v_lshlrev_b32 v6, 16, v37
  v_and_b32 v7, 0xffff0000, v37
  v_fmac_f32 v90, v6, v10
  v_fmac_f32 v91, v7, v10
  v_lshlrev_b32 v6, 16, v38
  v_and_b32 v7, 0xffff0000, v38
  v_fmac_f32 v92, v6, v10
  v_fmac_f32 v93, v7, v10
  v_lshlrev_b32 v6, 16, v39
  v_and_b32 v7, 0xffff0000, v39
  v_fmac_f32 v94, v6, v10
  v_fmac_f32 v95, v7, v10
  v_lshlrev_b32 v6, 16, v40
  v_and_b32 v7, 0xffff0000, v40
  v_fmac_f32 v96, v6, v10
  v_fmac_f32 v97, v7, v10
  v_lshlrev_b32 v6, 16, v41
  v_and_b32 v7, 0xffff0000, v41
  v_fmac_f32 v98, v6, v10
  v_fmac_f32 v99, v7, v10
  v_lshlrev_b32 v6, 16, v42
  v_and_b32 v7, 0xffff0000, v42
  v_fmac_f32 v100, v6, v10
  v_fmac_f32 v101, v7, v10
  v_lshlrev_b32 v6, 16, v43
  v_and_b32 v7, 0xffff0000, v43
  v_fmac_f32 v102, v6, v10
  v_fmac_f32 v103, v7, v10
  v_lshlrev_b32 v6, 16, v44
  v_and_b32 v7, 0xffff0000, v44
  v_fmac_f32 v104, v6, v10
  v_fmac_f32 v105, v7, v10
  v_lshlrev_b32 v6, 16, v45
  v_and_b32 v7, 0xffff0000, v45
  v_fmac_f32 v106, v6, v10
  v_fmac_f32 v107, v7, v10
  v_lshlrev_b32 v6, 16, v46
  v_and_b32 v7, 0xffff0000, v46
  v_fmac_f32 v108, v6, v10
  v_fmac_f32 v109, v7, v10
  v_lshlrev_b32 v6, 16, v47
  v_and_b32 v7, 0xffff0000, v47
  v_fmac_f32 v110, v6, v10
  v_fmac_f32 v111, v7, v10
  v_lshlrev_b32 v6, 16, v48
  v_and_b32 v7, 0xffff0000, v48
  v_fmac_f32 v112, v6, v10
  v_fmac_f32 v113, v7, v10
  v_lshlrev_b32 v6, 16, v49
  v_and_b32 v7, 0xffff0000, v49
  v_fmac_f32 v114, v6, v10
  v_fmac_f32 v115, v7, v10
  v_lshlrev_b32 v6, 16, v50
  v_and_b32 v7, 0xffff0000, v50
  v_fmac_f32 v116, v6, v10
  v_fmac_f32 v117, v7, v10
  v_lshlrev_b32 v6, 16, v51
  v_and_b32 v7, 0xffff0000, v51
  v_fmac_f32 v118, v6, v10
  v_fmac_f32 v119, v7, v10
  v_lshlrev_b32 v6, 16, v52
  v_and_b32 v7, 0xffff0000, v52
  v_fmac_f32 v120, v6, v10
  v_fmac_f32 v121, v7, v10
  v_lshlrev_b32 v6, 16, v53
  v_and_b32 v7, 0xffff0000, v53
  v_fmac_f32 v122, v6, v10
  v_fmac_f32 v123, v7, v10
  v_lshlrev_b32 v6, 16, v54
  v_and_b32 v7, 0xffff0000, v54
  v_fmac_f32 v124, v6, v10
  v_fmac_f32 v125, v7, v10
  v_lshlrev_b32 v6, 16, v55
  v_and_b32 v7, 0xffff0000, v55
  v_fmac_f32 v126, v6, v10
  v_fmac_f32 v127, v7, v10
  s_mov_b32 s47, 196608
  buffer_load_dwordx4 v[32:35], v5, s[28:31], s47 offen offset:0
  buffer_load_dwordx4 v[36:39], v5, s[28:31], s47 offen offset:256
  buffer_load_dwordx4 v[40:43], v5, s[28:31], s47 offen offset:512
  buffer_load_dwordx4 v[44:47], v5, s[28:31], s47 offen offset:768
  buffer_load_dwordx4 v[48:51], v5, s[28:31], s47 offen offset:1024
  buffer_load_dwordx4 v[52:55], v5, s[28:31], s47 offen offset:1280
  s_waitcnt vmcnt(6)
  v_lshlrev_b32 v6, 16, v56
  v_and_b32 v7, 0xffff0000, v56
  v_fmac_f32 v80, v6, v11
  v_fmac_f32 v81, v7, v11
  v_lshlrev_b32 v6, 16, v57
  v_and_b32 v7, 0xffff0000, v57
  v_fmac_f32 v82, v6, v11
  v_fmac_f32 v83, v7, v11
  v_lshlrev_b32 v6, 16, v58
  v_and_b32 v7, 0xffff0000, v58
  v_fmac_f32 v84, v6, v11
  v_fmac_f32 v85, v7, v11
  v_lshlrev_b32 v6, 16, v59
  v_and_b32 v7, 0xffff0000, v59
  v_fmac_f32 v86, v6, v11
  v_fmac_f32 v87, v7, v11
  v_lshlrev_b32 v6, 16, v60
  v_and_b32 v7, 0xffff0000, v60
  v_fmac_f32 v88, v6, v11
  v_fmac_f32 v89, v7, v11
  v_lshlrev_b32 v6, 16, v61
  v_and_b32 v7, 0xffff0000, v61
  v_fmac_f32 v90, v6, v11
  v_fmac_f32 v91, v7, v11
  v_lshlrev_b32 v6, 16, v62
  v_and_b32 v7, 0xffff0000, v62
  v_fmac_f32 v92, v6, v11
  v_fmac_f32 v93, v7, v11
  v_lshlrev_b32 v6, 16, v63
  v_and_b32 v7, 0xffff0000, v63
  v_fmac_f32 v94, v6, v11
  v_fmac_f32 v95, v7, v11
  v_lshlrev_b32 v6, 16, v64
  v_and_b32 v7, 0xffff0000, v64
  v_fmac_f32 v96, v6, v11
  v_fmac_f32 v97, v7, v11
  v_lshlrev_b32 v6, 16, v65
  v_and_b32 v7, 0xffff0000, v65
  v_fmac_f32 v98, v6, v11
  v_fmac_f32 v99, v7, v11
  v_lshlrev_b32 v6, 16, v66
  v_and_b32 v7, 0xffff0000, v66
  v_fmac_f32 v100, v6, v11
  v_fmac_f32 v101, v7, v11
  v_lshlrev_b32 v6, 16, v67
  v_and_b32 v7, 0xffff0000, v67
  v_fmac_f32 v102, v6, v11
  v_fmac_f32 v103, v7, v11
  v_lshlrev_b32 v6, 16, v68
  v_and_b32 v7, 0xffff0000, v68
  v_fmac_f32 v104, v6, v11
  v_fmac_f32 v105, v7, v11
  v_lshlrev_b32 v6, 16, v69
  v_and_b32 v7, 0xffff0000, v69
  v_fmac_f32 v106, v6, v11
  v_fmac_f32 v107, v7, v11
  v_lshlrev_b32 v6, 16, v70
  v_and_b32 v7, 0xffff0000, v70
  v_fmac_f32 v108, v6, v11
  v_fmac_f32 v109, v7, v11
  v_lshlrev_b32 v6, 16, v71
  v_and_b32 v7, 0xffff0000, v71
  v_fmac_f32 v110, v6, v11
  v_fmac_f32 v111, v7, v11
  v_lshlrev_b32 v6, 16, v72
  v_and_b32 v7, 0xffff0000, v72
  v_fmac_f32 v112, v6, v11
  v_fmac_f32 v113, v7, v11
  v_lshlrev_b32 v6, 16, v73
  v_and_b32 v7, 0xffff0000, v73
  v_fmac_f32 v114, v6, v11
  v_fmac_f32 v115, v7, v11
  v_lshlrev_b32 v6, 16, v74
  v_and_b32 v7, 0xffff0000, v74
  v_fmac_f32 v116, v6, v11
  v_fmac_f32 v117, v7, v11
  v_lshlrev_b32 v6, 16, v75
  v_and_b32 v7, 0xffff0000, v75
  v_fmac_f32 v118, v6, v11
  v_fmac_f32 v119, v7, v11
  v_lshlrev_b32 v6, 16, v76
  v_and_b32 v7, 0xffff0000, v76
  v_fmac_f32 v120, v6, v11
  v_fmac_f32 v121, v7, v11
  v_lshlrev_b32 v6, 16, v77
  v_and_b32 v7, 0xffff0000, v77
  v_fmac_f32 v122, v6, v11
  v_fmac_f32 v123, v7, v11
  v_lshlrev_b32 v6, 16, v78
  v_and_b32 v7, 0xffff0000, v78
  v_fmac_f32 v124, v6, v11
  v_fmac_f32 v125, v7, v11
  v_lshlrev_b32 v6, 16, v79
  v_and_b32 v7, 0xffff0000, v79
  v_fmac_f32 v126, v6, v11
  v_fmac_f32 v127, v7, v11
  s_mov_b32 s47, 245760
  buffer_load_dwordx4 v[56:59], v5, s[28:31], s47 offen offset:0
  buffer_load_dwordx4 v[60:63], v5, s[28:31], s47 offen offset:256
  buffer_load_dwordx4 v[64:67], v5, s[28:31], s47 offen offset:512
  buffer_load_dwordx4 v[68:71], v5, s[28:31], s47 offen offset:768
  buffer_load_dwordx4 v[72:75], v5, s[28:31], s47 offen offset:1024
  buffer_load_dwordx4 v[76:79], v5, s[28:31], s47 offen offset:1280
  s_waitcnt vmcnt(6)
  v_lshlrev_b32 v6, 16, v32
  v_and_b32 v7, 0xffff0000, v32
  v_fmac_f32 v80, v6, v12
  v_fmac_f32 v81, v7, v12
  v_lshlrev_b32 v6, 16, v33
  v_and_b32 v7, 0xffff0000, v33
  v_fmac_f32 v82, v6, v12
  v_fmac_f32 v83, v7, v12
  v_lshlrev_b32 v6, 16, v34
  v_and_b32 v7, 0xffff0000, v34
  v_fmac_f32 v84, v6, v12
  v_fmac_f32 v85, v7, v12
  v_lshlrev_b32 v6, 16, v35
  v_and_b32 v7, 0xffff0000, v35
  v_fmac_f32 v86, v6, v12
  v_fmac_f32 v87, v7, v12
  v_lshlrev_b32 v6, 16, v36
  v_and_b32 v7, 0xffff0000, v36
  v_fmac_f32 v88, v6, v12
  v_fmac_f32 v89, v7, v12
  v_lshlrev_b32 v6, 16, v37
  v_and_b32 v7, 0xffff0000, v37
  v_fmac_f32 v90, v6, v12
  v_fmac_f32 v91, v7, v12
  v_lshlrev_b32 v6, 16, v38
  v_and_b32 v7, 0xffff0000, v38
  v_fmac_f32 v92, v6, v12
  v_fmac_f32 v93, v7, v12
  v_lshlrev_b32 v6, 16, v39
  v_and_b32 v7, 0xffff0000, v39
  v_fmac_f32 v94, v6, v12
  v_fmac_f32 v95, v7, v12
  v_lshlrev_b32 v6, 16, v40
  v_and_b32 v7, 0xffff0000, v40
  v_fmac_f32 v96, v6, v12
  v_fmac_f32 v97, v7, v12
  v_lshlrev_b32 v6, 16, v41
  v_and_b32 v7, 0xffff0000, v41
  v_fmac_f32 v98, v6, v12
  v_fmac_f32 v99, v7, v12
  v_lshlrev_b32 v6, 16, v42
  v_and_b32 v7, 0xffff0000, v42
  v_fmac_f32 v100, v6, v12
  v_fmac_f32 v101, v7, v12
  v_lshlrev_b32 v6, 16, v43
  v_and_b32 v7, 0xffff0000, v43
  v_fmac_f32 v102, v6, v12
  v_fmac_f32 v103, v7, v12
  v_lshlrev_b32 v6, 16, v44
  v_and_b32 v7, 0xffff0000, v44
  v_fmac_f32 v104, v6, v12
  v_fmac_f32 v105, v7, v12
  v_lshlrev_b32 v6, 16, v45
  v_and_b32 v7, 0xffff0000, v45
  v_fmac_f32 v106, v6, v12
  v_fmac_f32 v107, v7, v12
  v_lshlrev_b32 v6, 16, v46
  v_and_b32 v7, 0xffff0000, v46
  v_fmac_f32 v108, v6, v12
  v_fmac_f32 v109, v7, v12
  v_lshlrev_b32 v6, 16, v47
  v_and_b32 v7, 0xffff0000, v47
  v_fmac_f32 v110, v6, v12
  v_fmac_f32 v111, v7, v12
  v_lshlrev_b32 v6, 16, v48
  v_and_b32 v7, 0xffff0000, v48
  v_fmac_f32 v112, v6, v12
  v_fmac_f32 v113, v7, v12
  v_lshlrev_b32 v6, 16, v49
  v_and_b32 v7, 0xffff0000, v49
  v_fmac_f32 v114, v6, v12
  v_fmac_f32 v115, v7, v12
  v_lshlrev_b32 v6, 16, v50
  v_and_b32 v7, 0xffff0000, v50
  v_fmac_f32 v116, v6, v12
  v_fmac_f32 v117, v7, v12
  v_lshlrev_b32 v6, 16, v51
  v_and_b32 v7, 0xffff0000, v51
  v_fmac_f32 v118, v6, v12
  v_fmac_f32 v119, v7, v12
  v_lshlrev_b32 v6, 16, v52
  v_and_b32 v7, 0xffff0000, v52
  v_fmac_f32 v120, v6, v12
  v_fmac_f32 v121, v7, v12
  v_lshlrev_b32 v6, 16, v53
  v_and_b32 v7, 0xffff0000, v53
  v_fmac_f32 v122, v6, v12
  v_fmac_f32 v123, v7, v12
  v_lshlrev_b32 v6, 16, v54
  v_and_b32 v7, 0xffff0000, v54
  v_fmac_f32 v124, v6, v12
  v_fmac_f32 v125, v7, v12
  v_lshlrev_b32 v6, 16, v55
  v_and_b32 v7, 0xffff0000, v55
  v_fmac_f32 v126, v6, v12
  v_fmac_f32 v127, v7, v12
  s_mov_b32 s47, 294912
  buffer_load_dwordx4 v[32:35], v5, s[28:31], s47 offen offset:0
  buffer_load_dwordx4 v[36:39], v5, s[28:31], s47 offen offset:256
  buffer_load_dwordx4 v[40:43], v5, s[28:31], s47 offen offset:512
  buffer_load_dwordx4 v[44:47], v5, s[28:31], s47 offen offset:768
  buffer_load_dwordx4 v[48:51], v5, s[28:31], s47 offen offset:1024
  buffer_load_dwordx4 v[52:55], v5, s[28:31], s47 offen offset:1280
  s_waitcnt vmcnt(6)
  v_lshlrev_b32 v6, 16, v56
  v_and_b32 v7, 0xffff0000, v56
  v_fmac_f32 v80, v6, v13
  v_fmac_f32 v81, v7, v13
  v_lshlrev_b32 v6, 16, v57
  v_and_b32 v7, 0xffff0000, v57
  v_fmac_f32 v82, v6, v13
  v_fmac_f32 v83, v7, v13
  v_lshlrev_b32 v6, 16, v58
  v_and_b32 v7, 0xffff0000, v58
  v_fmac_f32 v84, v6, v13
  v_fmac_f32 v85, v7, v13
  v_lshlrev_b32 v6, 16, v59
  v_and_b32 v7, 0xffff0000, v59
  v_fmac_f32 v86, v6, v13
  v_fmac_f32 v87, v7, v13
  v_lshlrev_b32 v6, 16, v60
  v_and_b32 v7, 0xffff0000, v60
  v_fmac_f32 v88, v6, v13
  v_fmac_f32 v89, v7, v13
  v_lshlrev_b32 v6, 16, v61
  v_and_b32 v7, 0xffff0000, v61
  v_fmac_f32 v90, v6, v13
  v_fmac_f32 v91, v7, v13
  v_lshlrev_b32 v6, 16, v62
  v_and_b32 v7, 0xffff0000, v62
  v_fmac_f32 v92, v6, v13
  v_fmac_f32 v93, v7, v13
  v_lshlrev_b32 v6, 16, v63
  v_and_b32 v7, 0xffff0000, v63
  v_fmac_f32 v94, v6, v13
  v_fmac_f32 v95, v7, v13
  v_lshlrev_b32 v6, 16, v64
  v_and_b32 v7, 0xffff0000, v64
  v_fmac_f32 v96, v6, v13
  v_fmac_f32 v97, v7, v13
  v_lshlrev_b32 v6, 16, v65
  v_and_b32 v7, 0xffff0000, v65
  v_fmac_f32 v98, v6, v13
  v_fmac_f32 v99, v7, v13
  v_lshlrev_b32 v6, 16, v66
  v_and_b32 v7, 0xffff0000, v66
  v_fmac_f32 v100, v6, v13
  v_fmac_f32 v101, v7, v13
  v_lshlrev_b32 v6, 16, v67
  v_and_b32 v7, 0xffff0000, v67
  v_fmac_f32 v102, v6, v13
  v_fmac_f32 v103, v7, v13
  v_lshlrev_b32 v6, 16, v68
  v_and_b32 v7, 0xffff0000, v68
  v_fmac_f32 v104, v6, v13
  v_fmac_f32 v105, v7, v13
  v_lshlrev_b32 v6, 16, v69
  v_and_b32 v7, 0xffff0000, v69
  v_fmac_f32 v106, v6, v13
  v_fmac_f32 v107, v7, v13
  v_lshlrev_b32 v6, 16, v70
  v_and_b32 v7, 0xffff0000, v70
  v_fmac_f32 v108, v6, v13
  v_fmac_f32 v109, v7, v13
  v_lshlrev_b32 v6, 16, v71
  v_and_b32 v7, 0xffff0000, v71
  v_fmac_f32 v110, v6, v13
  v_fmac_f32 v111, v7, v13
  v_lshlrev_b32 v6, 16, v72
  v_and_b32 v7, 0xffff0000, v72
  v_fmac_f32 v112, v6, v13
  v_fmac_f32 v113, v7, v13
  v_lshlrev_b32 v6, 16, v73
  v_and_b32 v7, 0xffff0000, v73
  v_fmac_f32 v114, v6, v13
  v_fmac_f32 v115, v7, v13
  v_lshlrev_b32 v6, 16, v74
  v_and_b32 v7, 0xffff0000, v74
  v_fmac_f32 v116, v6, v13
  v_fmac_f32 v117, v7, v13
  v_lshlrev_b32 v6, 16, v75
  v_and_b32 v7, 0xffff0000, v75
  v_fmac_f32 v118, v6, v13
  v_fmac_f32 v119, v7, v13
  v_lshlrev_b32 v6, 16, v76
  v_and_b32 v7, 0xffff0000, v76
  v_fmac_f32 v120, v6, v13
  v_fmac_f32 v121, v7, v13
  v_lshlrev_b32 v6, 16, v77
  v_and_b32 v7, 0xffff0000, v77
  v_fmac_f32 v122, v6, v13
  v_fmac_f32 v123, v7, v13
  v_lshlrev_b32 v6, 16, v78
  v_and_b32 v7, 0xffff0000, v78
  v_fmac_f32 v124, v6, v13
  v_fmac_f32 v125, v7, v13
  v_lshlrev_b32 v6, 16, v79
  v_and_b32 v7, 0xffff0000, v79
  v_fmac_f32 v126, v6, v13
  v_fmac_f32 v127, v7, v13
  s_mov_b32 s47, 344064
  buffer_load_dwordx4 v[56:59], v5, s[28:31], s47 offen offset:0
  buffer_load_dwordx4 v[60:63], v5, s[28:31], s47 offen offset:256
  buffer_load_dwordx4 v[64:67], v5, s[28:31], s47 offen offset:512
  buffer_load_dwordx4 v[68:71], v5, s[28:31], s47 offen offset:768
  buffer_load_dwordx4 v[72:75], v5, s[28:31], s47 offen offset:1024
  buffer_load_dwordx4 v[76:79], v5, s[28:31], s47 offen offset:1280
  s_waitcnt vmcnt(6)
  v_lshlrev_b32 v6, 16, v32
  v_and_b32 v7, 0xffff0000, v32
  v_fmac_f32 v80, v6, v14
  v_fmac_f32 v81, v7, v14
  v_lshlrev_b32 v6, 16, v33
  v_and_b32 v7, 0xffff0000, v33
  v_fmac_f32 v82, v6, v14
  v_fmac_f32 v83, v7, v14
  v_lshlrev_b32 v6, 16, v34
  v_and_b32 v7, 0xffff0000, v34
  v_fmac_f32 v84, v6, v14
  v_fmac_f32 v85, v7, v14
  v_lshlrev_b32 v6, 16, v35
  v_and_b32 v7, 0xffff0000, v35
  v_fmac_f32 v86, v6, v14
  v_fmac_f32 v87, v7, v14
  v_lshlrev_b32 v6, 16, v36
  v_and_b32 v7, 0xffff0000, v36
  v_fmac_f32 v88, v6, v14
  v_fmac_f32 v89, v7, v14
  v_lshlrev_b32 v6, 16, v37
  v_and_b32 v7, 0xffff0000, v37
  v_fmac_f32 v90, v6, v14
  v_fmac_f32 v91, v7, v14
  v_lshlrev_b32 v6, 16, v38
  v_and_b32 v7, 0xffff0000, v38
  v_fmac_f32 v92, v6, v14
  v_fmac_f32 v93, v7, v14
  v_lshlrev_b32 v6, 16, v39
  v_and_b32 v7, 0xffff0000, v39
  v_fmac_f32 v94, v6, v14
  v_fmac_f32 v95, v7, v14
  v_lshlrev_b32 v6, 16, v40
  v_and_b32 v7, 0xffff0000, v40
  v_fmac_f32 v96, v6, v14
  v_fmac_f32 v97, v7, v14
  v_lshlrev_b32 v6, 16, v41
  v_and_b32 v7, 0xffff0000, v41
  v_fmac_f32 v98, v6, v14
  v_fmac_f32 v99, v7, v14
  v_lshlrev_b32 v6, 16, v42
  v_and_b32 v7, 0xffff0000, v42
  v_fmac_f32 v100, v6, v14
  v_fmac_f32 v101, v7, v14
  v_lshlrev_b32 v6, 16, v43
  v_and_b32 v7, 0xffff0000, v43
  v_fmac_f32 v102, v6, v14
  v_fmac_f32 v103, v7, v14
  v_lshlrev_b32 v6, 16, v44
  v_and_b32 v7, 0xffff0000, v44
  v_fmac_f32 v104, v6, v14
  v_fmac_f32 v105, v7, v14
  v_lshlrev_b32 v6, 16, v45
  v_and_b32 v7, 0xffff0000, v45
  v_fmac_f32 v106, v6, v14
  v_fmac_f32 v107, v7, v14
  v_lshlrev_b32 v6, 16, v46
  v_and_b32 v7, 0xffff0000, v46
  v_fmac_f32 v108, v6, v14
  v_fmac_f32 v109, v7, v14
  v_lshlrev_b32 v6, 16, v47
  v_and_b32 v7, 0xffff0000, v47
  v_fmac_f32 v110, v6, v14
  v_fmac_f32 v111, v7, v14
  v_lshlrev_b32 v6, 16, v48
  v_and_b32 v7, 0xffff0000, v48
  v_fmac_f32 v112, v6, v14
  v_fmac_f32 v113, v7, v14
  v_lshlrev_b32 v6, 16, v49
  v_and_b32 v7, 0xffff0000, v49
  v_fmac_f32 v114, v6, v14
  v_fmac_f32 v115, v7, v14
  v_lshlrev_b32 v6, 16, v50
  v_and_b32 v7, 0xffff0000, v50
  v_fmac_f32 v116, v6, v14
  v_fmac_f32 v117, v7, v14
  v_lshlrev_b32 v6, 16, v51
  v_and_b32 v7, 0xffff0000, v51
  v_fmac_f32 v118, v6, v14
  v_fmac_f32 v119, v7, v14
  v_lshlrev_b32 v6, 16, v52
  v_and_b32 v7, 0xffff0000, v52
  v_fmac_f32 v120, v6, v14
  v_fmac_f32 v121, v7, v14
  v_lshlrev_b32 v6, 16, v53
  v_and_b32 v7, 0xffff0000, v53
  v_fmac_f32 v122, v6, v14
  v_fmac_f32 v123, v7, v14
  v_lshlrev_b32 v6, 16, v54
  v_and_b32 v7, 0xffff0000, v54
  v_fmac_f32 v124, v6, v14
  v_fmac_f32 v125, v7, v14
  v_lshlrev_b32 v6, 16, v55
  v_and_b32 v7, 0xffff0000, v55
  v_fmac_f32 v126, v6, v14
  v_fmac_f32 v127, v7, v14
  s_mov_b32 s47, 393216
  buffer_load_dwordx4 v[32:35], v5, s[28:31], s47 offen offset:0
  buffer_load_dwordx4 v[36:39], v5, s[28:31], s47 offen offset:256
  buffer_load_dwordx4 v[40:43], v5, s[28:31], s47 offen offset:512
  buffer_load_dwordx4 v[44:47], v5, s[28:31], s47 offen offset:768
  buffer_load_dwordx4 v[48:51], v5, s[28:31], s47 offen offset:1024
  buffer_load_dwordx4 v[52:55], v5, s[28:31], s47 offen offset:1280
  s_waitcnt vmcnt(6)
  v_lshlrev_b32 v6, 16, v56
  v_and_b32 v7, 0xffff0000, v56
  v_fmac_f32 v80, v6, v15
  v_fmac_f32 v81, v7, v15
  v_lshlrev_b32 v6, 16, v57
  v_and_b32 v7, 0xffff0000, v57
  v_fmac_f32 v82, v6, v15
  v_fmac_f32 v83, v7, v15
  v_lshlrev_b32 v6, 16, v58
  v_and_b32 v7, 0xffff0000, v58
  v_fmac_f32 v84, v6, v15
  v_fmac_f32 v85, v7, v15
  v_lshlrev_b32 v6, 16, v59
  v_and_b32 v7, 0xffff0000, v59
  v_fmac_f32 v86, v6, v15
  v_fmac_f32 v87, v7, v15
  v_lshlrev_b32 v6, 16, v60
  v_and_b32 v7, 0xffff0000, v60
  v_fmac_f32 v88, v6, v15
  v_fmac_f32 v89, v7, v15
  v_lshlrev_b32 v6, 16, v61
  v_and_b32 v7, 0xffff0000, v61
  v_fmac_f32 v90, v6, v15
  v_fmac_f32 v91, v7, v15
  v_lshlrev_b32 v6, 16, v62
  v_and_b32 v7, 0xffff0000, v62
  v_fmac_f32 v92, v6, v15
  v_fmac_f32 v93, v7, v15
  v_lshlrev_b32 v6, 16, v63
  v_and_b32 v7, 0xffff0000, v63
  v_fmac_f32 v94, v6, v15
  v_fmac_f32 v95, v7, v15
  v_lshlrev_b32 v6, 16, v64
  v_and_b32 v7, 0xffff0000, v64
  v_fmac_f32 v96, v6, v15
  v_fmac_f32 v97, v7, v15
  v_lshlrev_b32 v6, 16, v65
  v_and_b32 v7, 0xffff0000, v65
  v_fmac_f32 v98, v6, v15
  v_fmac_f32 v99, v7, v15
  v_lshlrev_b32 v6, 16, v66
  v_and_b32 v7, 0xffff0000, v66
  v_fmac_f32 v100, v6, v15
  v_fmac_f32 v101, v7, v15
  v_lshlrev_b32 v6, 16, v67
  v_and_b32 v7, 0xffff0000, v67
  v_fmac_f32 v102, v6, v15
  v_fmac_f32 v103, v7, v15
  v_lshlrev_b32 v6, 16, v68
  v_and_b32 v7, 0xffff0000, v68
  v_fmac_f32 v104, v6, v15
  v_fmac_f32 v105, v7, v15
  v_lshlrev_b32 v6, 16, v69
  v_and_b32 v7, 0xffff0000, v69
  v_fmac_f32 v106, v6, v15
  v_fmac_f32 v107, v7, v15
  v_lshlrev_b32 v6, 16, v70
  v_and_b32 v7, 0xffff0000, v70
  v_fmac_f32 v108, v6, v15
  v_fmac_f32 v109, v7, v15
  v_lshlrev_b32 v6, 16, v71
  v_and_b32 v7, 0xffff0000, v71
  v_fmac_f32 v110, v6, v15
  v_fmac_f32 v111, v7, v15
  v_lshlrev_b32 v6, 16, v72
  v_and_b32 v7, 0xffff0000, v72
  v_fmac_f32 v112, v6, v15
  v_fmac_f32 v113, v7, v15
  v_lshlrev_b32 v6, 16, v73
  v_and_b32 v7, 0xffff0000, v73
  v_fmac_f32 v114, v6, v15
  v_fmac_f32 v115, v7, v15
  v_lshlrev_b32 v6, 16, v74
  v_and_b32 v7, 0xffff0000, v74
  v_fmac_f32 v116, v6, v15
  v_fmac_f32 v117, v7, v15
  v_lshlrev_b32 v6, 16, v75
  v_and_b32 v7, 0xffff0000, v75
  v_fmac_f32 v118, v6, v15
  v_fmac_f32 v119, v7, v15
  v_lshlrev_b32 v6, 16, v76
  v_and_b32 v7, 0xffff0000, v76
  v_fmac_f32 v120, v6, v15
  v_fmac_f32 v121, v7, v15
  v_lshlrev_b32 v6, 16, v77
  v_and_b32 v7, 0xffff0000, v77
  v_fmac_f32 v122, v6, v15
  v_fmac_f32 v123, v7, v15
  v_lshlrev_b32 v6, 16, v78
  v_and_b32 v7, 0xffff0000, v78
  v_fmac_f32 v124, v6, v15
  v_fmac_f32 v125, v7, v15
  v_lshlrev_b32 v6, 16, v79
  v_and_b32 v7, 0xffff0000, v79
  v_fmac_f32 v126, v6, v15
  v_fmac_f32 v127, v7, v15
  s_mov_b32 s47, 442368
  buffer_load_dwordx4 v[56:59], v5, s[28:31], s47 offen offset:0
  buffer_load_dwordx4 v[60:63], v5, s[28:31], s47 offen offset:256
  buffer_load_dwordx4 v[64:67], v5, s[28:31], s47 offen offset:512
  buffer_load_dwordx4 v[68:71], v5, s[28:31], s47 offen offset:768
  buffer_load_dwordx4 v[72:75], v5, s[28:31], s47 offen offset:1024
  buffer_load_dwordx4 v[76:79], v5, s[28:31], s47 offen offset:1280
  s_waitcnt vmcnt(6)
  v_lshlrev_b32 v6, 16, v32
  v_and_b32 v7, 0xffff0000, v32
  v_fmac_f32 v80, v6, v16
  v_fmac_f32 v81, v7, v16
  v_lshlrev_b32 v6, 16, v33
  v_and_b32 v7, 0xffff0000, v33
  v_fmac_f32 v82, v6, v16
  v_fmac_f32 v83, v7, v16
  v_lshlrev_b32 v6, 16, v34
  v_and_b32 v7, 0xffff0000, v34
  v_fmac_f32 v84, v6, v16
  v_fmac_f32 v85, v7, v16
  v_lshlrev_b32 v6, 16, v35
  v_and_b32 v7, 0xffff0000, v35
  v_fmac_f32 v86, v6, v16
  v_fmac_f32 v87, v7, v16
  v_lshlrev_b32 v6, 16, v36
  v_and_b32 v7, 0xffff0000, v36
  v_fmac_f32 v88, v6, v16
  v_fmac_f32 v89, v7, v16
  v_lshlrev_b32 v6, 16, v37
  v_and_b32 v7, 0xffff0000, v37
  v_fmac_f32 v90, v6, v16
  v_fmac_f32 v91, v7, v16
  v_lshlrev_b32 v6, 16, v38
  v_and_b32 v7, 0xffff0000, v38
  v_fmac_f32 v92, v6, v16
  v_fmac_f32 v93, v7, v16
  v_lshlrev_b32 v6, 16, v39
  v_and_b32 v7, 0xffff0000, v39
  v_fmac_f32 v94, v6, v16
  v_fmac_f32 v95, v7, v16
  v_lshlrev_b32 v6, 16, v40
  v_and_b32 v7, 0xffff0000, v40
  v_fmac_f32 v96, v6, v16
  v_fmac_f32 v97, v7, v16
  v_lshlrev_b32 v6, 16, v41
  v_and_b32 v7, 0xffff0000, v41
  v_fmac_f32 v98, v6, v16
  v_fmac_f32 v99, v7, v16
  v_lshlrev_b32 v6, 16, v42
  v_and_b32 v7, 0xffff0000, v42
  v_fmac_f32 v100, v6, v16
  v_fmac_f32 v101, v7, v16
  v_lshlrev_b32 v6, 16, v43
  v_and_b32 v7, 0xffff0000, v43
  v_fmac_f32 v102, v6, v16
  v_fmac_f32 v103, v7, v16
  v_lshlrev_b32 v6, 16, v44
  v_and_b32 v7, 0xffff0000, v44
  v_fmac_f32 v104, v6, v16
  v_fmac_f32 v105, v7, v16
  v_lshlrev_b32 v6, 16, v45
  v_and_b32 v7, 0xffff0000, v45
  v_fmac_f32 v106, v6, v16
  v_fmac_f32 v107, v7, v16
  v_lshlrev_b32 v6, 16, v46
  v_and_b32 v7, 0xffff0000, v46
  v_fmac_f32 v108, v6, v16
  v_fmac_f32 v109, v7, v16
  v_lshlrev_b32 v6, 16, v47
  v_and_b32 v7, 0xffff0000, v47
  v_fmac_f32 v110, v6, v16
  v_fmac_f32 v111, v7, v16
  v_lshlrev_b32 v6, 16, v48
  v_and_b32 v7, 0xffff0000, v48
  v_fmac_f32 v112, v6, v16
  v_fmac_f32 v113, v7, v16
  v_lshlrev_b32 v6, 16, v49
  v_and_b32 v7, 0xffff0000, v49
  v_fmac_f32 v114, v6, v16
  v_fmac_f32 v115, v7, v16
  v_lshlrev_b32 v6, 16, v50
  v_and_b32 v7, 0xffff0000, v50
  v_fmac_f32 v116, v6, v16
  v_fmac_f32 v117, v7, v16
  v_lshlrev_b32 v6, 16, v51
  v_and_b32 v7, 0xffff0000, v51
  v_fmac_f32 v118, v6, v16
  v_fmac_f32 v119, v7, v16
  v_lshlrev_b32 v6, 16, v52
  v_and_b32 v7, 0xffff0000, v52
  v_fmac_f32 v120, v6, v16
  v_fmac_f32 v121, v7, v16
  v_lshlrev_b32 v6, 16, v53
  v_and_b32 v7, 0xffff0000, v53
  v_fmac_f32 v122, v6, v16
  v_fmac_f32 v123, v7, v16
  v_lshlrev_b32 v6, 16, v54
  v_and_b32 v7, 0xffff0000, v54
  v_fmac_f32 v124, v6, v16
  v_fmac_f32 v125, v7, v16
  v_lshlrev_b32 v6, 16, v55
  v_and_b32 v7, 0xffff0000, v55
  v_fmac_f32 v126, v6, v16
  v_fmac_f32 v127, v7, v16
  s_mov_b32 s47, 491520
  buffer_load_dwordx4 v[32:35], v5, s[28:31], s47 offen offset:0
  buffer_load_dwordx4 v[36:39], v5, s[28:31], s47 offen offset:256
  buffer_load_dwordx4 v[40:43], v5, s[28:31], s47 offen offset:512
  buffer_load_dwordx4 v[44:47], v5, s[28:31], s47 offen offset:768
  buffer_load_dwordx4 v[48:51], v5, s[28:31], s47 offen offset:1024
  buffer_load_dwordx4 v[52:55], v5, s[28:31], s47 offen offset:1280
  s_waitcnt vmcnt(6)
  v_lshlrev_b32 v6, 16, v56
  v_and_b32 v7, 0xffff0000, v56
  v_fmac_f32 v80, v6, v17
  v_fmac_f32 v81, v7, v17
  v_lshlrev_b32 v6, 16, v57
  v_and_b32 v7, 0xffff0000, v57
  v_fmac_f32 v82, v6, v17
  v_fmac_f32 v83, v7, v17
  v_lshlrev_b32 v6, 16, v58
  v_and_b32 v7, 0xffff0000, v58
  v_fmac_f32 v84, v6, v17
  v_fmac_f32 v85, v7, v17
  v_lshlrev_b32 v6, 16, v59
  v_and_b32 v7, 0xffff0000, v59
  v_fmac_f32 v86, v6, v17
  v_fmac_f32 v87, v7, v17
  v_lshlrev_b32 v6, 16, v60
  v_and_b32 v7, 0xffff0000, v60
  v_fmac_f32 v88, v6, v17
  v_fmac_f32 v89, v7, v17
  v_lshlrev_b32 v6, 16, v61
  v_and_b32 v7, 0xffff0000, v61
  v_fmac_f32 v90, v6, v17
  v_fmac_f32 v91, v7, v17
  v_lshlrev_b32 v6, 16, v62
  v_and_b32 v7, 0xffff0000, v62
  v_fmac_f32 v92, v6, v17
  v_fmac_f32 v93, v7, v17
  v_lshlrev_b32 v6, 16, v63
  v_and_b32 v7, 0xffff0000, v63
  v_fmac_f32 v94, v6, v17
  v_fmac_f32 v95, v7, v17
  v_lshlrev_b32 v6, 16, v64
  v_and_b32 v7, 0xffff0000, v64
  v_fmac_f32 v96, v6, v17
  v_fmac_f32 v97, v7, v17
  v_lshlrev_b32 v6, 16, v65
  v_and_b32 v7, 0xffff0000, v65
  v_fmac_f32 v98, v6, v17
  v_fmac_f32 v99, v7, v17
  v_lshlrev_b32 v6, 16, v66
  v_and_b32 v7, 0xffff0000, v66
  v_fmac_f32 v100, v6, v17
  v_fmac_f32 v101, v7, v17
  v_lshlrev_b32 v6, 16, v67
  v_and_b32 v7, 0xffff0000, v67
  v_fmac_f32 v102, v6, v17
  v_fmac_f32 v103, v7, v17
  v_lshlrev_b32 v6, 16, v68
  v_and_b32 v7, 0xffff0000, v68
  v_fmac_f32 v104, v6, v17
  v_fmac_f32 v105, v7, v17
  v_lshlrev_b32 v6, 16, v69
  v_and_b32 v7, 0xffff0000, v69
  v_fmac_f32 v106, v6, v17
  v_fmac_f32 v107, v7, v17
  v_lshlrev_b32 v6, 16, v70
  v_and_b32 v7, 0xffff0000, v70
  v_fmac_f32 v108, v6, v17
  v_fmac_f32 v109, v7, v17
  v_lshlrev_b32 v6, 16, v71
  v_and_b32 v7, 0xffff0000, v71
  v_fmac_f32 v110, v6, v17
  v_fmac_f32 v111, v7, v17
  v_lshlrev_b32 v6, 16, v72
  v_and_b32 v7, 0xffff0000, v72
  v_fmac_f32 v112, v6, v17
  v_fmac_f32 v113, v7, v17
  v_lshlrev_b32 v6, 16, v73
  v_and_b32 v7, 0xffff0000, v73
  v_fmac_f32 v114, v6, v17
  v_fmac_f32 v115, v7, v17
  v_lshlrev_b32 v6, 16, v74
  v_and_b32 v7, 0xffff0000, v74
  v_fmac_f32 v116, v6, v17
  v_fmac_f32 v117, v7, v17
  v_lshlrev_b32 v6, 16, v75
  v_and_b32 v7, 0xffff0000, v75
  v_fmac_f32 v118, v6, v17
  v_fmac_f32 v119, v7, v17
  v_lshlrev_b32 v6, 16, v76
  v_and_b32 v7, 0xffff0000, v76
  v_fmac_f32 v120, v6, v17
  v_fmac_f32 v121, v7, v17
  v_lshlrev_b32 v6, 16, v77
  v_and_b32 v7, 0xffff0000, v77
  v_fmac_f32 v122, v6, v17
  v_fmac_f32 v123, v7, v17
  v_lshlrev_b32 v6, 16, v78
  v_and_b32 v7, 0xffff0000, v78
  v_fmac_f32 v124, v6, v17
  v_fmac_f32 v125, v7, v17
  v_lshlrev_b32 v6, 16, v79
  v_and_b32 v7, 0xffff0000, v79
  v_fmac_f32 v126, v6, v17
  v_fmac_f32 v127, v7, v17
  s_waitcnt vmcnt(0)
  v_lshlrev_b32 v6, 16, v32
  v_and_b32 v7, 0xffff0000, v32
  v_fmac_f32 v80, v6, v18
  v_fmac_f32 v81, v7, v18
  v_lshlrev_b32 v6, 16, v33
  v_and_b32 v7, 0xffff0000, v33
  v_fmac_f32 v82, v6, v18
  v_fmac_f32 v83, v7, v18
  v_lshlrev_b32 v6, 16, v34
  v_and_b32 v7, 0xffff0000, v34
  v_fmac_f32 v84, v6, v18
  v_fmac_f32 v85, v7, v18
  v_lshlrev_b32 v6, 16, v35
  v_and_b32 v7, 0xffff0000, v35
  v_fmac_f32 v86, v6, v18
  v_fmac_f32 v87, v7, v18
  v_lshlrev_b32 v6, 16, v36
  v_and_b32 v7, 0xffff0000, v36
  v_fmac_f32 v88, v6, v18
  v_fmac_f32 v89, v7, v18
  v_lshlrev_b32 v6, 16, v37
  v_and_b32 v7, 0xffff0000, v37
  v_fmac_f32 v90, v6, v18
  v_fmac_f32 v91, v7, v18
  v_lshlrev_b32 v6, 16, v38
  v_and_b32 v7, 0xffff0000, v38
  v_fmac_f32 v92, v6, v18
  v_fmac_f32 v93, v7, v18
  v_lshlrev_b32 v6, 16, v39
  v_and_b32 v7, 0xffff0000, v39
  v_fmac_f32 v94, v6, v18
  v_fmac_f32 v95, v7, v18
  v_lshlrev_b32 v6, 16, v40
  v_and_b32 v7, 0xffff0000, v40
  v_fmac_f32 v96, v6, v18
  v_fmac_f32 v97, v7, v18
  v_lshlrev_b32 v6, 16, v41
  v_and_b32 v7, 0xffff0000, v41
  v_fmac_f32 v98, v6, v18
  v_fmac_f32 v99, v7, v18
  v_lshlrev_b32 v6, 16, v42
  v_and_b32 v7, 0xffff0000, v42
  v_fmac_f32 v100, v6, v18
  v_fmac_f32 v101, v7, v18
  v_lshlrev_b32 v6, 16, v43
  v_and_b32 v7, 0xffff0000, v43
  v_fmac_f32 v102, v6, v18
  v_fmac_f32 v103, v7, v18
  v_lshlrev_b32 v6, 16, v44
  v_and_b32 v7, 0xffff0000, v44
  v_fmac_f32 v104, v6, v18
  v_fmac_f32 v105, v7, v18
  v_lshlrev_b32 v6, 16, v45
  v_and_b32 v7, 0xffff0000, v45
  v_fmac_f32 v106, v6, v18
  v_fmac_f32 v107, v7, v18
  v_lshlrev_b32 v6, 16, v46
  v_and_b32 v7, 0xffff0000, v46
  v_fmac_f32 v108, v6, v18
  v_fmac_f32 v109, v7, v18
  v_lshlrev_b32 v6, 16, v47
  v_and_b32 v7, 0xffff0000, v47
  v_fmac_f32 v110, v6, v18
  v_fmac_f32 v111, v7, v18
  v_lshlrev_b32 v6, 16, v48
  v_and_b32 v7, 0xffff0000, v48
  v_fmac_f32 v112, v6, v18
  v_fmac_f32 v113, v7, v18
  v_lshlrev_b32 v6, 16, v49
  v_and_b32 v7, 0xffff0000, v49
  v_fmac_f32 v114, v6, v18
  v_fmac_f32 v115, v7, v18
  v_lshlrev_b32 v6, 16, v50
  v_and_b32 v7, 0xffff0000, v50
  v_fmac_f32 v116, v6, v18
  v_fmac_f32 v117, v7, v18
  v_lshlrev_b32 v6, 16, v51
  v_and_b32 v7, 0xffff0000, v51
  v_fmac_f32 v118, v6, v18
  v_fmac_f32 v119, v7, v18
  v_lshlrev_b32 v6, 16, v52
  v_and_b32 v7, 0xffff0000, v52
  v_fmac_f32 v120, v6, v18
  v_fmac_f32 v121, v7, v18
  v_lshlrev_b32 v6, 16, v53
  v_and_b32 v7, 0xffff0000, v53
  v_fmac_f32 v122, v6, v18
  v_fmac_f32 v123, v7, v18
  v_lshlrev_b32 v6, 16, v54
  v_and_b32 v7, 0xffff0000, v54
  v_fmac_f32 v124, v6, v18
  v_fmac_f32 v125, v7, v18
  v_lshlrev_b32 v6, 16, v55
  v_and_b32 v7, 0xffff0000, v55
  v_fmac_f32 v126, v6, v18
  v_fmac_f32 v127, v7, v18
  v_mul_u32_u24 v6, 1552, v2
  v_lshl_add_u32 v6, v3, 4, v6
  v_add_u32 v6, 73728, v6

  v_cvt_pk_bf16_f32 v32, v80, v81
  v_cvt_pk_bf16_f32 v33, v82, v83
  v_cvt_pk_bf16_f32 v34, v84, v85
  v_cvt_pk_bf16_f32 v35, v86, v87
  ds_write_b128 v6, v[32:35] offset:0
  s_nop 1
  v_cvt_pk_bf16_f32 v32, v88, v89
  v_cvt_pk_bf16_f32 v33, v90, v91
  v_cvt_pk_bf16_f32 v34, v92, v93
  v_cvt_pk_bf16_f32 v35, v94, v95
  ds_write_b128 v6, v[32:35] offset:256
  s_nop 1
  v_cvt_pk_bf16_f32 v32, v96, v97
  v_cvt_pk_bf16_f32 v33, v98, v99
  v_cvt_pk_bf16_f32 v34, v100, v101
  v_cvt_pk_bf16_f32 v35, v102, v103
  ds_write_b128 v6, v[32:35] offset:512
  s_nop 1
  v_cvt_pk_bf16_f32 v32, v104, v105
  v_cvt_pk_bf16_f32 v33, v106, v107
  v_cvt_pk_bf16_f32 v34, v108, v109
  v_cvt_pk_bf16_f32 v35, v110, v111
  ds_write_b128 v6, v[32:35] offset:768
  s_nop 1
  v_cvt_pk_bf16_f32 v32, v112, v113
  v_cvt_pk_bf16_f32 v33, v114, v115
  v_cvt_pk_bf16_f32 v34, v116, v117
  v_cvt_pk_bf16_f32 v35, v118, v119
  ds_write_b128 v6, v[32:35] offset:1024
  s_nop 1
  v_cvt_pk_bf16_f32 v32, v120, v121
  v_cvt_pk_bf16_f32 v33, v122, v123
  v_cvt_pk_bf16_f32 v34, v124, v125
  v_cvt_pk_bf16_f32 v35, v126, v127
  ds_write_b128 v6, v[32:35] offset:1280
  s_nop 1
  v_and_b32 v2, 15, v194
  v_lshrrev_b32 v3, 4, v194
  s_lshl_b32 s46, s44, 5
  s_lshl_b32 s47, s41, 4
  s_add_u32 s46, s46, s47
  v_add_u32 v4, s46, v2
  v_mul_u32_u24 v4, 1536, v4
  v_lshl_add_u32 v4, v3, 3, v4
  s_mul_i32 s46, s44, 3072
  s_lshl_b32 s47, s45, 1
  s_add_u32 s46, s46, s47
  s_add_u32 s46, s46, 202752
  v_lshlrev_b32 v5, 4, v3

  buffer_load_dwordx2 v[8:9], v4, s[32:35], s45 offen offset:0
  buffer_load_dwordx4 v[16:19], v5, s[16:19], s46 offen offset:0
  buffer_load_dwordx2 v[10:11], v4, s[32:35], s45 offen offset:32
  buffer_load_dwordx4 v[20:23], v5, s[16:19], s46 offen offset:64
  buffer_load_dwordx2 v[12:13], v4, s[32:35], s45 offen offset:64
  buffer_load_dwordx4 v[24:27], v5, s[16:19], s46 offen offset:128
  s_waitcnt lgkmcnt(0)
  s_waitcnt vmcnt(63)
  s_barrier
  v_mul_u32_u24 v6, 1552, v2
  v_lshl_add_u32 v6, v3, 4, v6
  s_mul_i32 s46, s40, 384
  s_add_u32 s46, s46, 73728
  v_add_u32 v6, s46, v6
  v_bfe_u32 v7, v194, 2, 2
  v_lshl_add_u32 v7, v3, 3, v7
  s_mul_i32 s46, s40, 192
  v_add_u32 v7, s46, v7
  v_mul_u32_u24 v7, 96, v7
  v_and_b32 v30, 3, v194
  v_lshl_add_u32 v7, v30, 3, v7

  ds_read_b128 v[48:51], v6 offset:0
  ds_read_b64_tr_b16 v[52:53], v7 offset:0
  ds_read_b64_tr_b16 v[54:55], v7 offset:384
  ds_read_b64_tr_b16 v[56:57], v7 offset:32
  ds_read_b64_tr_b16 v[58:59], v7 offset:416
  ds_read_b64_tr_b16 v[60:61], v7 offset:64
  ds_read_b64_tr_b16 v[62:63], v7 offset:448
  s_waitcnt lgkmcnt(0)
  v_mfma_f32_16x16x32_bf16 v[32:35], v[52:55], v[48:51], 0
  v_mfma_f32_16x16x32_bf16 v[36:39], v[56:59], v[48:51], 0
  v_mfma_f32_16x16x32_bf16 v[40:43], v[60:63], v[48:51], 0
  ds_read_b128 v[64:67], v6 offset:64
  ds_read_b64_tr_b16 v[68:69], v7 offset:3072
  ds_read_b64_tr_b16 v[70:71], v7 offset:3456
  ds_read_b64_tr_b16 v[72:73], v7 offset:3104
  ds_read_b64_tr_b16 v[74:75], v7 offset:3488
  ds_read_b64_tr_b16 v[76:77], v7 offset:3136
  ds_read_b64_tr_b16 v[78:79], v7 offset:3520
  s_waitcnt lgkmcnt(0)
  v_mfma_f32_16x16x32_bf16 v[32:35], v[68:71], v[64:67], v[32:35]
  v_mfma_f32_16x16x32_bf16 v[36:39], v[72:75], v[64:67], v[36:39]
  v_mfma_f32_16x16x32_bf16 v[40:43], v[76:79], v[64:67], v[40:43]
  ds_read_b128 v[48:51], v6 offset:128
  ds_read_b64_tr_b16 v[52:53], v7 offset:6144
  ds_read_b64_tr_b16 v[54:55], v7 offset:6528
  ds_read_b64_tr_b16 v[56:57], v7 offset:6176
  ds_read_b64_tr_b16 v[58:59], v7 offset:6560
  ds_read_b64_tr_b16 v[60:61], v7 offset:6208
  ds_read_b64_tr_b16 v[62:63], v7 offset:6592
  s_waitcnt lgkmcnt(0)
  v_mfma_f32_16x16x32_bf16 v[32:35], v[52:55], v[48:51], v[32:35]
  v_mfma_f32_16x16x32_bf16 v[36:39], v[56:59], v[48:51], v[36:39]
  v_mfma_f32_16x16x32_bf16 v[40:43], v[60:63], v[48:51], v[40:43]
  ds_read_b128 v[64:67], v6 offset:192
  ds_read_b64_tr_b16 v[68:69], v7 offset:9216
  ds_read_b64_tr_b16 v[70:71], v7 offset:9600
  ds_read_b64_tr_b16 v[72:73], v7 offset:9248
  ds_read_b64_tr_b16 v[74:75], v7 offset:9632
  ds_read_b64_tr_b16 v[76:77], v7 offset:9280
  ds_read_b64_tr_b16 v[78:79], v7 offset:9664
  s_waitcnt lgkmcnt(0)
  v_mfma_f32_16x16x32_bf16 v[32:35], v[68:71], v[64:67], v[32:35]
  v_mfma_f32_16x16x32_bf16 v[36:39], v[72:75], v[64:67], v[36:39]
  v_mfma_f32_16x16x32_bf16 v[40:43], v[76:79], v[64:67], v[40:43]
  ds_read_b128 v[48:51], v6 offset:256
  ds_read_b64_tr_b16 v[52:53], v7 offset:12288
  ds_read_b64_tr_b16 v[54:55], v7 offset:12672
  ds_read_b64_tr_b16 v[56:57], v7 offset:12320
  ds_read_b64_tr_b16 v[58:59], v7 offset:12704
  ds_read_b64_tr_b16 v[60:61], v7 offset:12352
  ds_read_b64_tr_b16 v[62:63], v7 offset:12736
  s_waitcnt lgkmcnt(0)
  v_mfma_f32_16x16x32_bf16 v[32:35], v[52:55], v[48:51], v[32:35]
  v_mfma_f32_16x16x32_bf16 v[36:39], v[56:59], v[48:51], v[36:39]
  v_mfma_f32_16x16x32_bf16 v[40:43], v[60:63], v[48:51], v[40:43]
  ds_read_b128 v[64:67], v6 offset:320
  ds_read_b64_tr_b16 v[68:69], v7 offset:15360
  ds_read_b64_tr_b16 v[70:71], v7 offset:15744
  ds_read_b64_tr_b16 v[72:73], v7 offset:15392
  ds_read_b64_tr_b16 v[74:75], v7 offset:15776
  ds_read_b64_tr_b16 v[76:77], v7 offset:15424
  ds_read_b64_tr_b16 v[78:79], v7 offset:15808
  s_waitcnt lgkmcnt(0)
  v_mfma_f32_16x16x32_bf16 v[32:35], v[68:71], v[64:67], v[32:35]
  v_mfma_f32_16x16x32_bf16 v[36:39], v[72:75], v[64:67], v[36:39]
  v_mfma_f32_16x16x32_bf16 v[40:43], v[76:79], v[64:67], v[40:43]
  s_nop 15
  s_barrier
  v_lshlrev_b32 v30, 4, v194
  s_mul_i32 s46, s40, 3072
  v_add_u32 v31, s46, v30
  ds_write_b128 v31, v[32:35]
  ds_write_b128 v31, v[36:39] offset:1024
  ds_write_b128 v31, v[40:43] offset:2048
  s_waitcnt lgkmcnt(0)
  s_barrier
  s_cmp_lg_u32 s40, 0
  s_cbranch_scc1 K4_end

  ds_read_b128 v[48:51], v30 offset:3072
  ds_read_b128 v[52:55], v30 offset:4096
  ds_read_b128 v[56:59], v30 offset:5120
  ds_read_b128 v[60:63], v30 offset:6144
  ds_read_b128 v[64:67], v30 offset:7168
  ds_read_b128 v[68:71], v30 offset:8192
  ds_read_b128 v[72:75], v30 offset:9216
  ds_read_b128 v[76:79], v30 offset:10240
  ds_read_b128 v[80:83], v30 offset:11264
  s_waitcnt lgkmcnt(0) vmcnt(0)
  v_add_f32 v32, v32, v48
  v_add_f32 v33, v33, v49
  v_add_f32 v34, v34, v50
  v_add_f32 v35, v35, v51
  v_add_f32 v36, v36, v52
  v_add_f32 v37, v37, v53
  v_add_f32 v38, v38, v54
  v_add_f32 v39, v39, v55
  v_add_f32 v40, v40, v56
  v_add_f32 v41, v41, v57
  v_add_f32 v42, v42, v58
  v_add_f32 v43, v43, v59
  v_add_f32 v32, v32, v60
  v_add_f32 v33, v33, v61
  v_add_f32 v34, v34, v62
  v_add_f32 v35, v35, v63
  v_add_f32 v36, v36, v64
  v_add_f32 v37, v37, v65
  v_add_f32 v38, v38, v66
  v_add_f32 v39, v39, v67
  v_add_f32 v40, v40, v68
  v_add_f32 v41, v41, v69
  v_add_f32 v42, v42, v70
  v_add_f32 v43, v43, v71
  v_add_f32 v32, v32, v72
  v_add_f32 v33, v33, v73
  v_add_f32 v34, v34, v74
  v_add_f32 v35, v35, v75
  v_add_f32 v36, v36, v76
  v_add_f32 v37, v37, v77
  v_add_f32 v38, v38, v78
  v_add_f32 v39, v39, v79
  v_add_f32 v40, v40, v80
  v_add_f32 v41, v41, v81
  v_add_f32 v42, v42, v82
  v_add_f32 v43, v43, v83
  v_lshlrev_b32 v100, 16, v8
  v_and_b32 v101, 0xffff0000, v8
  v_fmac_f32 v100, v32, v16
  v_fmac_f32 v101, v33, v17
  v_cvt_pk_bf16_f32 v8, v100, v101
  v_lshlrev_b32 v100, 16, v9
  v_and_b32 v101, 0xffff0000, v9
  v_fmac_f32 v100, v34, v18
  v_fmac_f32 v101, v35, v19
  v_cvt_pk_bf16_f32 v9, v100, v101
  buffer_store_dwordx2 v[8:9], v4, s[36:39], s45 offen offset:0
  v_lshlrev_b32 v100, 16, v10
  v_and_b32 v101, 0xffff0000, v10
  v_fmac_f32 v100, v36, v20
  v_fmac_f32 v101, v37, v21
  v_cvt_pk_bf16_f32 v10, v100, v101
  v_lshlrev_b32 v100, 16, v11
  v_and_b32 v101, 0xffff0000, v11
  v_fmac_f32 v100, v38, v22
  v_fmac_f32 v101, v39, v23
  v_cvt_pk_bf16_f32 v11, v100, v101
  buffer_store_dwordx2 v[10:11], v4, s[36:39], s45 offen offset:32
  v_lshlrev_b32 v100, 16, v12
  v_and_b32 v101, 0xffff0000, v12
  v_fmac_f32 v100, v40, v24
  v_fmac_f32 v101, v41, v25
  v_cvt_pk_bf16_f32 v12, v100, v101
  v_lshlrev_b32 v100, 16, v13
  v_and_b32 v101, 0xffff0000, v13
  v_fmac_f32 v100, v42, v26
  v_fmac_f32 v101, v43, v27
  v_cvt_pk_bf16_f32 v13, v100, v101
  buffer_store_dwordx2 v[12:13], v4, s[36:39], s45 offen offset:64
  s_endpgm
K4_end:
  s_endpgm

k4_kernel_END:
.section .rodata,"a"
.p2align 6
.amdhsa_kernel k1_kernel
  .amdhsa_next_free_vgpr 104
  .amdhsa_next_free_sgpr 102
  .amdhsa_accum_offset 104
  .amdhsa_group_segment_fixed_size 0
  .amdhsa_kernarg_size 96
  .amdhsa_user_sgpr_count 2
  .amdhsa_user_sgpr_kernarg_segment_ptr 1
  .amdhsa_system_sgpr_workgroup_id_x 1
.end_amdhsa_kernel
.p2align 6
.amdhsa_kernel k2_kernel
  .amdhsa_next_free_vgpr 336
  .amdhsa_next_free_sgpr 102
  .amdhsa_accum_offset 256
  .amdhsa_group_segment_fixed_size 0
  .amdhsa_kernarg_size 96
  .amdhsa_user_sgpr_count 2
  .amdhsa_user_sgpr_kernarg_segment_ptr 1
  .amdhsa_system_sgpr_workgroup_id_x 1
.end_amdhsa_kernel
.p2align 6
.amdhsa_kernel k3_kernel
  .amdhsa_next_free_vgpr 216
  .amdhsa_next_free_sgpr 102
  .amdhsa_accum_offset 216
  .amdhsa_group_segment_fixed_size 0
  .amdhsa_kernarg_size 96
  .amdhsa_user_sgpr_count 2
  .amdhsa_user_sgpr_kernarg_segment_ptr 1
  .amdhsa_system_sgpr_workgroup_id_x 1
.end_amdhsa_kernel
.p2align 6
.amdhsa_kernel k4_kernel
  .amdhsa_next_free_vgpr 216
  .amdhsa_next_free_sgpr 102
  .amdhsa_accum_offset 216
  .amdhsa_group_segment_fixed_size 0
  .amdhsa_kernarg_size 96
  .amdhsa_user_sgpr_count 2
  .amdhsa_user_sgpr_kernarg_segment_ptr 1
  .amdhsa_system_sgpr_workgroup_id_x 1
.end_amdhsa_kernel
```
